```python
import torch

def _softmax(x, axis=-1):
    return torch.softmax(x, dim=axis)

def _gelu(x):
    return torch.nn.functional.gelu(x, approximate='tanh')

def _silu(x):
    return torch.nn.functional.silu(x)

def _sigmoid(x):
    return torch.sigmoid(x)

def _layernorm(x, axis=-1, eps=1e-05):
    m = x.mean(dim=axis, keepdim=True)
    v = x.var(dim=axis, keepdim=True, unbiased=False)
    return (x - m) / torch.sqrt(v + eps)

def _scatter_add(tgt, idx, src, axis=0):
    return tgt.clone().index_add_(axis, idx, src)

def _segment_sum(src, seg, n):
    out = torch.zeros((n,) + src.shape[1:], dtype=src.dtype)
    return out.index_add_(0, seg, src)

def _pad(x, pw):
    flat = tuple((v for pair in reversed(pw) for v in pair))
    return torch.nn.functional.pad(x, flat)
kernel_name = 'adaLN_cond__compressed_kv_cla__swiglu_ffn__prompt'

def setup_inputs():

    _w = lambda a: (lambda t: t.to(torch.bfloat16) if t.is_floating_point() else t)(torch.as_tensor(a))

    def _A_setup():
        B, H, Sq, Sk, D, M = (1, 32, 2048, 2048, 128, 512)
        Dc = 4 * D
        return {'x': _w((lambda *s: torch.randn(*s, dtype=torch.bfloat16) * 0.05)(B, Sq, M)), 'c_kv': _w((lambda *s: torch.randn(*s, dtype=torch.bfloat16) * 1.6)(B, Sk, Dc)), 'w_q': _w((lambda *s: torch.randn(*s, dtype=torch.bfloat16) * 0.8)(M, H, D) * M ** (-0.5)), 'w_uk': _w((lambda *s: torch.randn(*s, dtype=torch.bfloat16) * 0.8)(Dc, H, D) * Dc ** (-0.5)), 'w_uv': _w((lambda *s: torch.randn(*s, dtype=torch.bfloat16) * 1.6)(Dc, H, D) * Dc ** (-0.5)), 'w_o': _w((lambda *s: torch.randn(*s, dtype=torch.bfloat16) * 1.6)(H, D, M) * (H * D) ** (-0.5))}
    _A_in = _A_setup()

    def _B_setup():
        B, S, D, F = (1, 2048, 512, 1792)
        return {'x': _w((lambda *s: torch.randn(*s, dtype=torch.bfloat16) * 0.05)(B, S, D)), 'w_gate': _w((lambda *s: torch.randn(*s, dtype=torch.bfloat16) * 0.05)(D, F)), 'w_up': _w((lambda *s: torch.randn(*s, dtype=torch.bfloat16) * 0.05)(D, F)), 'w_down': _w((lambda *s: torch.randn(*s, dtype=torch.bfloat16) * 0.05)(F, D))}
    _B_in = _B_setup()
    return {'A_x': _A_in['x'], 'A_c_kv': _A_in['c_kv'], 'A_w_q': _A_in['w_q'], 'A_w_uk': _A_in['w_uk'], 'A_w_uv': _A_in['w_uv'], 'A_w_o': _A_in['w_o'], 'B_x': _B_in['x'], 'B_w_gate': _B_in['w_gate'], 'B_w_up': _B_in['w_up'], 'B_w_down': _B_in['w_down'], 'c': _w((lambda *s: torch.randn(*s, dtype=torch.bfloat16) * 0.1)(1, 512) * 8.0), 'w_mod': _w((lambda *s: torch.randn(*s, dtype=torch.bfloat16) * 0.1)(512, 6 * 512) * 512 ** (-0.5) * 8.0)}

def reference(A_x, A_c_kv, A_w_q, A_w_uk, A_w_uv, A_w_o, B_x, B_w_gate, B_w_up, B_w_down, c, w_mod):

    def _A_ref(x, c_kv, w_q, w_uk, w_uv, w_o):
        B, Sq, M = (x.shape[0], x.shape[1], x.shape[2])
        Sk = c_kv.shape[1]
        H, D = (w_q.shape[1], w_q.shape[2])
        q = torch.einsum('bqm,mhd->bhqd', x, w_q)
        k = torch.einsum('bkc,chd->bhkd', c_kv, w_uk)
        v = torch.einsum('bkc,chd->bhkd', c_kv, w_uv)
        scores = torch.einsum('bhqd,bhkd->bhqk', q, k) * D ** (-0.5)
        off = Sk - Sq
        qi = torch.arange(Sq)[:, None]
        kj = torch.arange(Sk)[None, :]
        cmask = kj <= qi + off
        scores = torch.where(cmask[None, None], scores, -1000000000.0)
        p = _softmax(scores, axis=-1)
        ctx = torch.einsum('bhqk,bhkd->bhqd', p, v)
        return torch.einsum('bhqd,hdm->bqm', ctx, w_o)

    def _B_ref(x, w_gate, w_up, w_down):
        g = _silu(x @ w_gate)
        u = x @ w_up
        return g * u @ w_down
    x = A_x
    mod = (_silu(c) @ w_mod).reshape(c.shape[0], 6, 1, -1)
    sa, ca, ga, sb, cb, gb = (mod[:, 0].clone(), mod[:, 1].clone(), mod[:, 2].clone(), mod[:, 3].clone(), mod[:, 4].clone(), mod[:, 5].clone())
    h = _layernorm(x, axis=-1) * (1 + ca) + sa
    x = x + ga * _A_ref(h, A_c_kv, A_w_q, A_w_uk, A_w_uv, A_w_o)
    h = _layernorm(x, axis=-1) * (1 + cb) + sb
    x = x + gb * _B_ref(h, B_w_gate, B_w_up, B_w_down)
    return x
```

```asm
; @launch grid=(256,1,1) block=(512,1,1) lds=163840
.amdgcn_target "amdgcn-amd-amdhsa--gfx950"
.text
.globl adaLN_cond__compressed_kv_cla__swiglu_ffn__prompt_kernel
.p2align 8
.type adaLN_cond__compressed_kv_cla__swiglu_ffn__prompt_kernel,@function
adaLN_cond__compressed_kv_cla__swiglu_ffn__prompt_kernel:
s_cmp_ge_u32 s2, 256
s_cbranch_scc1 L_end_adaLN_cond__compressed_kv_cla__swiglu_ffn__prompt_kernel
s_load_dwordx2 s[4:5], s[0:1], 112
s_load_dwordx2 s[8:9], s[0:1], 104
s_load_dwordx2 s[12:13], s[0:1], 8
s_load_dwordx2 s[16:17], s[0:1], 24
s_load_dwordx2 s[56:57], s[0:1], 32
s_load_dwordx2 s[88:89], s[0:1], 0
s_load_dwordx2 s[92:93], s[0:1], 88
s_load_dwordx2 s[96:97], s[0:1], 80
s_sub_u32 s3, s2, 64
s_min_u32 s3, s3, 96
v_lshrrev_b32 v14, 6, v0
v_and_b32 v0, 63, v0
s_nop 0
v_readfirstlane_b32 s20, v14
s_and_b32 s21, s2, 7
s_lshl_b32 s21, s21, 2
s_bfe_u32 s38, s2, 0x20003
s_add_u32 s21, s21, s38
s_lshr_b32 s22, s2, 5
s_lshr_b32 s23, s20, 2
s_sub_u32 s38, 7, s20
s_sub_u32 s39, 15, s22
s_cmp_eq_u32 s23, 0
s_cselect_b32 s24, s20, s38
s_cselect_b32 s40, s39, s22
s_lshl_b32 s25, s40, 3
s_lshl_b32 s38, s24, 1
s_add_u32 s25, s25, s38
s_lshl_b32 s26, s39, 1
s_lshl_b32 s27, s22, 1
s_lshl_b32 s33, s39, 15
s_lshl_b32 s32, s22, 15
s_and_b32 s34, s20, 3
s_lshl_b32 s34, s34, 12
s_mul_i32 s38, s21, 524288
s_add_u32 s38, s38, s34
s_add_u32 s30, s38, 0x2000000
s_add_u32 s31, s38, 0x3100000
s_and_b32 s87, s2, 1
s_lshl_b32 s87, s87, 2
s_bfe_u32 s38, s2, 0x20003
s_add_u32 s87, s87, s38
s_bfe_u32 s84, s2, 0x20001
s_lshl_b32 s84, s84, 3
s_lshr_b32 s38, s2, 5
s_xor_b32 s38, s38, 0
s_add_u32 s84, s84, s38
v_lshrrev_b32 v14, 3, v0
v_lshlrev_b32 v1, 10, v14
v_lshrrev_b32 v14, 4, v0
v_and_b32 v15, 7, v0
v_xor_b32 v14, v14, v15
v_xor_b32 v15, 4, v14
v_lshl_add_u32 v2, v15, 4, v1
v_lshl_add_u32 v1, v14, 4, v1
v_add_u32 v2, 7168, v2
v_lshrrev_b32 v14, 3, v0
s_mov_b32 s55, 8192
v_mul_lo_u32 v3, v14, s55
v_bfe_u32 v14, v14, 1, 1
v_bfe_u32 v15, v0, 1, 2
v_xor_b32 v14, v14, v15
v_and_b32 v15, 1, v0
v_lshlrev_b32 v15, 4, v15
v_add_u32 v3, v3, v15
v_xor_b32 v15, 2, v14
v_lshl_add_u32 v4, v15, 5, v3
v_lshl_add_u32 v3, v14, 5, v3
v_add_u32 v4, 64512, v4
v_lshrrev_b32 v14, 4, v0
v_bfe_u32 v15, v0, 2, 2
v_lshl_add_u32 v6, v14, 3, v15
v_lshlrev_b32 v6, 7, v6
v_and_b32 v14, 1, v14
v_lshlrev_b32 v14, 1, v14
v_lshrrev_b32 v15, 1, v15
v_or_b32 v14, v14, v15
v_lshl_add_u32 v6, v14, 5, v6
v_and_b32 v15, 3, v0
v_lshl_add_u32 v6, v15, 3, v6
v_xor_b32 v7, 32, v6
v_xor_b32 v8, 64, v6
v_xor_b32 v9, 96, v6
s_mul_i32 s55, s20, 12288
s_add_u32 s55, s55, 65536
v_and_b32 v14, 15, v0
v_lshlrev_b32 v10, 7, v14
v_lshrrev_b32 v14, 1, v14
v_lshrrev_b32 v15, 4, v0
v_xor_b32 v14, v14, v15
v_lshl_add_u32 v10, v14, 4, v10
v_add_u32 v10, s55, v10
v_xor_b32 v11, 64, v10
v_lshlrev_b32 v5, 4, v0
s_lshl_b32 s38, s87, 8
s_lshl_b32 s43, s20, 5
s_add_u32 s43, s38, s43
s_lshl_b32 s43, s43, 10
s_lshl_b32 s52, s20, 17
s_lshl_b32 s38, s21, 8
s_add_u32 s52, s52, s38
s_lshl_b32 s53, s20, 11
s_lshl_b32 s85, s20, 17
s_lshl_b32 s38, s84, 8
s_add_u32 s85, s85, s38
s_mul_i32 s54, s84, 524288
s_lshl_b32 s38, s87, 3
s_add_u32 s38, s38, s20
s_lshl_b32 s38, s38, 13
s_add_u32 s54, s54, s38
v_lshrrev_b32 v14, 4, v0
v_lshlrev_b32 v14, 2, v14
v_and_b32 v15, 15, v0
v_cmp_le_u32 s[44:45], v14, v15
v_add_u32 v14, 1, v14
v_cmp_le_u32 s[46:47], v14, v15
v_add_u32 v14, 1, v14
v_cmp_le_u32 s[48:49], v14, v15
v_add_u32 v14, 1, v14
v_cmp_le_u32 s[50:51], v14, v15
s_mov_b32 s42, 0
s_mov_b32 s86, 0x7ff00000
s_waitcnt lgkmcnt(0)
s_mov_b32 s6, 0x10000000
s_mov_b32 s7, 0x20000
s_mov_b32 s10, 0x100
s_mov_b32 s11, 0x20000
s_mov_b32 s14, 0x200000
s_mov_b32 s15, 0x20000
s_mov_b32 s18, 0x400000
s_mov_b32 s19, 0x20000
s_mov_b32 s58, 0x400000
s_mov_b32 s59, 0x20000
s_mov_b32 s90, 0x200000
s_mov_b32 s91, 0x20000
s_mov_b32 s94, 0x300000
s_mov_b32 s95, 0x20000
s_mov_b32 s98, 0x400
s_mov_b32 s99, 0x20000
s_cmp_lg_u32 s20, 7
s_cbranch_scc1 L_noct_1001
s_lshr_b32 s38, s2, 3
s_getpc_b64 s[60:61]
L_pc_1002:
s_sub_u32 s60, s60, L_pc_1002-adaLN_cond__compressed_kv_cla__swiglu_ffn__prompt_kernel
s_subb_u32 s61, s61, 0
s_and_b32 s62, s38, 7
s_add_u32 s62, s62, 0
s_lshl_b32 s62, s62, 13
v_lshlrev_b32 v16, 7, v0
v_add_u32 v16, s62, v16
v_min_u32 v16, L_end_adaLN_cond__compressed_kv_cla__swiglu_ffn__prompt_kernel-adaLN_cond__compressed_kv_cla__swiglu_ffn__prompt_kernel, v16
v_mov_b32 v17, s61
v_add_co_u32 v16, vcc, s60, v16
s_nop 1
v_addc_co_u32 v17, vcc, 0, v17, vcc
global_load_dword v18, v[16:17], off
L_noct_1001:
s_add_u32 m0, s53, 0x0
s_add_u32 s38, s85, 0x0
buffer_load_dwordx4 v3, s[16:19], s38 offen lds
buffer_load_dwordx4 v4, s[16:19], s38 offen offset:1024 lds
s_add_u32 m0, s55, 0
s_add_u32 s38, s43, 0
buffer_load_dwordx4 v1, s[12:15], s38 offen lds
buffer_load_dwordx4 v2, s[12:15], s38 offen offset:1024 lds
s_add_u32 m0, s55, 2048
s_add_u32 s38, s43, 16384
buffer_load_dwordx4 v1, s[12:15], s38 offen lds
buffer_load_dwordx4 v2, s[12:15], s38 offen offset:1024 lds
s_lshr_b32 s38, s2, 5
s_mul_i32 s38, s38, 160
s_lshl_b32 s39, s20, 6
s_add_u32 s38, s38, s39
v_add_u32 v56, s38, v0
v_add_u32 v57, s39, v0
v_mov_b32 v58, 0xcccd
v_mul_u32_u24 v58, v56, v58
v_lshrrev_b32 v58, 18, v58
v_mul_u32_u24 v59, 5, v58
v_sub_u32 v59, v56, v59
v_add_u32 v59, 3, v59
v_lshlrev_b32 v59, 7, v59
v_lshl_add_u32 v59, v58, 10, v59
s_lshl_b32 s38, s87, 18
v_add_u32 v59, s38, v59
v_cmp_gt_u32 vcc, 160, v57
v_mov_b32 v58, 0x7ff00000
s_nop 0
v_cndmask_b32 v59, v58, v59, vcc
buffer_load_dword v12, v59, s[12:15], 0 offen
s_add_u32 m0, s55, 4096
s_add_u32 s38, s43, 128
buffer_load_dwordx4 v1, s[12:15], s38 offen lds
buffer_load_dwordx4 v2, s[12:15], s38 offen offset:1024 lds
s_add_u32 m0, s55, 6144
s_add_u32 s38, s43, 16512
buffer_load_dwordx4 v1, s[12:15], s38 offen lds
buffer_load_dwordx4 v2, s[12:15], s38 offen offset:1024 lds
s_cmp_ge_u32 s3, 0
s_cselect_b32 s39, 0, s86
s_cmp_lt_u32 s3, 96
s_cselect_b32 s39, s39, s86
v_and_b32 v116, 3, v0
v_lshrrev_b32 v117, 2, v0
s_lshl_b32 s38, s20, 4
v_add_u32 v117, s38, v117
s_movk_i32 s38, 6144
v_mul_lo_u32 v118, v117, s38
v_lshl_add_u32 v118, v116, 4, v118
s_lshl_b32 s38, s3, 6
v_add_u32 v118, s38, v118
v_lshlrev_b32 v119, 1, v117
buffer_load_ushort v96, v119, s[96:99], s39 offen offset:0
buffer_load_ushort v97, v119, s[96:99], s39 offen offset:256
buffer_load_ushort v98, v119, s[96:99], s39 offen offset:512
buffer_load_ushort v99, v119, s[96:99], s39 offen offset:768
s_add_u32 s38, s39, 0x0
buffer_load_dwordx4 v[100:103], v118, s[92:95], s38 offen
s_add_u32 s38, s39, 0xc0000
buffer_load_dwordx4 v[104:107], v118, s[92:95], s38 offen
s_add_u32 s38, s39, 0x180000
buffer_load_dwordx4 v[108:111], v118, s[92:95], s38 offen
s_add_u32 s38, s39, 0x240000
buffer_load_dwordx4 v[112:115], v118, s[92:95], s38 offen
s_add_u32 m0, s53, 0x4000
s_add_u32 s38, s85, 0x100000
buffer_load_dwordx4 v3, s[16:19], s38 offen lds
buffer_load_dwordx4 v4, s[16:19], s38 offen offset:1024 lds
s_add_u32 m0, s55, 8192
s_add_u32 s38, s43, 256
buffer_load_dwordx4 v1, s[12:15], s38 offen lds
buffer_load_dwordx4 v2, s[12:15], s38 offen offset:1024 lds
s_add_u32 m0, s55, 10240
s_add_u32 s38, s43, 16640
buffer_load_dwordx4 v1, s[12:15], s38 offen lds
buffer_load_dwordx4 v2, s[12:15], s38 offen offset:1024 lds
s_add_u32 m0, s53, 0x8000
s_add_u32 s38, s85, 0x200000
buffer_load_dwordx4 v3, s[16:19], s38 offen lds
buffer_load_dwordx4 v4, s[16:19], s38 offen offset:1024 lds
s_lshl_b32 s38, s21, 3
s_add_u32 s38, s38, s20
s_lshl_b32 s39, s22, 7
s_add_u32 s39, s39, s38
s_sub_u32 s40, 14, s22
s_lshl_b32 s40, s40, 7
s_add_u32 s40, s40, s38
s_cmp_lt_u32 s38, 128
s_cselect_b32 s29, s39, s40
s_waitcnt vmcnt(21)
ds_read_b128 a[0:3], v10 offset:0
ds_read_b128 a[4:7], v10 offset:2048
ds_read_b128 a[8:11], v11 offset:0
ds_read_b128 a[12:15], v11 offset:2048
s_waitcnt lgkmcnt(0)
s_barrier
s_add_u32 m0, s55, 0
s_add_u32 s38, s43, 384
buffer_load_dwordx4 v1, s[12:15], s38 offen lds
buffer_load_dwordx4 v2, s[12:15], s38 offen offset:1024 lds
s_add_u32 m0, s55, 2048
s_add_u32 s38, s43, 16768
buffer_load_dwordx4 v1, s[12:15], s38 offen lds
buffer_load_dwordx4 v2, s[12:15], s38 offen offset:1024 lds
ds_read_b64_tr_b16 v[16:17], v6 offset:0
ds_read_b64_tr_b16 v[18:19], v6 offset:512
ds_read_b64_tr_b16 v[20:21], v7 offset:0
ds_read_b64_tr_b16 v[22:23], v7 offset:512
ds_read_b64_tr_b16 v[24:25], v8 offset:0
ds_read_b64_tr_b16 v[26:27], v8 offset:512
ds_read_b64_tr_b16 v[28:29], v9 offset:0
ds_read_b64_tr_b16 v[30:31], v9 offset:512
ds_read_b64_tr_b16 v[32:33], v6 offset:4096
ds_read_b64_tr_b16 v[34:35], v6 offset:4608
ds_read_b64_tr_b16 v[36:37], v7 offset:4096
ds_read_b64_tr_b16 v[38:39], v7 offset:4608
ds_read_b64_tr_b16 v[40:41], v8 offset:4096
ds_read_b64_tr_b16 v[42:43], v8 offset:4608
ds_read_b64_tr_b16 v[44:45], v9 offset:4096
s_waitcnt lgkmcnt(7)
ds_read_b64_tr_b16 v[46:47], v9 offset:4608
v_mfma_f32_16x16x32_bf16 v[64:67], v[16:19], a[0:3], 0
ds_read_b64_tr_b16 v[48:49], v6 offset:8192
v_mfma_f32_16x16x32_bf16 v[80:83], v[16:19], a[4:7], 0
ds_read_b64_tr_b16 v[50:51], v6 offset:8704
v_mfma_f32_16x16x32_bf16 v[68:71], v[20:23], a[0:3], 0
ds_read_b64_tr_b16 v[52:53], v7 offset:8192
v_mfma_f32_16x16x32_bf16 v[84:87], v[20:23], a[4:7], 0
ds_read_b64_tr_b16 v[54:55], v7 offset:8704
v_mfma_f32_16x16x32_bf16 v[72:75], v[24:27], a[0:3], 0
ds_read_b64_tr_b16 v[56:57], v8 offset:8192
v_mfma_f32_16x16x32_bf16 v[88:91], v[24:27], a[4:7], 0
ds_read_b64_tr_b16 v[58:59], v8 offset:8704
v_mfma_f32_16x16x32_bf16 v[76:79], v[28:31], a[0:3], 0
ds_read_b64_tr_b16 v[60:61], v9 offset:8192
v_mfma_f32_16x16x32_bf16 v[92:95], v[28:31], a[4:7], 0
s_waitcnt lgkmcnt(7)
ds_read_b64_tr_b16 v[62:63], v9 offset:8704
s_waitcnt vmcnt(20)
ds_read_b128 a[16:19], v10 offset:4096
ds_read_b128 a[20:23], v10 offset:6144
ds_read_b128 a[24:27], v11 offset:4096
ds_read_b128 a[28:31], v11 offset:6144
v_mfma_f32_16x16x32_bf16 v[64:67], v[32:35], a[8:11], v[64:67]
ds_read_b64_tr_b16 v[16:17], v6 offset:12288
v_mfma_f32_16x16x32_bf16 v[80:83], v[32:35], a[12:15], v[80:83]
ds_read_b64_tr_b16 v[18:19], v6 offset:12800
v_mfma_f32_16x16x32_bf16 v[68:71], v[36:39], a[8:11], v[68:71]
ds_read_b64_tr_b16 v[20:21], v7 offset:12288
v_mfma_f32_16x16x32_bf16 v[84:87], v[36:39], a[12:15], v[84:87]
s_waitcnt lgkmcnt(3)
ds_read_b64_tr_b16 v[22:23], v7 offset:12800
v_mfma_f32_16x16x32_bf16 v[72:75], v[40:43], a[8:11], v[72:75]
ds_read_b64_tr_b16 v[24:25], v8 offset:12288
v_mfma_f32_16x16x32_bf16 v[88:91], v[40:43], a[12:15], v[88:91]
ds_read_b64_tr_b16 v[26:27], v8 offset:12800
v_mfma_f32_16x16x32_bf16 v[76:79], v[44:47], a[8:11], v[76:79]
ds_read_b64_tr_b16 v[28:29], v9 offset:12288
v_mfma_f32_16x16x32_bf16 v[92:95], v[44:47], a[12:15], v[92:95]
s_waitcnt lgkmcnt(7)
ds_read_b64_tr_b16 v[30:31], v9 offset:12800
s_waitcnt vmcnt(12)
s_cmp_ge_u32 s3, 0
s_cbranch_scc0 L_modp_1003
s_cmp_lt_u32 s3, 96
s_cbranch_scc0 L_modp_1003
s_mov_b32 s38, 0x3fb8aa3b
v_lshlrev_b32 v96, 16, v96
v_lshlrev_b32 v97, 16, v97
v_lshlrev_b32 v98, 16, v98
v_lshlrev_b32 v99, 16, v99
v_mul_f32 v116, s38, v96
v_mul_f32 v117, s38, v97
v_mul_f32 v118, s38, v98
v_mul_f32 v119, s38, v99
v_exp_f32 v116, -v116
v_exp_f32 v117, -v117
v_exp_f32 v118, -v118
v_exp_f32 v119, -v119
s_nop 0
v_add_f32 v116, 1.0, v116
v_add_f32 v117, 1.0, v117
v_add_f32 v118, 1.0, v118
v_add_f32 v119, 1.0, v119
v_rcp_f32 v116, v116
v_rcp_f32 v117, v117
v_rcp_f32 v118, v118
v_rcp_f32 v119, v119
s_nop 0
v_mul_f32 v96, v96, v116
v_mul_f32 v97, v97, v117
v_mul_f32 v98, v98, v118
v_mul_f32 v99, v99, v119
s_mov_b32 s39, 0xffff0000
v_lshlrev_b32 v116, 16, v100
v_and_b32 v117, s39, v100
v_mul_f32 v120, v96, v116
v_mul_f32 v121, v96, v117
v_lshlrev_b32 v116, 16, v101
v_and_b32 v117, s39, v101
v_mul_f32 v122, v96, v116
v_mul_f32 v123, v96, v117
v_lshlrev_b32 v116, 16, v102
v_and_b32 v117, s39, v102
v_mul_f32 v124, v96, v116
v_mul_f32 v125, v96, v117
v_lshlrev_b32 v116, 16, v103
v_and_b32 v117, s39, v103
v_mul_f32 v126, v96, v116
v_mul_f32 v127, v96, v117
v_lshlrev_b32 v116, 16, v104
v_and_b32 v117, s39, v104
v_fmac_f32 v120, v97, v116
v_fmac_f32 v121, v97, v117
v_lshlrev_b32 v116, 16, v105
v_and_b32 v117, s39, v105
v_fmac_f32 v122, v97, v116
v_fmac_f32 v123, v97, v117
v_lshlrev_b32 v116, 16, v106
v_and_b32 v117, s39, v106
v_fmac_f32 v124, v97, v116
v_fmac_f32 v125, v97, v117
v_lshlrev_b32 v116, 16, v107
v_and_b32 v117, s39, v107
v_fmac_f32 v126, v97, v116
v_fmac_f32 v127, v97, v117
v_lshlrev_b32 v116, 16, v108
v_and_b32 v117, s39, v108
v_fmac_f32 v120, v98, v116
v_fmac_f32 v121, v98, v117
v_lshlrev_b32 v116, 16, v109
v_and_b32 v117, s39, v109
v_fmac_f32 v122, v98, v116
v_fmac_f32 v123, v98, v117
v_lshlrev_b32 v116, 16, v110
v_and_b32 v117, s39, v110
v_fmac_f32 v124, v98, v116
v_fmac_f32 v125, v98, v117
v_lshlrev_b32 v116, 16, v111
v_and_b32 v117, s39, v111
v_fmac_f32 v126, v98, v116
v_fmac_f32 v127, v98, v117
v_lshlrev_b32 v116, 16, v112
v_and_b32 v117, s39, v112
v_fmac_f32 v120, v99, v116
v_fmac_f32 v121, v99, v117
v_lshlrev_b32 v116, 16, v113
v_and_b32 v117, s39, v113
v_fmac_f32 v122, v99, v116
v_fmac_f32 v123, v99, v117
v_lshlrev_b32 v116, 16, v114
v_and_b32 v117, s39, v114
v_fmac_f32 v124, v99, v116
v_fmac_f32 v125, v99, v117
v_lshlrev_b32 v116, 16, v115
v_and_b32 v117, s39, v115
v_fmac_f32 v126, v99, v116
v_fmac_f32 v127, v99, v117
s_nop 1
v_add_f32_dpp v120, v120, v120 row_ror:8 row_mask:0xf bank_mask:0xf
v_add_f32_dpp v121, v121, v121 row_ror:8 row_mask:0xf bank_mask:0xf
v_add_f32_dpp v122, v122, v122 row_ror:8 row_mask:0xf bank_mask:0xf
v_add_f32_dpp v123, v123, v123 row_ror:8 row_mask:0xf bank_mask:0xf
v_add_f32_dpp v124, v124, v124 row_ror:8 row_mask:0xf bank_mask:0xf
v_add_f32_dpp v125, v125, v125 row_ror:8 row_mask:0xf bank_mask:0xf
v_add_f32_dpp v126, v126, v126 row_ror:8 row_mask:0xf bank_mask:0xf
v_add_f32_dpp v127, v127, v127 row_ror:8 row_mask:0xf bank_mask:0xf
s_nop 1
v_add_f32_dpp v120, v120, v120 row_ror:4 row_mask:0xf bank_mask:0xf
v_add_f32_dpp v121, v121, v121 row_ror:4 row_mask:0xf bank_mask:0xf
v_add_f32_dpp v122, v122, v122 row_ror:4 row_mask:0xf bank_mask:0xf
v_add_f32_dpp v123, v123, v123 row_ror:4 row_mask:0xf bank_mask:0xf
v_add_f32_dpp v124, v124, v124 row_ror:4 row_mask:0xf bank_mask:0xf
v_add_f32_dpp v125, v125, v125 row_ror:4 row_mask:0xf bank_mask:0xf
v_add_f32_dpp v126, v126, v126 row_ror:4 row_mask:0xf bank_mask:0xf
v_add_f32_dpp v127, v127, v127 row_ror:4 row_mask:0xf bank_mask:0xf
v_lshrrev_b32 v117, 4, v0
s_lshl_b32 s38, s20, 2
v_add_u32 v117, s38, v117
v_lshlrev_b32 v117, 7, v117
v_and_b32 v116, 3, v0
v_lshl_add_u32 v117, v116, 5, v117
v_add_u32 v117, 49152, v117
v_and_b32 v116, 15, v0
v_cmp_gt_u32 vcc, 4, v116
s_nop 1
s_mov_b64 exec, vcc
ds_write_b128 v117, v[120:123]
ds_write_b128 v117, v[124:127] offset:16
s_mov_b64 exec, -1
s_waitcnt lgkmcnt(0)
L_modp_1003:
s_waitcnt vmcnt(10)
s_barrier
s_cmp_ge_u32 s3, 0
s_cselect_b32 s39, 0, s86
s_cmp_lt_u32 s3, 96
s_cselect_b32 s39, s39, s86
s_cmp_eq_u32 s20, 0
s_cselect_b32 s39, s39, s86
s_cmp_lg_u32 s39, 0
s_cbranch_scc1 L_modfin_1004
v_and_b32 v116, 31, v0
v_lshlrev_b32 v116, 2, v116
v_lshrrev_b32 v117, 5, v0
v_lshl_add_u32 v116, v117, 11, v116
v_add_u32 v116, 49152, v116
s_waitcnt lgkmcnt(0)
ds_read_b32 v100, v116 offset:0
ds_read_b32 v101, v116 offset:128
ds_read_b32 v102, v116 offset:256
ds_read_b32 v103, v116 offset:384
ds_read_b32 v104, v116 offset:512
ds_read_b32 v105, v116 offset:640
ds_read_b32 v106, v116 offset:768
ds_read_b32 v107, v116 offset:896
ds_read_b32 v108, v116 offset:1024
ds_read_b32 v109, v116 offset:1152
ds_read_b32 v110, v116 offset:1280
ds_read_b32 v111, v116 offset:1408
ds_read_b32 v112, v116 offset:1536
ds_read_b32 v113, v116 offset:1664
ds_read_b32 v114, v116 offset:1792
s_waitcnt lgkmcnt(7)
ds_read_b32 v115, v116 offset:1920
s_waitcnt lgkmcnt(0)
v_add_f32 v100, v100, v108
v_add_f32 v101, v101, v109
v_add_f32 v102, v102, v110
v_add_f32 v103, v103, v111
v_add_f32 v104, v104, v112
v_add_f32 v105, v105, v113
v_add_f32 v106, v106, v114
v_add_f32 v107, v107, v115
v_add_f32 v100, v100, v104
v_add_f32 v101, v101, v105
v_add_f32 v102, v102, v106
v_add_f32 v103, v103, v107
v_add_f32 v100, v100, v102
v_add_f32 v101, v101, v103
v_add_f32 v100, v100, v101
v_mov_b32 v101, v100
s_nop 1
v_permlane32_swap_b32 v100, v101
v_add_f32 v100, v100, v101
L_modfin_1004:
v_lshlrev_b32 v116, 2, v0
v_cmp_gt_u32 vcc, 32, v0
v_mov_b32 v117, 0x7ff00000
s_nop 0
v_cndmask_b32 v116, v117, v116, vcc
s_lshl_b32 s38, s3, 7
s_add_u32 s38, s38, 0x0
s_add_u32 s38, s38, s39
buffer_store_dword v100, v116, s[4:7], s38 offen sc1
s_lshl_b32 s38, s3, 7
s_add_u32 s38, s38, 0x20000
s_cmp_lt_u32 s3, 32
s_cselect_b32 s38, s38, s86
s_cmp_eq_u32 s20, 0
s_cselect_b32 s38, s38, s86
v_mov_b32 v118, 0
v_lshlrev_b32 v119, 12, v0
s_mov_b64 exec, 15
buffer_store_dword v118, v119, s[4:7], s38 offen sc1
s_mov_b64 exec, -1
v_add_u32 v6, 0x4000, v6
v_add_u32 v7, 0x4000, v7
v_add_u32 v8, 0x4000, v8
v_add_u32 v9, 0x4000, v9
s_add_u32 m0, s55, 4096
s_add_u32 s38, s43, 512
buffer_load_dwordx4 v1, s[12:15], s38 offen lds
buffer_load_dwordx4 v2, s[12:15], s38 offen offset:1024 lds
s_add_u32 m0, s55, 6144
s_add_u32 s38, s43, 16896
buffer_load_dwordx4 v1, s[12:15], s38 offen lds
buffer_load_dwordx4 v2, s[12:15], s38 offen offset:1024 lds
v_mfma_f32_16x16x32_bf16 v[64:67], v[48:51], a[16:19], v[64:67]
ds_read_b64_tr_b16 v[32:33], v6 offset:0
v_mfma_f32_16x16x32_bf16 v[80:83], v[48:51], a[20:23], v[80:83]
ds_read_b64_tr_b16 v[34:35], v6 offset:512
v_mfma_f32_16x16x32_bf16 v[68:71], v[52:55], a[16:19], v[68:71]
ds_read_b64_tr_b16 v[36:37], v7 offset:0
v_mfma_f32_16x16x32_bf16 v[84:87], v[52:55], a[20:23], v[84:87]
ds_read_b64_tr_b16 v[38:39], v7 offset:512
v_mfma_f32_16x16x32_bf16 v[72:75], v[56:59], a[16:19], v[72:75]
ds_read_b64_tr_b16 v[40:41], v8 offset:0
v_mfma_f32_16x16x32_bf16 v[88:91], v[56:59], a[20:23], v[88:91]
ds_read_b64_tr_b16 v[42:43], v8 offset:512
v_mfma_f32_16x16x32_bf16 v[76:79], v[60:63], a[16:19], v[76:79]
ds_read_b64_tr_b16 v[44:45], v9 offset:0
v_mfma_f32_16x16x32_bf16 v[92:95], v[60:63], a[20:23], v[92:95]
s_waitcnt lgkmcnt(7)
ds_read_b64_tr_b16 v[46:47], v9 offset:512
s_waitcnt vmcnt(12)
ds_read_b128 a[32:35], v10 offset:8192
ds_read_b128 a[36:39], v10 offset:10240
ds_read_b128 a[40:43], v11 offset:8192
ds_read_b128 a[44:47], v11 offset:10240
v_mfma_f32_16x16x32_bf16 v[64:67], v[16:19], a[24:27], v[64:67]
ds_read_b64_tr_b16 v[48:49], v6 offset:4096
v_mfma_f32_16x16x32_bf16 v[80:83], v[16:19], a[28:31], v[80:83]
ds_read_b64_tr_b16 v[50:51], v6 offset:4608
v_mfma_f32_16x16x32_bf16 v[68:71], v[20:23], a[24:27], v[68:71]
ds_read_b64_tr_b16 v[52:53], v7 offset:4096
v_mfma_f32_16x16x32_bf16 v[84:87], v[20:23], a[28:31], v[84:87]
s_waitcnt lgkmcnt(3)
ds_read_b64_tr_b16 v[54:55], v7 offset:4608
v_mfma_f32_16x16x32_bf16 v[72:75], v[24:27], a[24:27], v[72:75]
ds_read_b64_tr_b16 v[56:57], v8 offset:4096
v_mfma_f32_16x16x32_bf16 v[88:91], v[24:27], a[28:31], v[88:91]
ds_read_b64_tr_b16 v[58:59], v8 offset:4608
v_mfma_f32_16x16x32_bf16 v[76:79], v[28:31], a[24:27], v[76:79]
ds_read_b64_tr_b16 v[60:61], v9 offset:4096
v_mfma_f32_16x16x32_bf16 v[92:95], v[28:31], a[28:31], v[92:95]
s_waitcnt lgkmcnt(7)
ds_read_b64_tr_b16 v[62:63], v9 offset:4608
s_add_u32 m0, s55, 8192
s_add_u32 s38, s43, 640
buffer_load_dwordx4 v1, s[12:15], s38 offen lds
buffer_load_dwordx4 v2, s[12:15], s38 offen offset:1024 lds
s_add_u32 m0, s55, 10240
s_add_u32 s38, s43, 17024
buffer_load_dwordx4 v1, s[12:15], s38 offen lds
buffer_load_dwordx4 v2, s[12:15], s38 offen offset:1024 lds
v_mfma_f32_16x16x32_bf16 v[64:67], v[32:35], a[32:35], v[64:67]
ds_read_b64_tr_b16 v[16:17], v6 offset:8192
v_mfma_f32_16x16x32_bf16 v[80:83], v[32:35], a[36:39], v[80:83]
ds_read_b64_tr_b16 v[18:19], v6 offset:8704
v_mfma_f32_16x16x32_bf16 v[68:71], v[36:39], a[32:35], v[68:71]
ds_read_b64_tr_b16 v[20:21], v7 offset:8192
v_mfma_f32_16x16x32_bf16 v[84:87], v[36:39], a[36:39], v[84:87]
ds_read_b64_tr_b16 v[22:23], v7 offset:8704
v_mfma_f32_16x16x32_bf16 v[72:75], v[40:43], a[32:35], v[72:75]
ds_read_b64_tr_b16 v[24:25], v8 offset:8192
v_mfma_f32_16x16x32_bf16 v[88:91], v[40:43], a[36:39], v[88:91]
ds_read_b64_tr_b16 v[26:27], v8 offset:8704
v_mfma_f32_16x16x32_bf16 v[76:79], v[44:47], a[32:35], v[76:79]
ds_read_b64_tr_b16 v[28:29], v9 offset:8192
v_mfma_f32_16x16x32_bf16 v[92:95], v[44:47], a[36:39], v[92:95]
s_waitcnt lgkmcnt(7)
ds_read_b64_tr_b16 v[30:31], v9 offset:8704
s_waitcnt vmcnt(10)
ds_read_b128 a[48:51], v10 offset:0
ds_read_b128 a[52:55], v10 offset:2048
ds_read_b128 a[56:59], v11 offset:0
ds_read_b128 a[60:63], v11 offset:2048
v_mfma_f32_16x16x32_bf16 v[64:67], v[48:51], a[40:43], v[64:67]
ds_read_b64_tr_b16 v[32:33], v6 offset:12288
v_mfma_f32_16x16x32_bf16 v[80:83], v[48:51], a[44:47], v[80:83]
ds_read_b64_tr_b16 v[34:35], v6 offset:12800
v_mfma_f32_16x16x32_bf16 v[68:71], v[52:55], a[40:43], v[68:71]
ds_read_b64_tr_b16 v[36:37], v7 offset:12288
v_mfma_f32_16x16x32_bf16 v[84:87], v[52:55], a[44:47], v[84:87]
s_waitcnt lgkmcnt(3)
ds_read_b64_tr_b16 v[38:39], v7 offset:12800
v_mfma_f32_16x16x32_bf16 v[72:75], v[56:59], a[40:43], v[72:75]
ds_read_b64_tr_b16 v[40:41], v8 offset:12288
v_mfma_f32_16x16x32_bf16 v[88:91], v[56:59], a[44:47], v[88:91]
ds_read_b64_tr_b16 v[42:43], v8 offset:12800
v_mfma_f32_16x16x32_bf16 v[76:79], v[60:63], a[40:43], v[76:79]
ds_read_b64_tr_b16 v[44:45], v9 offset:12288
v_mfma_f32_16x16x32_bf16 v[92:95], v[60:63], a[44:47], v[92:95]
s_waitcnt lgkmcnt(7)
ds_read_b64_tr_b16 v[46:47], v9 offset:12800
s_waitcnt vmcnt(8)
s_barrier
s_cmp_eq_u32 s20, 0
s_cselect_b32 s38, 0, s86
s_cmp_ge_u32 s3, 0
s_cselect_b32 s38, s38, s86
s_cmp_lt_u32 s3, 32
s_cselect_b32 s38, s38, s86
v_mov_b32 v96, 1
s_mov_b64 exec, 1
buffer_atomic_add v96, off, s[8:11], s38 sc1
s_mov_b64 exec, -1
v_add_u32 v6, 0x4000, v6
v_add_u32 v7, 0x4000, v7
v_add_u32 v8, 0x4000, v8
v_add_u32 v9, 0x4000, v9
s_add_u32 m0, s55, 0
s_add_u32 s38, s43, 768
buffer_load_dwordx4 v1, s[12:15], s38 offen lds
buffer_load_dwordx4 v2, s[12:15], s38 offen offset:1024 lds
s_add_u32 m0, s55, 2048
s_add_u32 s38, s43, 17152
buffer_load_dwordx4 v1, s[12:15], s38 offen lds
buffer_load_dwordx4 v2, s[12:15], s38 offen offset:1024 lds
v_mfma_f32_16x16x32_bf16 v[64:67], v[16:19], a[48:51], v[64:67]
ds_read_b64_tr_b16 v[48:49], v6 offset:0
v_mfma_f32_16x16x32_bf16 v[80:83], v[16:19], a[52:55], v[80:83]
ds_read_b64_tr_b16 v[50:51], v6 offset:512
v_mfma_f32_16x16x32_bf16 v[68:71], v[20:23], a[48:51], v[68:71]
ds_read_b64_tr_b16 v[52:53], v7 offset:0
s_add_u32 m0, s53, 0xc000
s_add_u32 s38, s85, 0x300000
buffer_load_dwordx4 v3, s[16:19], s38 offen lds
buffer_load_dwordx4 v4, s[16:19], s38 offen offset:1024 lds
v_mfma_f32_16x16x32_bf16 v[84:87], v[20:23], a[52:55], v[84:87]
ds_read_b64_tr_b16 v[54:55], v7 offset:512
v_mfma_f32_16x16x32_bf16 v[72:75], v[24:27], a[48:51], v[72:75]
ds_read_b64_tr_b16 v[56:57], v8 offset:0
v_mfma_f32_16x16x32_bf16 v[88:91], v[24:27], a[52:55], v[88:91]
ds_read_b64_tr_b16 v[58:59], v8 offset:512
v_mfma_f32_16x16x32_bf16 v[76:79], v[28:31], a[48:51], v[76:79]
ds_read_b64_tr_b16 v[60:61], v9 offset:0
v_mfma_f32_16x16x32_bf16 v[92:95], v[28:31], a[52:55], v[92:95]
s_waitcnt lgkmcnt(7)
ds_read_b64_tr_b16 v[62:63], v9 offset:512
s_waitcnt vmcnt(11)
ds_read_b128 a[64:67], v10 offset:4096
ds_read_b128 a[68:71], v10 offset:6144
ds_read_b128 a[72:75], v11 offset:4096
ds_read_b128 a[76:79], v11 offset:6144
v_mfma_f32_16x16x32_bf16 v[64:67], v[32:35], a[56:59], v[64:67]
ds_read_b64_tr_b16 v[16:17], v6 offset:4096
v_mfma_f32_16x16x32_bf16 v[80:83], v[32:35], a[60:63], v[80:83]
ds_read_b64_tr_b16 v[18:19], v6 offset:4608
v_mfma_f32_16x16x32_bf16 v[68:71], v[36:39], a[56:59], v[68:71]
ds_read_b64_tr_b16 v[20:21], v7 offset:4096
s_add_u32 m0, s53, 0x0
s_add_u32 s38, s85, 0x80
buffer_load_dwordx4 v3, s[16:19], s38 offen lds
buffer_load_dwordx4 v4, s[16:19], s38 offen offset:1024 lds
v_mfma_f32_16x16x32_bf16 v[84:87], v[36:39], a[60:63], v[84:87]
s_waitcnt lgkmcnt(3)
ds_read_b64_tr_b16 v[22:23], v7 offset:4608
v_mfma_f32_16x16x32_bf16 v[72:75], v[40:43], a[56:59], v[72:75]
ds_read_b64_tr_b16 v[24:25], v8 offset:4096
v_mfma_f32_16x16x32_bf16 v[88:91], v[40:43], a[60:63], v[88:91]
ds_read_b64_tr_b16 v[26:27], v8 offset:4608
v_mfma_f32_16x16x32_bf16 v[76:79], v[44:47], a[56:59], v[76:79]
ds_read_b64_tr_b16 v[28:29], v9 offset:4096
v_mfma_f32_16x16x32_bf16 v[92:95], v[44:47], a[60:63], v[92:95]
s_waitcnt lgkmcnt(7)
ds_read_b64_tr_b16 v[30:31], v9 offset:4608
s_add_u32 m0, s55, 4096
s_add_u32 s38, s43, 896
buffer_load_dwordx4 v1, s[12:15], s38 offen lds
buffer_load_dwordx4 v2, s[12:15], s38 offen offset:1024 lds
s_add_u32 m0, s55, 6144
s_add_u32 s38, s43, 17280
buffer_load_dwordx4 v1, s[12:15], s38 offen lds
buffer_load_dwordx4 v2, s[12:15], s38 offen offset:1024 lds
v_mfma_f32_16x16x32_bf16 v[64:67], v[48:51], a[64:67], v[64:67]
ds_read_b64_tr_b16 v[32:33], v6 offset:8192
v_mfma_f32_16x16x32_bf16 v[80:83], v[48:51], a[68:71], v[80:83]
ds_read_b64_tr_b16 v[34:35], v6 offset:8704
v_mfma_f32_16x16x32_bf16 v[68:71], v[52:55], a[64:67], v[68:71]
ds_read_b64_tr_b16 v[36:37], v7 offset:8192
v_mfma_f32_16x16x32_bf16 v[84:87], v[52:55], a[68:71], v[84:87]
ds_read_b64_tr_b16 v[38:39], v7 offset:8704
v_mfma_f32_16x16x32_bf16 v[72:75], v[56:59], a[64:67], v[72:75]
ds_read_b64_tr_b16 v[40:41], v8 offset:8192
v_mfma_f32_16x16x32_bf16 v[88:91], v[56:59], a[68:71], v[88:91]
ds_read_b64_tr_b16 v[42:43], v8 offset:8704
v_mfma_f32_16x16x32_bf16 v[76:79], v[60:63], a[64:67], v[76:79]
ds_read_b64_tr_b16 v[44:45], v9 offset:8192
v_mfma_f32_16x16x32_bf16 v[92:95], v[60:63], a[68:71], v[92:95]
s_waitcnt lgkmcnt(7)
ds_read_b64_tr_b16 v[46:47], v9 offset:8704
s_waitcnt vmcnt(13)
ds_read_b128 a[80:83], v10 offset:8192
ds_read_b128 a[84:87], v10 offset:10240
ds_read_b128 a[88:91], v11 offset:8192
ds_read_b128 a[92:95], v11 offset:10240
v_mfma_f32_16x16x32_bf16 v[64:67], v[16:19], a[72:75], v[64:67]
ds_read_b64_tr_b16 v[48:49], v6 offset:12288
v_mfma_f32_16x16x32_bf16 v[80:83], v[16:19], a[76:79], v[80:83]
ds_read_b64_tr_b16 v[50:51], v6 offset:12800
v_mfma_f32_16x16x32_bf16 v[68:71], v[20:23], a[72:75], v[68:71]
ds_read_b64_tr_b16 v[52:53], v7 offset:12288
v_mfma_f32_16x16x32_bf16 v[84:87], v[20:23], a[76:79], v[84:87]
s_waitcnt lgkmcnt(3)
ds_read_b64_tr_b16 v[54:55], v7 offset:12800
v_mfma_f32_16x16x32_bf16 v[72:75], v[24:27], a[72:75], v[72:75]
ds_read_b64_tr_b16 v[56:57], v8 offset:12288
v_mfma_f32_16x16x32_bf16 v[88:91], v[24:27], a[76:79], v[88:91]
ds_read_b64_tr_b16 v[58:59], v8 offset:12800
v_mfma_f32_16x16x32_bf16 v[76:79], v[28:31], a[72:75], v[76:79]
ds_read_b64_tr_b16 v[60:61], v9 offset:12288
v_mfma_f32_16x16x32_bf16 v[92:95], v[28:31], a[76:79], v[92:95]
s_waitcnt lgkmcnt(7)
ds_read_b64_tr_b16 v[62:63], v9 offset:12800
s_waitcnt vmcnt(6)
s_barrier
s_lshl_b32 s38, s29, 10
buffer_load_dwordx4 v[12:15], v5, s[88:91], s38 offen
v_add_u32 v6, 0x4000, v6
v_add_u32 v7, 0x4000, v7
v_add_u32 v8, 0x4000, v8
v_add_u32 v9, 0x4000, v9
v_mfma_f32_16x16x32_bf16 v[64:67], v[32:35], a[80:83], v[64:67]
ds_read_b64_tr_b16 v[16:17], v6 offset:0
v_mfma_f32_16x16x32_bf16 v[80:83], v[32:35], a[84:87], v[80:83]
ds_read_b64_tr_b16 v[18:19], v6 offset:512
v_mfma_f32_16x16x32_bf16 v[68:71], v[36:39], a[80:83], v[68:71]
ds_read_b64_tr_b16 v[20:21], v7 offset:0
s_add_u32 m0, s53, 0x4000
s_add_u32 s38, s85, 0x100080
buffer_load_dwordx4 v3, s[16:19], s38 offen lds
buffer_load_dwordx4 v4, s[16:19], s38 offen offset:1024 lds
v_mfma_f32_16x16x32_bf16 v[84:87], v[36:39], a[84:87], v[84:87]
ds_read_b64_tr_b16 v[22:23], v7 offset:512
v_mfma_f32_16x16x32_bf16 v[72:75], v[40:43], a[80:83], v[72:75]
ds_read_b64_tr_b16 v[24:25], v8 offset:0
v_mfma_f32_16x16x32_bf16 v[88:91], v[40:43], a[84:87], v[88:91]
ds_read_b64_tr_b16 v[26:27], v8 offset:512
v_mfma_f32_16x16x32_bf16 v[76:79], v[44:47], a[80:83], v[76:79]
ds_read_b64_tr_b16 v[28:29], v9 offset:0
v_mfma_f32_16x16x32_bf16 v[92:95], v[44:47], a[84:87], v[92:95]
s_waitcnt lgkmcnt(7)
ds_read_b64_tr_b16 v[30:31], v9 offset:512
ds_read_b128 a[96:99], v10 offset:0
ds_read_b128 a[100:103], v10 offset:2048
ds_read_b128 a[104:107], v11 offset:0
ds_read_b128 a[108:111], v11 offset:2048
v_mfma_f32_16x16x32_bf16 v[64:67], v[48:51], a[88:91], v[64:67]
ds_read_b64_tr_b16 v[32:33], v6 offset:4096
v_mfma_f32_16x16x32_bf16 v[80:83], v[48:51], a[92:95], v[80:83]
ds_read_b64_tr_b16 v[34:35], v6 offset:4608
v_mfma_f32_16x16x32_bf16 v[68:71], v[52:55], a[88:91], v[68:71]
ds_read_b64_tr_b16 v[36:37], v7 offset:4096
v_mfma_f32_16x16x32_bf16 v[84:87], v[52:55], a[92:95], v[84:87]
s_waitcnt lgkmcnt(3)
ds_read_b64_tr_b16 v[38:39], v7 offset:4608
v_mfma_f32_16x16x32_bf16 v[72:75], v[56:59], a[88:91], v[72:75]
ds_read_b64_tr_b16 v[40:41], v8 offset:4096
v_mfma_f32_16x16x32_bf16 v[88:91], v[56:59], a[92:95], v[88:91]
ds_read_b64_tr_b16 v[42:43], v8 offset:4608
v_mfma_f32_16x16x32_bf16 v[76:79], v[60:63], a[88:91], v[76:79]
ds_read_b64_tr_b16 v[44:45], v9 offset:4096
v_mfma_f32_16x16x32_bf16 v[92:95], v[60:63], a[92:95], v[92:95]
s_waitcnt lgkmcnt(7)
ds_read_b64_tr_b16 v[46:47], v9 offset:4608
v_mfma_f32_16x16x32_bf16 v[64:67], v[16:19], a[96:99], v[64:67]
ds_read_b64_tr_b16 v[48:49], v6 offset:8192
v_mfma_f32_16x16x32_bf16 v[80:83], v[16:19], a[100:103], v[80:83]
ds_read_b64_tr_b16 v[50:51], v6 offset:8704
v_mfma_f32_16x16x32_bf16 v[68:71], v[20:23], a[96:99], v[68:71]
ds_read_b64_tr_b16 v[52:53], v7 offset:8192
v_mfma_f32_16x16x32_bf16 v[84:87], v[20:23], a[100:103], v[84:87]
ds_read_b64_tr_b16 v[54:55], v7 offset:8704
v_mfma_f32_16x16x32_bf16 v[72:75], v[24:27], a[96:99], v[72:75]
ds_read_b64_tr_b16 v[56:57], v8 offset:8192
v_mfma_f32_16x16x32_bf16 v[88:91], v[24:27], a[100:103], v[88:91]
ds_read_b64_tr_b16 v[58:59], v8 offset:8704
v_mfma_f32_16x16x32_bf16 v[76:79], v[28:31], a[96:99], v[76:79]
ds_read_b64_tr_b16 v[60:61], v9 offset:8192
v_mfma_f32_16x16x32_bf16 v[92:95], v[28:31], a[100:103], v[92:95]
s_waitcnt lgkmcnt(7)
ds_read_b64_tr_b16 v[62:63], v9 offset:8704
s_waitcnt vmcnt(3)
ds_read_b128 a[112:115], v10 offset:4096
ds_read_b128 a[116:119], v10 offset:6144
ds_read_b128 a[120:123], v11 offset:4096
ds_read_b128 a[124:127], v11 offset:6144
v_mfma_f32_16x16x32_bf16 v[64:67], v[32:35], a[104:107], v[64:67]
ds_read_b64_tr_b16 v[16:17], v6 offset:12288
v_mfma_f32_16x16x32_bf16 v[80:83], v[32:35], a[108:111], v[80:83]
ds_read_b64_tr_b16 v[18:19], v6 offset:12800
v_mfma_f32_16x16x32_bf16 v[68:71], v[36:39], a[104:107], v[68:71]
ds_read_b64_tr_b16 v[20:21], v7 offset:12288
v_mfma_f32_16x16x32_bf16 v[84:87], v[36:39], a[108:111], v[84:87]
s_waitcnt lgkmcnt(3)
ds_read_b64_tr_b16 v[22:23], v7 offset:12800
v_mfma_f32_16x16x32_bf16 v[72:75], v[40:43], a[104:107], v[72:75]
ds_read_b64_tr_b16 v[24:25], v8 offset:12288
v_mfma_f32_16x16x32_bf16 v[88:91], v[40:43], a[108:111], v[88:91]
ds_read_b64_tr_b16 v[26:27], v8 offset:12800
v_mfma_f32_16x16x32_bf16 v[76:79], v[44:47], a[104:107], v[76:79]
ds_read_b64_tr_b16 v[28:29], v9 offset:12288
v_mfma_f32_16x16x32_bf16 v[92:95], v[44:47], a[108:111], v[92:95]
s_waitcnt lgkmcnt(7)
ds_read_b64_tr_b16 v[30:31], v9 offset:12800
s_barrier
v_add_u32 v6, 0xffff4000, v6
v_add_u32 v7, 0xffff4000, v7
v_add_u32 v8, 0xffff4000, v8
v_add_u32 v9, 0xffff4000, v9
v_mfma_f32_16x16x32_bf16 v[64:67], v[48:51], a[112:115], v[64:67]
ds_read_b64_tr_b16 v[32:33], v6 offset:0
v_mfma_f32_16x16x32_bf16 v[80:83], v[48:51], a[116:119], v[80:83]
ds_read_b64_tr_b16 v[34:35], v6 offset:512
v_mfma_f32_16x16x32_bf16 v[68:71], v[52:55], a[112:115], v[68:71]
ds_read_b64_tr_b16 v[36:37], v7 offset:0
s_add_u32 m0, s53, 0x8000
s_add_u32 s38, s85, 0x200080
buffer_load_dwordx4 v3, s[16:19], s38 offen lds
buffer_load_dwordx4 v4, s[16:19], s38 offen offset:1024 lds
v_mfma_f32_16x16x32_bf16 v[84:87], v[52:55], a[116:119], v[84:87]
ds_read_b64_tr_b16 v[38:39], v7 offset:512
v_mfma_f32_16x16x32_bf16 v[72:75], v[56:59], a[112:115], v[72:75]
ds_read_b64_tr_b16 v[40:41], v8 offset:0
v_mfma_f32_16x16x32_bf16 v[88:91], v[56:59], a[116:119], v[88:91]
ds_read_b64_tr_b16 v[42:43], v8 offset:512
v_mfma_f32_16x16x32_bf16 v[76:79], v[60:63], a[112:115], v[76:79]
ds_read_b64_tr_b16 v[44:45], v9 offset:0
v_mfma_f32_16x16x32_bf16 v[92:95], v[60:63], a[116:119], v[92:95]
s_waitcnt lgkmcnt(7)
ds_read_b64_tr_b16 v[46:47], v9 offset:512
v_mfma_f32_16x16x32_bf16 v[64:67], v[16:19], a[120:123], v[64:67]
ds_read_b64_tr_b16 v[48:49], v6 offset:4096
v_mfma_f32_16x16x32_bf16 v[80:83], v[16:19], a[124:127], v[80:83]
ds_read_b64_tr_b16 v[50:51], v6 offset:4608
v_mfma_f32_16x16x32_bf16 v[68:71], v[20:23], a[120:123], v[68:71]
ds_read_b64_tr_b16 v[52:53], v7 offset:4096
s_add_u32 m0, s53, 0x10000
s_add_u32 s38, s85, 0x300080
buffer_load_dwordx4 v3, s[16:19], s38 offen lds
buffer_load_dwordx4 v4, s[16:19], s38 offen offset:1024 lds
v_mfma_f32_16x16x32_bf16 v[84:87], v[20:23], a[124:127], v[84:87]
ds_read_b64_tr_b16 v[54:55], v7 offset:4608
v_mfma_f32_16x16x32_bf16 v[72:75], v[24:27], a[120:123], v[72:75]
ds_read_b64_tr_b16 v[56:57], v8 offset:4096
v_mfma_f32_16x16x32_bf16 v[88:91], v[24:27], a[124:127], v[88:91]
ds_read_b64_tr_b16 v[58:59], v8 offset:4608
v_mfma_f32_16x16x32_bf16 v[76:79], v[28:31], a[120:123], v[76:79]
ds_read_b64_tr_b16 v[60:61], v9 offset:4096
v_mfma_f32_16x16x32_bf16 v[92:95], v[28:31], a[124:127], v[92:95]
s_waitcnt lgkmcnt(7)
ds_read_b64_tr_b16 v[62:63], v9 offset:4608
v_mfma_f32_16x16x32_bf16 v[96:99], v[32:35], a[0:3], 0
ds_read_b64_tr_b16 v[16:17], v6 offset:8192
v_mfma_f32_16x16x32_bf16 v[112:115], v[32:35], a[4:7], 0
ds_read_b64_tr_b16 v[18:19], v6 offset:8704
v_cvt_pk_bf16_f32 v64, v64, v65
v_mfma_f32_16x16x32_bf16 v[100:103], v[36:39], a[0:3], 0
ds_read_b64_tr_b16 v[20:21], v7 offset:8192
v_cvt_pk_bf16_f32 v65, v66, v67
v_mfma_f32_16x16x32_bf16 v[116:119], v[36:39], a[4:7], 0
ds_read_b64_tr_b16 v[22:23], v7 offset:8704
v_cvt_pk_bf16_f32 v66, v68, v69
v_mfma_f32_16x16x32_bf16 v[104:107], v[40:43], a[0:3], 0
ds_read_b64_tr_b16 v[24:25], v8 offset:8192
v_cvt_pk_bf16_f32 v67, v70, v71
v_mfma_f32_16x16x32_bf16 v[120:123], v[40:43], a[4:7], 0
ds_read_b64_tr_b16 v[26:27], v8 offset:8704
s_add_u32 s38, s54, 0x2000000
buffer_store_dwordx4 v[64:67], v5, s[4:7], s38 offen sc1
v_mfma_f32_16x16x32_bf16 v[108:111], v[44:47], a[0:3], 0
ds_read_b64_tr_b16 v[28:29], v9 offset:8192
v_mfma_f32_16x16x32_bf16 v[124:127], v[44:47], a[4:7], 0
s_waitcnt lgkmcnt(7)
ds_read_b64_tr_b16 v[30:31], v9 offset:8704
s_waitcnt vmcnt(7)
v_mfma_f32_16x16x32_bf16 v[96:99], v[48:51], a[8:11], v[96:99]
ds_read_b64_tr_b16 v[32:33], v6 offset:12288
v_lshlrev_b32 v64, 16, v12
v_and_b32 v65, 0xffff0000, v12
v_mfma_f32_16x16x32_bf16 v[112:115], v[48:51], a[12:15], v[112:115]
ds_read_b64_tr_b16 v[34:35], v6 offset:12800
v_lshlrev_b32 v66, 16, v13
v_and_b32 v67, 0xffff0000, v13
v_mfma_f32_16x16x32_bf16 v[100:103], v[52:55], a[8:11], v[100:103]
ds_read_b64_tr_b16 v[36:37], v7 offset:12288
v_lshlrev_b32 v68, 16, v14
v_and_b32 v69, 0xffff0000, v14
v_mfma_f32_16x16x32_bf16 v[116:119], v[52:55], a[12:15], v[116:119]
ds_read_b64_tr_b16 v[38:39], v7 offset:12800
v_lshlrev_b32 v70, 16, v15
v_and_b32 v71, 0xffff0000, v15
v_mfma_f32_16x16x32_bf16 v[104:107], v[56:59], a[8:11], v[104:107]
ds_read_b64_tr_b16 v[40:41], v8 offset:12288
v_add_f32 v10, v64, v65
v_add_f32 v11, v66, v67
v_mfma_f32_16x16x32_bf16 v[120:123], v[56:59], a[12:15], v[120:123]
ds_read_b64_tr_b16 v[42:43], v8 offset:12800
v_add_f32 v10, v10, v11
v_add_f32 v11, v68, v69
v_mfma_f32_16x16x32_bf16 v[108:111], v[60:63], a[8:11], v[108:111]
ds_read_b64_tr_b16 v[44:45], v9 offset:12288
v_add_f32 v10, v10, v11
v_add_f32 v11, v70, v71
v_mfma_f32_16x16x32_bf16 v[124:127], v[60:63], a[12:15], v[124:127]
s_waitcnt lgkmcnt(7)
ds_read_b64_tr_b16 v[46:47], v9 offset:12800
v_add_f32 v10, v10, v11
s_nop 1
s_waitcnt vmcnt(5)
s_barrier
s_mov_b32 s35, 0
s_cmp_eq_u32 s20, 0
s_cselect_b32 s38, s35, s86
buffer_load_dword v2, off, s[8:11], s38 sc1
v_add_u32 v6, 0x4000, v6
v_add_u32 v7, 0x4000, v7
v_add_u32 v8, 0x4000, v8
v_add_u32 v9, 0x4000, v9
v_mfma_f32_16x16x32_bf16 v[96:99], v[16:19], a[16:19], v[96:99]
ds_read_b64_tr_b16 v[48:49], v6 offset:0
v_add_f32_dpp v10, v10, v10 row_ror:8 row_mask:0xf bank_mask:0xf
s_nop 1
v_mfma_f32_16x16x32_bf16 v[112:115], v[16:19], a[20:23], v[112:115]
ds_read_b64_tr_b16 v[50:51], v6 offset:512
v_add_f32_dpp v10, v10, v10 row_ror:4 row_mask:0xf bank_mask:0xf
s_nop 1
v_mfma_f32_16x16x32_bf16 v[100:103], v[20:23], a[16:19], v[100:103]
ds_read_b64_tr_b16 v[52:53], v7 offset:0
s_add_u32 m0, s53, 0x14000
s_add_u32 s38, s85, 0x0
buffer_load_dwordx4 v3, s[56:59], s38 offen lds
buffer_load_dwordx4 v4, s[56:59], s38 offen offset:1024 lds
v_add_f32_dpp v10, v10, v10 row_ror:2 row_mask:0xf bank_mask:0xf
s_nop 1
v_mfma_f32_16x16x32_bf16 v[116:119], v[20:23], a[20:23], v[116:119]
ds_read_b64_tr_b16 v[54:55], v7 offset:512
v_add_f32_dpp v10, v10, v10 row_ror:1 row_mask:0xf bank_mask:0xf
v_mov_b32 v11, v10
v_mfma_f32_16x16x32_bf16 v[104:107], v[24:27], a[16:19], v[104:107]
ds_read_b64_tr_b16 v[56:57], v8 offset:0
s_nop 1
v_permlane16_swap_b32 v10, v11
v_mfma_f32_16x16x32_bf16 v[120:123], v[24:27], a[20:23], v[120:123]
ds_read_b64_tr_b16 v[58:59], v8 offset:512
v_add_f32 v10, v10, v11
v_mov_b32 v11, v10
v_mfma_f32_16x16x32_bf16 v[108:111], v[28:31], a[16:19], v[108:111]
ds_read_b64_tr_b16 v[60:61], v9 offset:0
s_nop 1
v_permlane32_swap_b32 v10, v11
v_mfma_f32_16x16x32_bf16 v[124:127], v[28:31], a[20:23], v[124:127]
s_waitcnt lgkmcnt(7)
ds_read_b64_tr_b16 v[62:63], v9 offset:512
v_add_f32 v10, v10, v11
v_mul_f32 v10, 0x3b000000, v10
v_mfma_f32_16x16x32_bf16 v[96:99], v[32:35], a[24:27], v[96:99]
ds_read_b64_tr_b16 v[16:17], v6 offset:4096
v_sub_f32 v64, v64, v10
v_mfma_f32_16x16x32_bf16 v[112:115], v[32:35], a[28:31], v[112:115]
ds_read_b64_tr_b16 v[18:19], v6 offset:4608
v_cvt_pk_bf16_f32 v72, v72, v73
v_sub_f32 v65, v65, v10
v_mfma_f32_16x16x32_bf16 v[100:103], v[36:39], a[24:27], v[100:103]
ds_read_b64_tr_b16 v[20:21], v7 offset:4096
v_cvt_pk_bf16_f32 v73, v74, v75
s_add_u32 m0, s53, 0x18000
s_add_u32 s38, s85, 0x100000
buffer_load_dwordx4 v3, s[56:59], s38 offen lds
buffer_load_dwordx4 v4, s[56:59], s38 offen offset:1024 lds
v_sub_f32 v66, v66, v10
v_mfma_f32_16x16x32_bf16 v[116:119], v[36:39], a[28:31], v[116:119]
ds_read_b64_tr_b16 v[22:23], v7 offset:4608
v_cvt_pk_bf16_f32 v74, v76, v77
v_sub_f32 v67, v67, v10
v_mfma_f32_16x16x32_bf16 v[104:107], v[40:43], a[24:27], v[104:107]
ds_read_b64_tr_b16 v[24:25], v8 offset:4096
v_cvt_pk_bf16_f32 v75, v78, v79
v_sub_f32 v68, v68, v10
v_mfma_f32_16x16x32_bf16 v[120:123], v[40:43], a[28:31], v[120:123]
ds_read_b64_tr_b16 v[26:27], v8 offset:4608
s_add_u32 s38, s54, 0x2000400
buffer_store_dwordx4 v[72:75], v5, s[4:7], s38 offen sc1
v_sub_f32 v69, v69, v10
v_mfma_f32_16x16x32_bf16 v[108:111], v[44:47], a[24:27], v[108:111]
ds_read_b64_tr_b16 v[28:29], v9 offset:4096
v_sub_f32 v70, v70, v10
v_mfma_f32_16x16x32_bf16 v[124:127], v[44:47], a[28:31], v[124:127]
s_waitcnt lgkmcnt(7)
ds_read_b64_tr_b16 v[30:31], v9 offset:4608
v_sub_f32 v71, v71, v10
v_mfma_f32_16x16x32_bf16 v[96:99], v[48:51], a[32:35], v[96:99]
ds_read_b64_tr_b16 v[32:33], v6 offset:8192
v_mul_f32 v11, v64, v64
v_mfma_f32_16x16x32_bf16 v[112:115], v[48:51], a[36:39], v[112:115]
ds_read_b64_tr_b16 v[34:35], v6 offset:8704
v_cvt_pk_bf16_f32 v80, v80, v81
v_fmac_f32 v11, v65, v65
v_mfma_f32_16x16x32_bf16 v[100:103], v[52:55], a[32:35], v[100:103]
ds_read_b64_tr_b16 v[36:37], v7 offset:8192
v_cvt_pk_bf16_f32 v81, v82, v83
v_fmac_f32 v11, v66, v66
v_mfma_f32_16x16x32_bf16 v[116:119], v[52:55], a[36:39], v[116:119]
ds_read_b64_tr_b16 v[38:39], v7 offset:8704
v_cvt_pk_bf16_f32 v82, v84, v85
v_fmac_f32 v11, v67, v67
v_mfma_f32_16x16x32_bf16 v[104:107], v[56:59], a[32:35], v[104:107]
ds_read_b64_tr_b16 v[40:41], v8 offset:8192
v_cvt_pk_bf16_f32 v83, v86, v87
v_fmac_f32 v11, v68, v68
v_mfma_f32_16x16x32_bf16 v[120:123], v[56:59], a[36:39], v[120:123]
ds_read_b64_tr_b16 v[42:43], v8 offset:8704
s_add_u32 s38, s54, 0x2001000
buffer_store_dwordx4 v[80:83], v5, s[4:7], s38 offen sc1
v_fmac_f32 v11, v69, v69
v_mfma_f32_16x16x32_bf16 v[108:111], v[60:63], a[32:35], v[108:111]
ds_read_b64_tr_b16 v[44:45], v9 offset:8192
v_fmac_f32 v11, v70, v70
v_mfma_f32_16x16x32_bf16 v[124:127], v[60:63], a[36:39], v[124:127]
s_waitcnt lgkmcnt(7)
ds_read_b64_tr_b16 v[46:47], v9 offset:8704
v_fmac_f32 v11, v71, v71
v_mfma_f32_16x16x32_bf16 v[96:99], v[16:19], a[40:43], v[96:99]
ds_read_b64_tr_b16 v[48:49], v6 offset:12288
s_nop 1
v_add_f32_dpp v11, v11, v11 row_ror:8 row_mask:0xf bank_mask:0xf
v_mfma_f32_16x16x32_bf16 v[112:115], v[16:19], a[44:47], v[112:115]
ds_read_b64_tr_b16 v[50:51], v6 offset:12800
s_nop 1
v_add_f32_dpp v11, v11, v11 row_ror:4 row_mask:0xf bank_mask:0xf
v_mfma_f32_16x16x32_bf16 v[100:103], v[20:23], a[40:43], v[100:103]
ds_read_b64_tr_b16 v[52:53], v7 offset:12288
s_nop 1
v_add_f32_dpp v11, v11, v11 row_ror:2 row_mask:0xf bank_mask:0xf
v_mfma_f32_16x16x32_bf16 v[116:119], v[20:23], a[44:47], v[116:119]
ds_read_b64_tr_b16 v[54:55], v7 offset:12800
s_nop 1
v_add_f32_dpp v11, v11, v11 row_ror:1 row_mask:0xf bank_mask:0xf
v_mfma_f32_16x16x32_bf16 v[104:107], v[24:27], a[40:43], v[104:107]
ds_read_b64_tr_b16 v[56:57], v8 offset:12288
v_mov_b32 v10, v11
s_nop 1
v_mfma_f32_16x16x32_bf16 v[120:123], v[24:27], a[44:47], v[120:123]
ds_read_b64_tr_b16 v[58:59], v8 offset:12800
v_permlane16_swap_b32 v11, v10
v_add_f32 v11, v11, v10
v_mfma_f32_16x16x32_bf16 v[108:111], v[28:31], a[40:43], v[108:111]
ds_read_b64_tr_b16 v[60:61], v9 offset:12288
v_mov_b32 v10, v11
s_nop 1
v_mfma_f32_16x16x32_bf16 v[124:127], v[28:31], a[44:47], v[124:127]
s_waitcnt lgkmcnt(7)
ds_read_b64_tr_b16 v[62:63], v9 offset:12800
v_permlane32_swap_b32 v11, v10
v_add_f32 v11, v11, v10
s_waitcnt vmcnt(6)
s_cmp_lg_u32 s20, 0
s_cbranch_scc1 L_pok_1005
v_readfirstlane_b32 s38, v2
s_nop 3
s_cmp_ge_u32 s38, 32
s_cbranch_scc1 L_pok_1005
s_mov_b32 s39, 0x40000
L_ploop_1006:
s_sleep 4
buffer_load_dword v2, off, s[8:11], s35 sc1
s_waitcnt vmcnt(0)
v_readfirstlane_b32 s38, v2
s_nop 3
s_cmp_ge_u32 s38, 32
s_cbranch_scc1 L_pok_1005
s_sub_u32 s39, s39, 1
s_cmp_lg_u32 s39, 0
s_cbranch_scc1 L_ploop_1006
L_pok_1005:
s_barrier
v_lshlrev_b32 v1, 5, v0
s_mov_b32 s38, 0x0
buffer_load_dwordx4 v[72:75], v1, s[4:7], s38 offen offset:0 sc1
buffer_load_dwordx4 v[76:79], v1, s[4:7], s38 offen offset:16 sc1
buffer_load_dwordx4 v[80:83], v1, s[4:7], s38 offen offset:2048 sc1
buffer_load_dwordx4 v[84:87], v1, s[4:7], s38 offen offset:2064 sc1
v_add_u32 v6, 0x4000, v6
v_add_u32 v7, 0x4000, v7
v_add_u32 v8, 0x4000, v8
v_add_u32 v9, 0x4000, v9
v_mfma_f32_16x16x32_bf16 v[96:99], v[32:35], a[48:51], v[96:99]
ds_read_b64_tr_b16 v[16:17], v6 offset:0
v_mov_b32 v10, 0x3727c5ac
v_fmac_f32 v10, 0x3b000000, v11
v_mfma_f32_16x16x32_bf16 v[112:115], v[32:35], a[52:55], v[112:115]
ds_read_b64_tr_b16 v[18:19], v6 offset:512
v_rsq_f32 v10, v10
s_nop 0
v_mfma_f32_16x16x32_bf16 v[100:103], v[36:39], a[48:51], v[100:103]
ds_read_b64_tr_b16 v[20:21], v7 offset:0
s_add_u32 m0, s53, 0x1c000
s_add_u32 s38, s85, 0x200000
buffer_load_dwordx4 v3, s[56:59], s38 offen lds
buffer_load_dwordx4 v4, s[56:59], s38 offen offset:1024 lds
v_mul_f32 v10, 0x3e0293ee, v10
v_mul_f32 v64, v64, v10
v_mfma_f32_16x16x32_bf16 v[116:119], v[36:39], a[52:55], v[116:119]
ds_read_b64_tr_b16 v[22:23], v7 offset:512
v_mul_f32 v65, v65, v10
v_mul_f32 v66, v66, v10
v_mfma_f32_16x16x32_bf16 v[104:107], v[40:43], a[48:51], v[104:107]
ds_read_b64_tr_b16 v[24:25], v8 offset:0
v_mul_f32 v67, v67, v10
v_mul_f32 v68, v68, v10
v_mfma_f32_16x16x32_bf16 v[120:123], v[40:43], a[52:55], v[120:123]
ds_read_b64_tr_b16 v[26:27], v8 offset:512
v_mul_f32 v69, v69, v10
v_mul_f32 v70, v70, v10
v_mfma_f32_16x16x32_bf16 v[108:111], v[44:47], a[48:51], v[108:111]
ds_read_b64_tr_b16 v[28:29], v9 offset:0
v_mul_f32 v71, v71, v10
v_mfma_f32_16x16x32_bf16 v[124:127], v[44:47], a[52:55], v[124:127]
s_waitcnt lgkmcnt(7)
ds_read_b64_tr_b16 v[30:31], v9 offset:512
v_mfma_f32_16x16x32_bf16 v[96:99], v[48:51], a[56:59], v[96:99]
ds_read_b64_tr_b16 v[32:33], v6 offset:4096
v_mfma_f32_16x16x32_bf16 v[112:115], v[48:51], a[60:63], v[112:115]
ds_read_b64_tr_b16 v[34:35], v6 offset:4608
v_cvt_pk_bf16_f32 v88, v88, v89
v_mfma_f32_16x16x32_bf16 v[100:103], v[52:55], a[56:59], v[100:103]
ds_read_b64_tr_b16 v[36:37], v7 offset:4096
v_cvt_pk_bf16_f32 v89, v90, v91
s_add_u32 m0, s53, 0x20000
s_add_u32 s38, s85, 0x300000
buffer_load_dwordx4 v3, s[56:59], s38 offen lds
buffer_load_dwordx4 v4, s[56:59], s38 offen offset:1024 lds
v_mfma_f32_16x16x32_bf16 v[116:119], v[52:55], a[60:63], v[116:119]
ds_read_b64_tr_b16 v[38:39], v7 offset:4608
v_cvt_pk_bf16_f32 v90, v92, v93
v_mfma_f32_16x16x32_bf16 v[104:107], v[56:59], a[56:59], v[104:107]
ds_read_b64_tr_b16 v[40:41], v8 offset:4096
v_cvt_pk_bf16_f32 v91, v94, v95
v_mfma_f32_16x16x32_bf16 v[120:123], v[56:59], a[60:63], v[120:123]
ds_read_b64_tr_b16 v[42:43], v8 offset:4608
s_add_u32 s38, s54, 0x2001400
buffer_store_dwordx4 v[88:91], v5, s[4:7], s38 offen sc1
v_mfma_f32_16x16x32_bf16 v[108:111], v[60:63], a[56:59], v[108:111]
ds_read_b64_tr_b16 v[44:45], v9 offset:4096
v_mfma_f32_16x16x32_bf16 v[124:127], v[60:63], a[60:63], v[124:127]
s_waitcnt lgkmcnt(7)
ds_read_b64_tr_b16 v[46:47], v9 offset:4608
v_mfma_f32_16x16x32_bf16 v[96:99], v[16:19], a[64:67], v[96:99]
ds_read_b64_tr_b16 v[48:49], v6 offset:8192
v_mfma_f32_16x16x32_bf16 v[112:115], v[16:19], a[68:71], v[112:115]
ds_read_b64_tr_b16 v[50:51], v6 offset:8704
v_mfma_f32_16x16x32_bf16 v[100:103], v[20:23], a[64:67], v[100:103]
ds_read_b64_tr_b16 v[52:53], v7 offset:8192
v_mfma_f32_16x16x32_bf16 v[116:119], v[20:23], a[68:71], v[116:119]
ds_read_b64_tr_b16 v[54:55], v7 offset:8704
v_mfma_f32_16x16x32_bf16 v[104:107], v[24:27], a[64:67], v[104:107]
ds_read_b64_tr_b16 v[56:57], v8 offset:8192
v_mfma_f32_16x16x32_bf16 v[120:123], v[24:27], a[68:71], v[120:123]
ds_read_b64_tr_b16 v[58:59], v8 offset:8704
v_mfma_f32_16x16x32_bf16 v[108:111], v[28:31], a[64:67], v[108:111]
ds_read_b64_tr_b16 v[60:61], v9 offset:8192
v_mfma_f32_16x16x32_bf16 v[124:127], v[28:31], a[68:71], v[124:127]
s_waitcnt lgkmcnt(7)
ds_read_b64_tr_b16 v[62:63], v9 offset:8704
v_mfma_f32_16x16x32_bf16 v[96:99], v[32:35], a[72:75], v[96:99]
ds_read_b64_tr_b16 v[16:17], v6 offset:12288
v_mfma_f32_16x16x32_bf16 v[112:115], v[32:35], a[76:79], v[112:115]
ds_read_b64_tr_b16 v[18:19], v6 offset:12800
v_mfma_f32_16x16x32_bf16 v[100:103], v[36:39], a[72:75], v[100:103]
ds_read_b64_tr_b16 v[20:21], v7 offset:12288
v_mfma_f32_16x16x32_bf16 v[116:119], v[36:39], a[76:79], v[116:119]
ds_read_b64_tr_b16 v[22:23], v7 offset:12800
v_mfma_f32_16x16x32_bf16 v[104:107], v[40:43], a[72:75], v[104:107]
ds_read_b64_tr_b16 v[24:25], v8 offset:12288
v_mfma_f32_16x16x32_bf16 v[120:123], v[40:43], a[76:79], v[120:123]
ds_read_b64_tr_b16 v[26:27], v8 offset:12800
v_mfma_f32_16x16x32_bf16 v[108:111], v[44:47], a[72:75], v[108:111]
ds_read_b64_tr_b16 v[28:29], v9 offset:12288
v_mfma_f32_16x16x32_bf16 v[124:127], v[44:47], a[76:79], v[124:127]
s_waitcnt lgkmcnt(7)
ds_read_b64_tr_b16 v[30:31], v9 offset:12800
s_barrier
s_load_dwordx2 s[16:17], s[0:1], 16
s_waitcnt lgkmcnt(0)
s_mov_b32 s18, 0x400000
s_mov_b32 s19, 0x20000
v_add_u32 v6, 0x8000, v6
v_add_u32 v7, 0x8000, v7
v_add_u32 v8, 0x8000, v8
v_add_u32 v9, 0x8000, v9
v_mfma_f32_16x16x32_bf16 v[96:99], v[48:51], a[80:83], v[96:99]
ds_read_b64_tr_b16 v[32:33], v6 offset:0
v_mfma_f32_16x16x32_bf16 v[112:115], v[48:51], a[84:87], v[112:115]
ds_read_b64_tr_b16 v[34:35], v6 offset:512
v_mfma_f32_16x16x32_bf16 v[100:103], v[52:55], a[80:83], v[100:103]
ds_read_b64_tr_b16 v[36:37], v7 offset:0
s_add_u32 m0, s53, 0x24000
s_add_u32 s38, s85, 0x80
buffer_load_dwordx4 v3, s[56:59], s38 offen lds
buffer_load_dwordx4 v4, s[56:59], s38 offen offset:1024 lds
v_mfma_f32_16x16x32_bf16 v[116:119], v[52:55], a[84:87], v[116:119]
ds_read_b64_tr_b16 v[38:39], v7 offset:512
v_mfma_f32_16x16x32_bf16 v[104:107], v[56:59], a[80:83], v[104:107]
ds_read_b64_tr_b16 v[40:41], v8 offset:0
v_mfma_f32_16x16x32_bf16 v[120:123], v[56:59], a[84:87], v[120:123]
ds_read_b64_tr_b16 v[42:43], v8 offset:512
v_mfma_f32_16x16x32_bf16 v[108:111], v[60:63], a[80:83], v[108:111]
ds_read_b64_tr_b16 v[44:45], v9 offset:0
v_mfma_f32_16x16x32_bf16 v[124:127], v[60:63], a[84:87], v[124:127]
s_waitcnt lgkmcnt(7)
ds_read_b64_tr_b16 v[46:47], v9 offset:512
v_mfma_f32_16x16x32_bf16 v[96:99], v[16:19], a[88:91], v[96:99]
ds_read_b64_tr_b16 v[48:49], v6 offset:4096
v_mfma_f32_16x16x32_bf16 v[112:115], v[16:19], a[92:95], v[112:115]
ds_read_b64_tr_b16 v[50:51], v6 offset:4608
v_mfma_f32_16x16x32_bf16 v[100:103], v[20:23], a[88:91], v[100:103]
ds_read_b64_tr_b16 v[52:53], v7 offset:4096
s_add_u32 m0, s53, 0xc000
s_add_u32 s38, s85, 0x100080
buffer_load_dwordx4 v3, s[56:59], s38 offen lds
buffer_load_dwordx4 v4, s[56:59], s38 offen offset:1024 lds
v_mfma_f32_16x16x32_bf16 v[116:119], v[20:23], a[92:95], v[116:119]
ds_read_b64_tr_b16 v[54:55], v7 offset:4608
v_mfma_f32_16x16x32_bf16 v[104:107], v[24:27], a[88:91], v[104:107]
ds_read_b64_tr_b16 v[56:57], v8 offset:4096
v_mfma_f32_16x16x32_bf16 v[120:123], v[24:27], a[92:95], v[120:123]
ds_read_b64_tr_b16 v[58:59], v8 offset:4608
v_mfma_f32_16x16x32_bf16 v[108:111], v[28:31], a[88:91], v[108:111]
ds_read_b64_tr_b16 v[60:61], v9 offset:4096
v_mfma_f32_16x16x32_bf16 v[124:127], v[28:31], a[92:95], v[124:127]
s_waitcnt lgkmcnt(7)
ds_read_b64_tr_b16 v[62:63], v9 offset:4608
s_waitcnt vmcnt(9)
v_mfma_f32_16x16x32_bf16 v[96:99], v[32:35], a[96:99], v[96:99]
ds_read_b64_tr_b16 v[16:17], v6 offset:8192
v_add_f32 v80, 1.0, v80
v_add_f32 v81, 1.0, v81
v_mfma_f32_16x16x32_bf16 v[112:115], v[32:35], a[100:103], v[112:115]
ds_read_b64_tr_b16 v[18:19], v6 offset:8704
v_add_f32 v82, 1.0, v82
v_add_f32 v83, 1.0, v83
v_mfma_f32_16x16x32_bf16 v[100:103], v[36:39], a[96:99], v[100:103]
ds_read_b64_tr_b16 v[20:21], v7 offset:8192
v_add_f32 v84, 1.0, v84
v_add_f32 v85, 1.0, v85
v_mfma_f32_16x16x32_bf16 v[116:119], v[36:39], a[100:103], v[116:119]
ds_read_b64_tr_b16 v[22:23], v7 offset:8704
v_add_f32 v86, 1.0, v86
v_add_f32 v87, 1.0, v87
v_mfma_f32_16x16x32_bf16 v[104:107], v[40:43], a[96:99], v[104:107]
ds_read_b64_tr_b16 v[24:25], v8 offset:8192
v_mul_f32 v72, 0x3e0293ee, v72
v_mul_f32 v73, 0x3e0293ee, v73
v_mfma_f32_16x16x32_bf16 v[120:123], v[40:43], a[100:103], v[120:123]
ds_read_b64_tr_b16 v[26:27], v8 offset:8704
v_mul_f32 v74, 0x3e0293ee, v74
v_mul_f32 v75, 0x3e0293ee, v75
v_mfma_f32_16x16x32_bf16 v[108:111], v[44:47], a[96:99], v[108:111]
ds_read_b64_tr_b16 v[28:29], v9 offset:8192
v_mul_f32 v76, 0x3e0293ee, v76
v_mul_f32 v77, 0x3e0293ee, v77
v_mfma_f32_16x16x32_bf16 v[124:127], v[44:47], a[100:103], v[124:127]
s_waitcnt lgkmcnt(7)
ds_read_b64_tr_b16 v[30:31], v9 offset:8704
v_mul_f32 v78, 0x3e0293ee, v78
v_mul_f32 v79, 0x3e0293ee, v79
v_mfma_f32_16x16x32_bf16 v[96:99], v[48:51], a[104:107], v[96:99]
ds_read_b64_tr_b16 v[32:33], v6 offset:12288
v_fma_f32 v64, v64, v80, v72
v_fma_f32 v65, v65, v81, v73
v_mfma_f32_16x16x32_bf16 v[112:115], v[48:51], a[108:111], v[112:115]
ds_read_b64_tr_b16 v[34:35], v6 offset:12800
v_fma_f32 v66, v66, v82, v74
v_fma_f32 v67, v67, v83, v75
v_mfma_f32_16x16x32_bf16 v[100:103], v[52:55], a[104:107], v[100:103]
ds_read_b64_tr_b16 v[36:37], v7 offset:12288
v_fma_f32 v68, v68, v84, v76
v_fma_f32 v69, v69, v85, v77
v_mfma_f32_16x16x32_bf16 v[116:119], v[52:55], a[108:111], v[116:119]
ds_read_b64_tr_b16 v[38:39], v7 offset:12800
v_fma_f32 v70, v70, v86, v78
v_fma_f32 v71, v71, v87, v79
v_mfma_f32_16x16x32_bf16 v[104:107], v[56:59], a[104:107], v[104:107]
ds_read_b64_tr_b16 v[40:41], v8 offset:12288
v_cvt_pk_bf16_f32 v88, v64, v65
v_cvt_pk_bf16_f32 v89, v66, v67
v_mfma_f32_16x16x32_bf16 v[120:123], v[56:59], a[108:111], v[120:123]
ds_read_b64_tr_b16 v[42:43], v8 offset:12800
v_cvt_pk_bf16_f32 v90, v68, v69
v_cvt_pk_bf16_f32 v91, v70, v71
v_mfma_f32_16x16x32_bf16 v[108:111], v[60:63], a[104:107], v[108:111]
ds_read_b64_tr_b16 v[44:45], v9 offset:12288
v_lshrrev_b32 v1, 2, v0
v_lshlrev_b32 v1, 10, v1
v_mfma_f32_16x16x32_bf16 v[124:127], v[60:63], a[108:111], v[124:127]
s_waitcnt lgkmcnt(7)
ds_read_b64_tr_b16 v[46:47], v9 offset:12800
v_and_b32 v2, 3, v0
v_lshl_add_u32 v1, v2, 8, v1
s_barrier
v_add_u32 v6, 0x4000, v6
v_add_u32 v7, 0x4000, v7
v_add_u32 v8, 0x4000, v8
v_add_u32 v9, 0x4000, v9
v_mfma_f32_16x16x32_bf16 v[96:99], v[16:19], a[112:115], v[96:99]
ds_read_b64_tr_b16 v[48:49], v6 offset:0
v_mfma_f32_16x16x32_bf16 v[112:115], v[16:19], a[116:119], v[112:115]
ds_read_b64_tr_b16 v[50:51], v6 offset:512
v_mfma_f32_16x16x32_bf16 v[100:103], v[20:23], a[112:115], v[100:103]
ds_read_b64_tr_b16 v[52:53], v7 offset:0
s_add_u32 m0, s53, 0x0
s_add_u32 s38, s85, 0x200080
buffer_load_dwordx4 v3, s[56:59], s38 offen lds
buffer_load_dwordx4 v4, s[56:59], s38 offen offset:1024 lds
v_mfma_f32_16x16x32_bf16 v[116:119], v[20:23], a[116:119], v[116:119]
ds_read_b64_tr_b16 v[54:55], v7 offset:512
v_mfma_f32_16x16x32_bf16 v[104:107], v[24:27], a[112:115], v[104:107]
ds_read_b64_tr_b16 v[56:57], v8 offset:0
v_mfma_f32_16x16x32_bf16 v[120:123], v[24:27], a[116:119], v[120:123]
ds_read_b64_tr_b16 v[58:59], v8 offset:512
v_mfma_f32_16x16x32_bf16 v[108:111], v[28:31], a[112:115], v[108:111]
ds_read_b64_tr_b16 v[60:61], v9 offset:0
v_mfma_f32_16x16x32_bf16 v[124:127], v[28:31], a[116:119], v[124:127]
s_waitcnt lgkmcnt(7)
ds_read_b64_tr_b16 v[62:63], v9 offset:512
v_mul_u32_u24 v1, 144, v0
s_lshl_b32 s38, s20, 4
s_add_u32 s38, s38, 32768
v_add_u32 v1, s38, v1
ds_write_b128 v1, v[88:91]
s_waitcnt lgkmcnt(0)
v_mfma_f32_16x16x32_bf16 v[96:99], v[32:35], a[120:123], v[96:99]
ds_read_b64_tr_b16 v[16:17], v6 offset:4096
v_mfma_f32_16x16x32_bf16 v[112:115], v[32:35], a[124:127], v[112:115]
ds_read_b64_tr_b16 v[18:19], v6 offset:4608
v_mfma_f32_16x16x32_bf16 v[100:103], v[36:39], a[120:123], v[100:103]
ds_read_b64_tr_b16 v[20:21], v7 offset:4096
s_add_u32 m0, s53, 0x4000
s_add_u32 s38, s85, 0x300080
buffer_load_dwordx4 v3, s[56:59], s38 offen lds
buffer_load_dwordx4 v4, s[56:59], s38 offen offset:1024 lds
v_mfma_f32_16x16x32_bf16 v[116:119], v[36:39], a[124:127], v[116:119]
ds_read_b64_tr_b16 v[22:23], v7 offset:4608
v_mfma_f32_16x16x32_bf16 v[104:107], v[40:43], a[120:123], v[104:107]
ds_read_b64_tr_b16 v[24:25], v8 offset:4096
v_mfma_f32_16x16x32_bf16 v[120:123], v[40:43], a[124:127], v[120:123]
ds_read_b64_tr_b16 v[26:27], v8 offset:4608
v_mfma_f32_16x16x32_bf16 v[108:111], v[44:47], a[120:123], v[108:111]
ds_read_b64_tr_b16 v[28:29], v9 offset:4096
v_mfma_f32_16x16x32_bf16 v[124:127], v[44:47], a[124:127], v[124:127]
s_waitcnt lgkmcnt(7)
ds_read_b64_tr_b16 v[30:31], v9 offset:4608
v_mfma_f32_16x16x32_bf16 v[64:67], a[0:3], v[48:51], 0
ds_read_b64_tr_b16 v[32:33], v6 offset:8192
v_mfma_f32_16x16x32_bf16 v[80:83], a[4:7], v[48:51], 0
ds_read_b64_tr_b16 v[34:35], v6 offset:8704
v_mfma_f32_16x16x32_bf16 v[68:71], a[0:3], v[52:55], 0
ds_read_b64_tr_b16 v[36:37], v7 offset:8192
v_mfma_f32_16x16x32_bf16 v[84:87], a[4:7], v[52:55], 0
ds_read_b64_tr_b16 v[38:39], v7 offset:8704
v_mfma_f32_16x16x32_bf16 v[72:75], a[0:3], v[56:59], 0
ds_read_b64_tr_b16 v[40:41], v8 offset:8192
v_mfma_f32_16x16x32_bf16 v[88:91], a[4:7], v[56:59], 0
ds_read_b64_tr_b16 v[42:43], v8 offset:8704
v_mfma_f32_16x16x32_bf16 v[76:79], a[0:3], v[60:63], 0
ds_read_b64_tr_b16 v[44:45], v9 offset:8192
v_mfma_f32_16x16x32_bf16 v[92:95], a[4:7], v[60:63], 0
s_waitcnt lgkmcnt(7)
ds_read_b64_tr_b16 v[46:47], v9 offset:8704
v_mfma_f32_16x16x32_bf16 v[64:67], a[8:11], v[16:19], v[64:67]
ds_read_b64_tr_b16 v[48:49], v6 offset:12288
v_mfma_f32_16x16x32_bf16 v[80:83], a[12:15], v[16:19], v[80:83]
ds_read_b64_tr_b16 v[50:51], v6 offset:12800
v_mfma_f32_16x16x32_bf16 v[68:71], a[8:11], v[20:23], v[68:71]
ds_read_b64_tr_b16 v[52:53], v7 offset:12288
v_mfma_f32_16x16x32_bf16 v[84:87], a[12:15], v[20:23], v[84:87]
ds_read_b64_tr_b16 v[54:55], v7 offset:12800
v_mfma_f32_16x16x32_bf16 v[72:75], a[8:11], v[24:27], v[72:75]
ds_read_b64_tr_b16 v[56:57], v8 offset:12288
v_mfma_f32_16x16x32_bf16 v[88:91], a[12:15], v[24:27], v[88:91]
ds_read_b64_tr_b16 v[58:59], v8 offset:12800
v_mfma_f32_16x16x32_bf16 v[76:79], a[8:11], v[28:31], v[76:79]
ds_read_b64_tr_b16 v[60:61], v9 offset:12288
v_mfma_f32_16x16x32_bf16 v[92:95], a[12:15], v[28:31], v[92:95]
s_waitcnt lgkmcnt(7)
ds_read_b64_tr_b16 v[62:63], v9 offset:12800
s_barrier
v_lshrrev_b32 v1, 3, v0
s_lshl_b32 s38, s20, 3
v_add_u32 v1, s38, v1
v_mul_u32_u24 v1, 144, v1
v_and_b32 v2, 7, v0
v_lshl_add_u32 v1, v2, 4, v1
v_add_u32 v1, 32768, v1
ds_read_b128 v[12:15], v1
v_lshrrev_b32 v1, 5, v0
v_lshlrev_b32 v1, 10, v1
v_bfe_u32 v10, v0, 3, 2
v_lshl_add_u32 v1, v10, 8, v1
v_lshl_add_u32 v1, v2, 4, v1
s_lshr_b32 s38, s29, 4
s_lshl_b32 s38, s38, 14
s_and_b32 s39, s29, 8
s_lshl_b32 s39, s39, 4
s_add_u32 s38, s38, s39
s_lshl_b32 s39, s20, 11
s_add_u32 s38, s38, s39
s_add_u32 s38, s38, 0x100000
s_waitcnt lgkmcnt(0)
buffer_store_dwordx4 v[12:15], v1, s[4:7], s38 offen sc1
v_add_u32 v6, 0x4000, v6
v_add_u32 v7, 0x4000, v7
v_add_u32 v8, 0x4000, v8
v_add_u32 v9, 0x4000, v9
v_mfma_f32_16x16x32_bf16 v[64:67], a[16:19], v[32:35], v[64:67]
ds_read_b64_tr_b16 v[16:17], v6 offset:0
v_mfma_f32_16x16x32_bf16 v[80:83], a[20:23], v[32:35], v[80:83]
ds_read_b64_tr_b16 v[18:19], v6 offset:512
v_mfma_f32_16x16x32_bf16 v[68:71], a[16:19], v[36:39], v[68:71]
ds_read_b64_tr_b16 v[20:21], v7 offset:0
v_mfma_f32_16x16x32_bf16 v[84:87], a[20:23], v[36:39], v[84:87]
ds_read_b64_tr_b16 v[22:23], v7 offset:512
v_mfma_f32_16x16x32_bf16 v[72:75], a[16:19], v[40:43], v[72:75]
ds_read_b64_tr_b16 v[24:25], v8 offset:0
v_mfma_f32_16x16x32_bf16 v[88:91], a[20:23], v[40:43], v[88:91]
ds_read_b64_tr_b16 v[26:27], v8 offset:512
v_mfma_f32_16x16x32_bf16 v[76:79], a[16:19], v[44:47], v[76:79]
ds_read_b64_tr_b16 v[28:29], v9 offset:0
v_mfma_f32_16x16x32_bf16 v[92:95], a[20:23], v[44:47], v[92:95]
s_waitcnt lgkmcnt(7)
ds_read_b64_tr_b16 v[30:31], v9 offset:512
v_mfma_f32_16x16x32_bf16 v[64:67], a[24:27], v[48:51], v[64:67]
ds_read_b64_tr_b16 v[32:33], v6 offset:4096
v_mfma_f32_16x16x32_bf16 v[80:83], a[28:31], v[48:51], v[80:83]
ds_read_b64_tr_b16 v[34:35], v6 offset:4608
v_cvt_pk_bf16_f32 v96, v96, v97
v_mfma_f32_16x16x32_bf16 v[68:71], a[24:27], v[52:55], v[68:71]
ds_read_b64_tr_b16 v[36:37], v7 offset:4096
v_cvt_pk_bf16_f32 v97, v98, v99
v_mfma_f32_16x16x32_bf16 v[84:87], a[28:31], v[52:55], v[84:87]
ds_read_b64_tr_b16 v[38:39], v7 offset:4608
v_cvt_pk_bf16_f32 v98, v100, v101
v_mfma_f32_16x16x32_bf16 v[72:75], a[24:27], v[56:59], v[72:75]
ds_read_b64_tr_b16 v[40:41], v8 offset:4096
v_cvt_pk_bf16_f32 v99, v102, v103
v_mfma_f32_16x16x32_bf16 v[88:91], a[28:31], v[56:59], v[88:91]
ds_read_b64_tr_b16 v[42:43], v8 offset:4608
s_add_u32 s38, s54, 0x2000800
buffer_store_dwordx4 v[96:99], v5, s[4:7], s38 offen sc1
v_mfma_f32_16x16x32_bf16 v[76:79], a[24:27], v[60:63], v[76:79]
ds_read_b64_tr_b16 v[44:45], v9 offset:4096
v_mfma_f32_16x16x32_bf16 v[92:95], a[28:31], v[60:63], v[92:95]
s_waitcnt lgkmcnt(7)
ds_read_b64_tr_b16 v[46:47], v9 offset:4608
v_mfma_f32_16x16x32_bf16 v[64:67], a[32:35], v[16:19], v[64:67]
ds_read_b64_tr_b16 v[48:49], v6 offset:8192
v_mfma_f32_16x16x32_bf16 v[80:83], a[36:39], v[16:19], v[80:83]
ds_read_b64_tr_b16 v[50:51], v6 offset:8704
v_mfma_f32_16x16x32_bf16 v[68:71], a[32:35], v[20:23], v[68:71]
ds_read_b64_tr_b16 v[52:53], v7 offset:8192
v_mfma_f32_16x16x32_bf16 v[84:87], a[36:39], v[20:23], v[84:87]
ds_read_b64_tr_b16 v[54:55], v7 offset:8704
v_mfma_f32_16x16x32_bf16 v[72:75], a[32:35], v[24:27], v[72:75]
ds_read_b64_tr_b16 v[56:57], v8 offset:8192
v_mfma_f32_16x16x32_bf16 v[88:91], a[36:39], v[24:27], v[88:91]
ds_read_b64_tr_b16 v[58:59], v8 offset:8704
v_mfma_f32_16x16x32_bf16 v[76:79], a[32:35], v[28:31], v[76:79]
ds_read_b64_tr_b16 v[60:61], v9 offset:8192
v_mfma_f32_16x16x32_bf16 v[92:95], a[36:39], v[28:31], v[92:95]
s_waitcnt lgkmcnt(7)
ds_read_b64_tr_b16 v[62:63], v9 offset:8704
v_mfma_f32_16x16x32_bf16 v[64:67], a[40:43], v[32:35], v[64:67]
ds_read_b64_tr_b16 v[16:17], v6 offset:12288
v_mfma_f32_16x16x32_bf16 v[80:83], a[44:47], v[32:35], v[80:83]
ds_read_b64_tr_b16 v[18:19], v6 offset:12800
v_mfma_f32_16x16x32_bf16 v[68:71], a[40:43], v[36:39], v[68:71]
ds_read_b64_tr_b16 v[20:21], v7 offset:12288
v_mfma_f32_16x16x32_bf16 v[84:87], a[44:47], v[36:39], v[84:87]
ds_read_b64_tr_b16 v[22:23], v7 offset:12800
v_mfma_f32_16x16x32_bf16 v[72:75], a[40:43], v[40:43], v[72:75]
ds_read_b64_tr_b16 v[24:25], v8 offset:12288
v_mfma_f32_16x16x32_bf16 v[88:91], a[44:47], v[40:43], v[88:91]
ds_read_b64_tr_b16 v[26:27], v8 offset:12800
v_mfma_f32_16x16x32_bf16 v[76:79], a[40:43], v[44:47], v[76:79]
ds_read_b64_tr_b16 v[28:29], v9 offset:12288
v_mfma_f32_16x16x32_bf16 v[92:95], a[44:47], v[44:47], v[92:95]
s_waitcnt lgkmcnt(7)
ds_read_b64_tr_b16 v[30:31], v9 offset:12800
s_waitcnt vmcnt(13)
s_barrier
v_add_u32 v6, 0x4000, v6
v_add_u32 v7, 0x4000, v7
v_add_u32 v8, 0x4000, v8
v_add_u32 v9, 0x4000, v9
v_mfma_f32_16x16x32_bf16 v[64:67], a[48:51], v[48:51], v[64:67]
ds_read_b64_tr_b16 v[32:33], v6 offset:0
v_mfma_f32_16x16x32_bf16 v[80:83], a[52:55], v[48:51], v[80:83]
ds_read_b64_tr_b16 v[34:35], v6 offset:512
v_mfma_f32_16x16x32_bf16 v[68:71], a[48:51], v[52:55], v[68:71]
ds_read_b64_tr_b16 v[36:37], v7 offset:0
s_add_u32 m0, s53, 0x8000
s_add_u32 s38, s52, 0x0
buffer_load_dwordx4 v3, s[16:19], s38 offen lds
buffer_load_dwordx4 v4, s[16:19], s38 offen offset:1024 lds
v_mfma_f32_16x16x32_bf16 v[84:87], a[52:55], v[52:55], v[84:87]
ds_read_b64_tr_b16 v[38:39], v7 offset:512
v_mfma_f32_16x16x32_bf16 v[72:75], a[48:51], v[56:59], v[72:75]
ds_read_b64_tr_b16 v[40:41], v8 offset:0
v_mfma_f32_16x16x32_bf16 v[88:91], a[52:55], v[56:59], v[88:91]
ds_read_b64_tr_b16 v[42:43], v8 offset:512
v_mfma_f32_16x16x32_bf16 v[76:79], a[48:51], v[60:63], v[76:79]
ds_read_b64_tr_b16 v[44:45], v9 offset:0
v_mfma_f32_16x16x32_bf16 v[92:95], a[52:55], v[60:63], v[92:95]
s_waitcnt lgkmcnt(7)
ds_read_b64_tr_b16 v[46:47], v9 offset:512
v_mfma_f32_16x16x32_bf16 v[64:67], a[56:59], v[16:19], v[64:67]
ds_read_b64_tr_b16 v[48:49], v6 offset:4096
v_mfma_f32_16x16x32_bf16 v[80:83], a[60:63], v[16:19], v[80:83]
ds_read_b64_tr_b16 v[50:51], v6 offset:4608
v_cvt_pk_bf16_f32 v104, v104, v105
v_mfma_f32_16x16x32_bf16 v[68:71], a[56:59], v[20:23], v[68:71]
ds_read_b64_tr_b16 v[52:53], v7 offset:4096
v_cvt_pk_bf16_f32 v105, v106, v107
v_mfma_f32_16x16x32_bf16 v[84:87], a[60:63], v[20:23], v[84:87]
ds_read_b64_tr_b16 v[54:55], v7 offset:4608
v_cvt_pk_bf16_f32 v106, v108, v109
v_mfma_f32_16x16x32_bf16 v[72:75], a[56:59], v[24:27], v[72:75]
ds_read_b64_tr_b16 v[56:57], v8 offset:4096
v_cvt_pk_bf16_f32 v107, v110, v111
v_mfma_f32_16x16x32_bf16 v[88:91], a[60:63], v[24:27], v[88:91]
ds_read_b64_tr_b16 v[58:59], v8 offset:4608
s_add_u32 s38, s54, 0x2000c00
buffer_store_dwordx4 v[104:107], v5, s[4:7], s38 offen sc1
v_mfma_f32_16x16x32_bf16 v[76:79], a[56:59], v[28:31], v[76:79]
ds_read_b64_tr_b16 v[60:61], v9 offset:4096
v_mfma_f32_16x16x32_bf16 v[92:95], a[60:63], v[28:31], v[92:95]
s_waitcnt lgkmcnt(7)
ds_read_b64_tr_b16 v[62:63], v9 offset:4608
v_mfma_f32_16x16x32_bf16 v[64:67], a[64:67], v[32:35], v[64:67]
ds_read_b64_tr_b16 v[16:17], v6 offset:8192
v_mfma_f32_16x16x32_bf16 v[80:83], a[68:71], v[32:35], v[80:83]
ds_read_b64_tr_b16 v[18:19], v6 offset:8704
v_mfma_f32_16x16x32_bf16 v[68:71], a[64:67], v[36:39], v[68:71]
ds_read_b64_tr_b16 v[20:21], v7 offset:8192
v_mfma_f32_16x16x32_bf16 v[84:87], a[68:71], v[36:39], v[84:87]
ds_read_b64_tr_b16 v[22:23], v7 offset:8704
v_mfma_f32_16x16x32_bf16 v[72:75], a[64:67], v[40:43], v[72:75]
ds_read_b64_tr_b16 v[24:25], v8 offset:8192
v_mfma_f32_16x16x32_bf16 v[88:91], a[68:71], v[40:43], v[88:91]
ds_read_b64_tr_b16 v[26:27], v8 offset:8704
v_mfma_f32_16x16x32_bf16 v[76:79], a[64:67], v[44:47], v[76:79]
ds_read_b64_tr_b16 v[28:29], v9 offset:8192
v_mfma_f32_16x16x32_bf16 v[92:95], a[68:71], v[44:47], v[92:95]
s_waitcnt lgkmcnt(7)
ds_read_b64_tr_b16 v[30:31], v9 offset:8704
v_mfma_f32_16x16x32_bf16 v[64:67], a[72:75], v[48:51], v[64:67]
ds_read_b64_tr_b16 v[32:33], v6 offset:12288
v_mfma_f32_16x16x32_bf16 v[80:83], a[76:79], v[48:51], v[80:83]
ds_read_b64_tr_b16 v[34:35], v6 offset:12800
v_mfma_f32_16x16x32_bf16 v[68:71], a[72:75], v[52:55], v[68:71]
ds_read_b64_tr_b16 v[36:37], v7 offset:12288
v_mfma_f32_16x16x32_bf16 v[84:87], a[76:79], v[52:55], v[84:87]
ds_read_b64_tr_b16 v[38:39], v7 offset:12800
v_mfma_f32_16x16x32_bf16 v[72:75], a[72:75], v[56:59], v[72:75]
ds_read_b64_tr_b16 v[40:41], v8 offset:12288
v_mfma_f32_16x16x32_bf16 v[88:91], a[76:79], v[56:59], v[88:91]
ds_read_b64_tr_b16 v[42:43], v8 offset:12800
v_mfma_f32_16x16x32_bf16 v[76:79], a[72:75], v[60:63], v[76:79]
ds_read_b64_tr_b16 v[44:45], v9 offset:12288
v_mfma_f32_16x16x32_bf16 v[92:95], a[76:79], v[60:63], v[92:95]
s_waitcnt lgkmcnt(7)
ds_read_b64_tr_b16 v[46:47], v9 offset:12800
s_waitcnt vmcnt(4)
s_barrier
s_lshl_b32 s40, s22, 7
s_add_u32 s40, s40, 0x20000
s_cmp_eq_u32 s20, 0
s_cselect_b32 s38, s40, s86
v_mov_b32 v1, 1
s_mov_b64 exec, 1
buffer_atomic_add v1, off, s[4:7], s38 sc1
s_mov_b64 exec, -1
v_add_u32 v6, 0x4000, v6
v_add_u32 v7, 0x4000, v7
v_add_u32 v8, 0x4000, v8
v_add_u32 v9, 0x4000, v9
v_mfma_f32_16x16x32_bf16 v[64:67], a[80:83], v[16:19], v[64:67]
ds_read_b64_tr_b16 v[48:49], v6 offset:0
v_mfma_f32_16x16x32_bf16 v[80:83], a[84:87], v[16:19], v[80:83]
ds_read_b64_tr_b16 v[50:51], v6 offset:512
v_mfma_f32_16x16x32_bf16 v[68:71], a[80:83], v[20:23], v[68:71]
ds_read_b64_tr_b16 v[52:53], v7 offset:0
s_add_u32 m0, s53, 0x10000
s_add_u32 s38, s52, 0x100000
buffer_load_dwordx4 v3, s[16:19], s38 offen lds
buffer_load_dwordx4 v4, s[16:19], s38 offen offset:1024 lds
v_mfma_f32_16x16x32_bf16 v[84:87], a[84:87], v[20:23], v[84:87]
ds_read_b64_tr_b16 v[54:55], v7 offset:512
v_mfma_f32_16x16x32_bf16 v[72:75], a[80:83], v[24:27], v[72:75]
ds_read_b64_tr_b16 v[56:57], v8 offset:0
v_mfma_f32_16x16x32_bf16 v[88:91], a[84:87], v[24:27], v[88:91]
ds_read_b64_tr_b16 v[58:59], v8 offset:512
v_mfma_f32_16x16x32_bf16 v[76:79], a[80:83], v[28:31], v[76:79]
ds_read_b64_tr_b16 v[60:61], v9 offset:0
v_mfma_f32_16x16x32_bf16 v[92:95], a[84:87], v[28:31], v[92:95]
s_waitcnt lgkmcnt(7)
ds_read_b64_tr_b16 v[62:63], v9 offset:512
v_mfma_f32_16x16x32_bf16 v[64:67], a[88:91], v[32:35], v[64:67]
ds_read_b64_tr_b16 v[16:17], v6 offset:4096
v_mfma_f32_16x16x32_bf16 v[80:83], a[92:95], v[32:35], v[80:83]
ds_read_b64_tr_b16 v[18:19], v6 offset:4608
v_cvt_pk_bf16_f32 v112, v112, v113
v_mfma_f32_16x16x32_bf16 v[68:71], a[88:91], v[36:39], v[68:71]
ds_read_b64_tr_b16 v[20:21], v7 offset:4096
v_cvt_pk_bf16_f32 v113, v114, v115
s_add_u32 m0, s53, 0x14000
s_add_u32 s38, s52, 0x200000
buffer_load_dwordx4 v3, s[16:19], s38 offen lds
buffer_load_dwordx4 v4, s[16:19], s38 offen offset:1024 lds
v_mfma_f32_16x16x32_bf16 v[84:87], a[92:95], v[36:39], v[84:87]
ds_read_b64_tr_b16 v[22:23], v7 offset:4608
v_cvt_pk_bf16_f32 v114, v116, v117
v_mfma_f32_16x16x32_bf16 v[72:75], a[88:91], v[40:43], v[72:75]
ds_read_b64_tr_b16 v[24:25], v8 offset:4096
v_cvt_pk_bf16_f32 v115, v118, v119
v_mfma_f32_16x16x32_bf16 v[88:91], a[92:95], v[40:43], v[88:91]
ds_read_b64_tr_b16 v[26:27], v8 offset:4608
s_add_u32 s38, s54, 0x2001800
buffer_store_dwordx4 v[112:115], v5, s[4:7], s38 offen sc1
v_mfma_f32_16x16x32_bf16 v[76:79], a[88:91], v[44:47], v[76:79]
ds_read_b64_tr_b16 v[28:29], v9 offset:4096
v_mfma_f32_16x16x32_bf16 v[92:95], a[92:95], v[44:47], v[92:95]
s_waitcnt lgkmcnt(7)
ds_read_b64_tr_b16 v[30:31], v9 offset:4608
v_mfma_f32_16x16x32_bf16 v[64:67], a[96:99], v[48:51], v[64:67]
ds_read_b64_tr_b16 v[32:33], v6 offset:8192
v_mfma_f32_16x16x32_bf16 v[80:83], a[100:103], v[48:51], v[80:83]
ds_read_b64_tr_b16 v[34:35], v6 offset:8704
v_mfma_f32_16x16x32_bf16 v[68:71], a[96:99], v[52:55], v[68:71]
ds_read_b64_tr_b16 v[36:37], v7 offset:8192
v_mfma_f32_16x16x32_bf16 v[84:87], a[100:103], v[52:55], v[84:87]
ds_read_b64_tr_b16 v[38:39], v7 offset:8704
v_mfma_f32_16x16x32_bf16 v[72:75], a[96:99], v[56:59], v[72:75]
ds_read_b64_tr_b16 v[40:41], v8 offset:8192
v_mfma_f32_16x16x32_bf16 v[88:91], a[100:103], v[56:59], v[88:91]
ds_read_b64_tr_b16 v[42:43], v8 offset:8704
v_mfma_f32_16x16x32_bf16 v[76:79], a[96:99], v[60:63], v[76:79]
ds_read_b64_tr_b16 v[44:45], v9 offset:8192
v_mfma_f32_16x16x32_bf16 v[92:95], a[100:103], v[60:63], v[92:95]
s_waitcnt lgkmcnt(7)
ds_read_b64_tr_b16 v[46:47], v9 offset:8704
v_mfma_f32_16x16x32_bf16 v[64:67], a[104:107], v[16:19], v[64:67]
ds_read_b64_tr_b16 v[48:49], v6 offset:12288
v_mfma_f32_16x16x32_bf16 v[80:83], a[108:111], v[16:19], v[80:83]
ds_read_b64_tr_b16 v[50:51], v6 offset:12800
v_mfma_f32_16x16x32_bf16 v[68:71], a[104:107], v[20:23], v[68:71]
ds_read_b64_tr_b16 v[52:53], v7 offset:12288
v_mfma_f32_16x16x32_bf16 v[84:87], a[108:111], v[20:23], v[84:87]
ds_read_b64_tr_b16 v[54:55], v7 offset:12800
v_mfma_f32_16x16x32_bf16 v[72:75], a[104:107], v[24:27], v[72:75]
ds_read_b64_tr_b16 v[56:57], v8 offset:12288
v_mfma_f32_16x16x32_bf16 v[88:91], a[108:111], v[24:27], v[88:91]
ds_read_b64_tr_b16 v[58:59], v8 offset:12800
v_mfma_f32_16x16x32_bf16 v[76:79], a[104:107], v[28:31], v[76:79]
ds_read_b64_tr_b16 v[60:61], v9 offset:12288
v_mfma_f32_16x16x32_bf16 v[92:95], a[108:111], v[28:31], v[92:95]
s_waitcnt lgkmcnt(7)
ds_read_b64_tr_b16 v[62:63], v9 offset:12800
s_barrier
s_lshl_b32 s35, s22, 7
s_add_u32 s35, s35, 0x20000
s_cmp_eq_u32 s20, 0
s_cselect_b32 s38, s35, s86
buffer_load_dword v2, off, s[4:7], s38 sc1
v_add_u32 v6, 0x4000, v6
v_add_u32 v7, 0x4000, v7
v_add_u32 v8, 0x4000, v8
v_add_u32 v9, 0x4000, v9
v_mfma_f32_16x16x32_bf16 v[64:67], a[112:115], v[32:35], v[64:67]
ds_read_b64_tr_b16 v[16:17], v6 offset:0
v_mfma_f32_16x16x32_bf16 v[80:83], a[116:119], v[32:35], v[80:83]
ds_read_b64_tr_b16 v[18:19], v6 offset:512
v_mfma_f32_16x16x32_bf16 v[68:71], a[112:115], v[36:39], v[68:71]
ds_read_b64_tr_b16 v[20:21], v7 offset:0
s_add_u32 m0, s53, 0x18000
s_add_u32 s38, s52, 0x80
buffer_load_dwordx4 v3, s[16:19], s38 offen lds
buffer_load_dwordx4 v4, s[16:19], s38 offen offset:1024 lds
v_mfma_f32_16x16x32_bf16 v[84:87], a[116:119], v[36:39], v[84:87]
ds_read_b64_tr_b16 v[22:23], v7 offset:512
v_mfma_f32_16x16x32_bf16 v[72:75], a[112:115], v[40:43], v[72:75]
ds_read_b64_tr_b16 v[24:25], v8 offset:0
v_mfma_f32_16x16x32_bf16 v[88:91], a[116:119], v[40:43], v[88:91]
ds_read_b64_tr_b16 v[26:27], v8 offset:512
v_mfma_f32_16x16x32_bf16 v[76:79], a[112:115], v[44:47], v[76:79]
ds_read_b64_tr_b16 v[28:29], v9 offset:0
v_mfma_f32_16x16x32_bf16 v[92:95], a[116:119], v[44:47], v[92:95]
s_waitcnt lgkmcnt(7)
ds_read_b64_tr_b16 v[30:31], v9 offset:512
v_mfma_f32_16x16x32_bf16 v[64:67], a[120:123], v[48:51], v[64:67]
ds_read_b64_tr_b16 v[32:33], v6 offset:4096
v_mfma_f32_16x16x32_bf16 v[80:83], a[124:127], v[48:51], v[80:83]
ds_read_b64_tr_b16 v[34:35], v6 offset:4608
v_cvt_pk_bf16_f32 v120, v120, v121
v_mfma_f32_16x16x32_bf16 v[68:71], a[120:123], v[52:55], v[68:71]
ds_read_b64_tr_b16 v[36:37], v7 offset:4096
v_cvt_pk_bf16_f32 v121, v122, v123
v_mfma_f32_16x16x32_bf16 v[84:87], a[124:127], v[52:55], v[84:87]
ds_read_b64_tr_b16 v[38:39], v7 offset:4608
v_cvt_pk_bf16_f32 v122, v124, v125
v_mfma_f32_16x16x32_bf16 v[72:75], a[120:123], v[56:59], v[72:75]
ds_read_b64_tr_b16 v[40:41], v8 offset:4096
v_cvt_pk_bf16_f32 v123, v126, v127
v_mfma_f32_16x16x32_bf16 v[88:91], a[124:127], v[56:59], v[88:91]
ds_read_b64_tr_b16 v[42:43], v8 offset:4608
s_add_u32 s38, s54, 0x2001c00
buffer_store_dwordx4 v[120:123], v5, s[4:7], s38 offen sc1
v_mfma_f32_16x16x32_bf16 v[76:79], a[120:123], v[60:63], v[76:79]
ds_read_b64_tr_b16 v[44:45], v9 offset:4096
v_mfma_f32_16x16x32_bf16 v[92:95], a[124:127], v[60:63], v[92:95]
s_waitcnt lgkmcnt(7)
ds_read_b64_tr_b16 v[46:47], v9 offset:4608
v_mfma_f32_16x16x32_bf16 v[96:99], a[0:3], v[16:19], 0
ds_read_b64_tr_b16 v[48:49], v6 offset:8192
v_mfma_f32_16x16x32_bf16 v[112:115], a[4:7], v[16:19], 0
ds_read_b64_tr_b16 v[50:51], v6 offset:8704
v_mfma_f32_16x16x32_bf16 v[100:103], a[0:3], v[20:23], 0
ds_read_b64_tr_b16 v[52:53], v7 offset:8192
v_mfma_f32_16x16x32_bf16 v[116:119], a[4:7], v[20:23], 0
ds_read_b64_tr_b16 v[54:55], v7 offset:8704
v_mfma_f32_16x16x32_bf16 v[104:107], a[0:3], v[24:27], 0
ds_read_b64_tr_b16 v[56:57], v8 offset:8192
v_mfma_f32_16x16x32_bf16 v[120:123], a[4:7], v[24:27], 0
ds_read_b64_tr_b16 v[58:59], v8 offset:8704
v_mfma_f32_16x16x32_bf16 v[108:111], a[0:3], v[28:31], 0
ds_read_b64_tr_b16 v[60:61], v9 offset:8192
v_mfma_f32_16x16x32_bf16 v[124:127], a[4:7], v[28:31], 0
s_waitcnt lgkmcnt(7)
ds_read_b64_tr_b16 v[62:63], v9 offset:8704
v_mfma_f32_16x16x32_bf16 v[96:99], a[8:11], v[32:35], v[96:99]
ds_read_b64_tr_b16 v[16:17], v6 offset:12288
v_mfma_f32_16x16x32_bf16 v[112:115], a[12:15], v[32:35], v[112:115]
ds_read_b64_tr_b16 v[18:19], v6 offset:12800
v_mfma_f32_16x16x32_bf16 v[100:103], a[8:11], v[36:39], v[100:103]
ds_read_b64_tr_b16 v[20:21], v7 offset:12288
v_mfma_f32_16x16x32_bf16 v[116:119], a[12:15], v[36:39], v[116:119]
ds_read_b64_tr_b16 v[22:23], v7 offset:12800
v_mfma_f32_16x16x32_bf16 v[104:107], a[8:11], v[40:43], v[104:107]
ds_read_b64_tr_b16 v[24:25], v8 offset:12288
v_mfma_f32_16x16x32_bf16 v[120:123], a[12:15], v[40:43], v[120:123]
ds_read_b64_tr_b16 v[26:27], v8 offset:12800
v_mfma_f32_16x16x32_bf16 v[108:111], a[8:11], v[44:47], v[108:111]
ds_read_b64_tr_b16 v[28:29], v9 offset:12288
v_mfma_f32_16x16x32_bf16 v[124:127], a[12:15], v[44:47], v[124:127]
s_waitcnt lgkmcnt(7)
ds_read_b64_tr_b16 v[30:31], v9 offset:12800
s_waitcnt vmcnt(3)
s_cmp_lg_u32 s20, 0
s_cbranch_scc1 L_pok_1007
v_readfirstlane_b32 s38, v2
s_nop 3
s_cmp_ge_u32 s38, 32
s_cbranch_scc1 L_pok_1007
s_mov_b32 s39, 0x40000
L_ploop_1008:
s_sleep 4
buffer_load_dword v2, off, s[4:7], s35 sc1
s_waitcnt vmcnt(0)
v_readfirstlane_b32 s38, v2
s_nop 3
s_cmp_ge_u32 s38, 32
s_cbranch_scc1 L_pok_1007
s_sub_u32 s39, s39, 1
s_cmp_lg_u32 s39, 0
s_cbranch_scc1 L_ploop_1008
L_pok_1007:
s_barrier
v_add_u32 v6, 0xfffe8000, v6
v_add_u32 v7, 0xfffe8000, v7
v_add_u32 v8, 0xfffe8000, v8
v_add_u32 v9, 0xfffe8000, v9
v_mfma_f32_16x16x32_bf16 v[96:99], a[16:19], v[48:51], v[96:99]
ds_read_b64_tr_b16 v[32:33], v6 offset:0
v_mfma_f32_16x16x32_bf16 v[112:115], a[20:23], v[48:51], v[112:115]
ds_read_b64_tr_b16 v[34:35], v6 offset:512
v_mfma_f32_16x16x32_bf16 v[100:103], a[16:19], v[52:55], v[100:103]
ds_read_b64_tr_b16 v[36:37], v7 offset:0
s_add_u32 m0, s53, 0x1c000
s_add_u32 s38, s52, 0x100080
buffer_load_dwordx4 v3, s[16:19], s38 offen lds
buffer_load_dwordx4 v4, s[16:19], s38 offen offset:1024 lds
v_mfma_f32_16x16x32_bf16 v[116:119], a[20:23], v[52:55], v[116:119]
ds_read_b64_tr_b16 v[38:39], v7 offset:512
v_mfma_f32_16x16x32_bf16 v[104:107], a[16:19], v[56:59], v[104:107]
ds_read_b64_tr_b16 v[40:41], v8 offset:0
v_mfma_f32_16x16x32_bf16 v[120:123], a[20:23], v[56:59], v[120:123]
ds_read_b64_tr_b16 v[42:43], v8 offset:512
v_mfma_f32_16x16x32_bf16 v[108:111], a[16:19], v[60:63], v[108:111]
ds_read_b64_tr_b16 v[44:45], v9 offset:0
v_mfma_f32_16x16x32_bf16 v[124:127], a[20:23], v[60:63], v[124:127]
s_waitcnt lgkmcnt(7)
ds_read_b64_tr_b16 v[46:47], v9 offset:512
v_mfma_f32_16x16x32_bf16 v[96:99], a[24:27], v[16:19], v[96:99]
ds_read_b64_tr_b16 v[48:49], v6 offset:4096
v_mfma_f32_16x16x32_bf16 v[112:115], a[28:31], v[16:19], v[112:115]
ds_read_b64_tr_b16 v[50:51], v6 offset:4608
v_cvt_pk_bf16_f32 v64, v64, v65
v_mfma_f32_16x16x32_bf16 v[100:103], a[24:27], v[20:23], v[100:103]
ds_read_b64_tr_b16 v[52:53], v7 offset:4096
v_cvt_pk_bf16_f32 v65, v66, v67
v_mfma_f32_16x16x32_bf16 v[116:119], a[28:31], v[20:23], v[116:119]
ds_read_b64_tr_b16 v[54:55], v7 offset:4608
v_cvt_pk_bf16_f32 v66, v80, v81
v_mfma_f32_16x16x32_bf16 v[104:107], a[24:27], v[24:27], v[104:107]
ds_read_b64_tr_b16 v[56:57], v8 offset:4096
v_cvt_pk_bf16_f32 v67, v82, v83
v_mfma_f32_16x16x32_bf16 v[120:123], a[28:31], v[24:27], v[120:123]
ds_read_b64_tr_b16 v[58:59], v8 offset:4608
s_add_u32 s38, s54, 0x3100000
buffer_store_dwordx4 v[64:67], v5, s[4:7], s38 offen sc1
v_mfma_f32_16x16x32_bf16 v[108:111], a[24:27], v[28:31], v[108:111]
ds_read_b64_tr_b16 v[60:61], v9 offset:4096
v_mfma_f32_16x16x32_bf16 v[124:127], a[28:31], v[28:31], v[124:127]
s_waitcnt lgkmcnt(7)
ds_read_b64_tr_b16 v[62:63], v9 offset:4608
v_mfma_f32_16x16x32_bf16 v[96:99], a[32:35], v[32:35], v[96:99]
ds_read_b64_tr_b16 v[16:17], v6 offset:8192
v_mfma_f32_16x16x32_bf16 v[112:115], a[36:39], v[32:35], v[112:115]
ds_read_b64_tr_b16 v[18:19], v6 offset:8704
v_mfma_f32_16x16x32_bf16 v[100:103], a[32:35], v[36:39], v[100:103]
ds_read_b64_tr_b16 v[20:21], v7 offset:8192
v_mfma_f32_16x16x32_bf16 v[116:119], a[36:39], v[36:39], v[116:119]
ds_read_b64_tr_b16 v[22:23], v7 offset:8704
v_mfma_f32_16x16x32_bf16 v[104:107], a[32:35], v[40:43], v[104:107]
ds_read_b64_tr_b16 v[24:25], v8 offset:8192
v_mfma_f32_16x16x32_bf16 v[120:123], a[36:39], v[40:43], v[120:123]
ds_read_b64_tr_b16 v[26:27], v8 offset:8704
v_mfma_f32_16x16x32_bf16 v[108:111], a[32:35], v[44:47], v[108:111]
ds_read_b64_tr_b16 v[28:29], v9 offset:8192
v_mfma_f32_16x16x32_bf16 v[124:127], a[36:39], v[44:47], v[124:127]
s_waitcnt lgkmcnt(7)
ds_read_b64_tr_b16 v[30:31], v9 offset:8704
s_lshl_b32 s38, s25, 14
s_add_u32 s38, s38, 0x100000
buffer_load_dwordx4 a[0:3], v5, s[4:7], s38 offen sc1
s_lshl_b32 s38, s25, 14
s_add_u32 s38, s38, 0x104000
buffer_load_dwordx4 a[4:7], v5, s[4:7], s38 offen sc1
v_mfma_f32_16x16x32_bf16 v[96:99], a[40:43], v[48:51], v[96:99]
ds_read_b64_tr_b16 v[32:33], v6 offset:12288
v_mfma_f32_16x16x32_bf16 v[112:115], a[44:47], v[48:51], v[112:115]
ds_read_b64_tr_b16 v[34:35], v6 offset:12800
v_mfma_f32_16x16x32_bf16 v[100:103], a[40:43], v[52:55], v[100:103]
ds_read_b64_tr_b16 v[36:37], v7 offset:12288
v_mfma_f32_16x16x32_bf16 v[116:119], a[44:47], v[52:55], v[116:119]
ds_read_b64_tr_b16 v[38:39], v7 offset:12800
v_mfma_f32_16x16x32_bf16 v[104:107], a[40:43], v[56:59], v[104:107]
ds_read_b64_tr_b16 v[40:41], v8 offset:12288
v_mfma_f32_16x16x32_bf16 v[120:123], a[44:47], v[56:59], v[120:123]
ds_read_b64_tr_b16 v[42:43], v8 offset:12800
v_mfma_f32_16x16x32_bf16 v[108:111], a[40:43], v[60:63], v[108:111]
ds_read_b64_tr_b16 v[44:45], v9 offset:12288
v_mfma_f32_16x16x32_bf16 v[124:127], a[44:47], v[60:63], v[124:127]
s_waitcnt lgkmcnt(7)
ds_read_b64_tr_b16 v[46:47], v9 offset:12800
s_lshl_b32 s38, s25, 14
s_add_u32 s38, s38, 0x100400
buffer_load_dwordx4 a[8:11], v5, s[4:7], s38 offen sc1
s_lshl_b32 s38, s25, 14
s_add_u32 s38, s38, 0x104400
buffer_load_dwordx4 a[12:15], v5, s[4:7], s38 offen sc1
s_barrier
v_add_u32 v6, 0xffff4000, v6
v_add_u32 v7, 0xffff4000, v7
v_add_u32 v8, 0xffff4000, v8
v_add_u32 v9, 0xffff4000, v9
v_mfma_f32_16x16x32_bf16 v[96:99], a[48:51], v[16:19], v[96:99]
ds_read_b64_tr_b16 v[48:49], v6 offset:0
v_mfma_f32_16x16x32_bf16 v[112:115], a[52:55], v[16:19], v[112:115]
ds_read_b64_tr_b16 v[50:51], v6 offset:512
v_mfma_f32_16x16x32_bf16 v[100:103], a[48:51], v[20:23], v[100:103]
ds_read_b64_tr_b16 v[52:53], v7 offset:0
s_add_u32 m0, s53, 0x20000
s_add_u32 s38, s52, 0x200080
buffer_load_dwordx4 v3, s[16:19], s38 offen lds
buffer_load_dwordx4 v4, s[16:19], s38 offen offset:1024 lds
v_mfma_f32_16x16x32_bf16 v[116:119], a[52:55], v[20:23], v[116:119]
ds_read_b64_tr_b16 v[54:55], v7 offset:512
v_mfma_f32_16x16x32_bf16 v[104:107], a[48:51], v[24:27], v[104:107]
ds_read_b64_tr_b16 v[56:57], v8 offset:0
v_mfma_f32_16x16x32_bf16 v[120:123], a[52:55], v[24:27], v[120:123]
ds_read_b64_tr_b16 v[58:59], v8 offset:512
v_mfma_f32_16x16x32_bf16 v[108:111], a[48:51], v[28:31], v[108:111]
ds_read_b64_tr_b16 v[60:61], v9 offset:0
v_mfma_f32_16x16x32_bf16 v[124:127], a[52:55], v[28:31], v[124:127]
s_waitcnt lgkmcnt(7)
ds_read_b64_tr_b16 v[62:63], v9 offset:512
s_lshl_b32 s38, s25, 14
s_add_u32 s38, s38, 0x100800
buffer_load_dwordx4 a[16:19], v5, s[4:7], s38 offen sc1
s_lshl_b32 s38, s25, 14
s_add_u32 s38, s38, 0x104800
buffer_load_dwordx4 a[20:23], v5, s[4:7], s38 offen sc1
v_mfma_f32_16x16x32_bf16 v[96:99], a[56:59], v[32:35], v[96:99]
ds_read_b64_tr_b16 v[16:17], v6 offset:4096
v_mfma_f32_16x16x32_bf16 v[112:115], a[60:63], v[32:35], v[112:115]
ds_read_b64_tr_b16 v[18:19], v6 offset:4608
v_cvt_pk_bf16_f32 v68, v68, v69
v_mfma_f32_16x16x32_bf16 v[100:103], a[56:59], v[36:39], v[100:103]
ds_read_b64_tr_b16 v[20:21], v7 offset:4096
v_cvt_pk_bf16_f32 v69, v70, v71
v_mfma_f32_16x16x32_bf16 v[116:119], a[60:63], v[36:39], v[116:119]
ds_read_b64_tr_b16 v[22:23], v7 offset:4608
v_cvt_pk_bf16_f32 v70, v84, v85
v_mfma_f32_16x16x32_bf16 v[104:107], a[56:59], v[40:43], v[104:107]
ds_read_b64_tr_b16 v[24:25], v8 offset:4096
v_cvt_pk_bf16_f32 v71, v86, v87
v_mfma_f32_16x16x32_bf16 v[120:123], a[60:63], v[40:43], v[120:123]
ds_read_b64_tr_b16 v[26:27], v8 offset:4608
s_add_u32 s38, s54, 0x3100400
buffer_store_dwordx4 v[68:71], v5, s[4:7], s38 offen sc1
v_mfma_f32_16x16x32_bf16 v[108:111], a[56:59], v[44:47], v[108:111]
ds_read_b64_tr_b16 v[28:29], v9 offset:4096
v_mfma_f32_16x16x32_bf16 v[124:127], a[60:63], v[44:47], v[124:127]
s_waitcnt lgkmcnt(7)
ds_read_b64_tr_b16 v[30:31], v9 offset:4608
s_lshl_b32 s38, s25, 14
s_add_u32 s38, s38, 0x100c00
buffer_load_dwordx4 a[24:27], v5, s[4:7], s38 offen sc1
s_lshl_b32 s38, s25, 14
s_add_u32 s38, s38, 0x104c00
buffer_load_dwordx4 a[28:31], v5, s[4:7], s38 offen sc1
v_mfma_f32_16x16x32_bf16 v[96:99], a[64:67], v[48:51], v[96:99]
ds_read_b64_tr_b16 v[32:33], v6 offset:8192
v_mfma_f32_16x16x32_bf16 v[112:115], a[68:71], v[48:51], v[112:115]
ds_read_b64_tr_b16 v[34:35], v6 offset:8704
v_mfma_f32_16x16x32_bf16 v[100:103], a[64:67], v[52:55], v[100:103]
ds_read_b64_tr_b16 v[36:37], v7 offset:8192
v_mfma_f32_16x16x32_bf16 v[116:119], a[68:71], v[52:55], v[116:119]
ds_read_b64_tr_b16 v[38:39], v7 offset:8704
v_mfma_f32_16x16x32_bf16 v[104:107], a[64:67], v[56:59], v[104:107]
ds_read_b64_tr_b16 v[40:41], v8 offset:8192
v_mfma_f32_16x16x32_bf16 v[120:123], a[68:71], v[56:59], v[120:123]
ds_read_b64_tr_b16 v[42:43], v8 offset:8704
v_mfma_f32_16x16x32_bf16 v[108:111], a[64:67], v[60:63], v[108:111]
ds_read_b64_tr_b16 v[44:45], v9 offset:8192
v_mfma_f32_16x16x32_bf16 v[124:127], a[68:71], v[60:63], v[124:127]
s_waitcnt lgkmcnt(7)
ds_read_b64_tr_b16 v[46:47], v9 offset:8704
s_lshl_b32 s38, s25, 14
s_add_u32 s38, s38, 0x101000
buffer_load_dwordx4 a[32:35], v5, s[4:7], s38 offen sc1
s_lshl_b32 s38, s25, 14
s_add_u32 s38, s38, 0x105000
buffer_load_dwordx4 a[36:39], v5, s[4:7], s38 offen sc1
v_mfma_f32_16x16x32_bf16 v[96:99], a[72:75], v[16:19], v[96:99]
ds_read_b64_tr_b16 v[48:49], v6 offset:12288
v_mfma_f32_16x16x32_bf16 v[112:115], a[76:79], v[16:19], v[112:115]
ds_read_b64_tr_b16 v[50:51], v6 offset:12800
v_mfma_f32_16x16x32_bf16 v[100:103], a[72:75], v[20:23], v[100:103]
ds_read_b64_tr_b16 v[52:53], v7 offset:12288
v_mfma_f32_16x16x32_bf16 v[116:119], a[76:79], v[20:23], v[116:119]
ds_read_b64_tr_b16 v[54:55], v7 offset:12800
v_mfma_f32_16x16x32_bf16 v[104:107], a[72:75], v[24:27], v[104:107]
ds_read_b64_tr_b16 v[56:57], v8 offset:12288
v_mfma_f32_16x16x32_bf16 v[120:123], a[76:79], v[24:27], v[120:123]
ds_read_b64_tr_b16 v[58:59], v8 offset:12800
v_mfma_f32_16x16x32_bf16 v[108:111], a[72:75], v[28:31], v[108:111]
ds_read_b64_tr_b16 v[60:61], v9 offset:12288
v_mfma_f32_16x16x32_bf16 v[124:127], a[76:79], v[28:31], v[124:127]
s_waitcnt lgkmcnt(7)
ds_read_b64_tr_b16 v[62:63], v9 offset:12800
s_lshl_b32 s38, s25, 14
s_add_u32 s38, s38, 0x101400
buffer_load_dwordx4 a[40:43], v5, s[4:7], s38 offen sc1
s_lshl_b32 s38, s25, 14
s_add_u32 s38, s38, 0x105400
buffer_load_dwordx4 a[44:47], v5, s[4:7], s38 offen sc1
s_barrier
v_add_u32 v6, 0x4000, v6
v_add_u32 v7, 0x4000, v7
v_add_u32 v8, 0x4000, v8
v_add_u32 v9, 0x4000, v9
v_mfma_f32_16x16x32_bf16 v[96:99], a[80:83], v[32:35], v[96:99]
ds_read_b64_tr_b16 v[16:17], v6 offset:0
v_mfma_f32_16x16x32_bf16 v[112:115], a[84:87], v[32:35], v[112:115]
ds_read_b64_tr_b16 v[18:19], v6 offset:512
v_mfma_f32_16x16x32_bf16 v[100:103], a[80:83], v[36:39], v[100:103]
ds_read_b64_tr_b16 v[20:21], v7 offset:0
s_add_u32 m0, s53, 0xc000
s_add_u32 s38, s52, 0x300000
buffer_load_dwordx4 v3, s[16:19], s38 offen lds
buffer_load_dwordx4 v4, s[16:19], s38 offen offset:1024 lds
v_mfma_f32_16x16x32_bf16 v[116:119], a[84:87], v[36:39], v[116:119]
ds_read_b64_tr_b16 v[22:23], v7 offset:512
v_mfma_f32_16x16x32_bf16 v[104:107], a[80:83], v[40:43], v[104:107]
ds_read_b64_tr_b16 v[24:25], v8 offset:0
v_mfma_f32_16x16x32_bf16 v[120:123], a[84:87], v[40:43], v[120:123]
ds_read_b64_tr_b16 v[26:27], v8 offset:512
v_mfma_f32_16x16x32_bf16 v[108:111], a[80:83], v[44:47], v[108:111]
ds_read_b64_tr_b16 v[28:29], v9 offset:0
v_mfma_f32_16x16x32_bf16 v[124:127], a[84:87], v[44:47], v[124:127]
s_waitcnt lgkmcnt(7)
ds_read_b64_tr_b16 v[30:31], v9 offset:512
s_lshl_b32 s38, s25, 14
s_add_u32 s38, s38, 0x101800
buffer_load_dwordx4 a[48:51], v5, s[4:7], s38 offen sc1
s_lshl_b32 s38, s25, 14
s_add_u32 s38, s38, 0x105800
buffer_load_dwordx4 a[52:55], v5, s[4:7], s38 offen sc1
v_mfma_f32_16x16x32_bf16 v[96:99], a[88:91], v[48:51], v[96:99]
ds_read_b64_tr_b16 v[32:33], v6 offset:4096
v_mfma_f32_16x16x32_bf16 v[112:115], a[92:95], v[48:51], v[112:115]
ds_read_b64_tr_b16 v[34:35], v6 offset:4608
v_cvt_pk_bf16_f32 v72, v72, v73
v_mfma_f32_16x16x32_bf16 v[100:103], a[88:91], v[52:55], v[100:103]
ds_read_b64_tr_b16 v[36:37], v7 offset:4096
v_cvt_pk_bf16_f32 v73, v74, v75
v_mfma_f32_16x16x32_bf16 v[116:119], a[92:95], v[52:55], v[116:119]
ds_read_b64_tr_b16 v[38:39], v7 offset:4608
v_cvt_pk_bf16_f32 v74, v88, v89
v_mfma_f32_16x16x32_bf16 v[104:107], a[88:91], v[56:59], v[104:107]
ds_read_b64_tr_b16 v[40:41], v8 offset:4096
v_cvt_pk_bf16_f32 v75, v90, v91
v_mfma_f32_16x16x32_bf16 v[120:123], a[92:95], v[56:59], v[120:123]
ds_read_b64_tr_b16 v[42:43], v8 offset:4608
s_add_u32 s38, s54, 0x3100800
buffer_store_dwordx4 v[72:75], v5, s[4:7], s38 offen sc1
v_mfma_f32_16x16x32_bf16 v[108:111], a[88:91], v[60:63], v[108:111]
ds_read_b64_tr_b16 v[44:45], v9 offset:4096
v_mfma_f32_16x16x32_bf16 v[124:127], a[92:95], v[60:63], v[124:127]
s_waitcnt lgkmcnt(7)
ds_read_b64_tr_b16 v[46:47], v9 offset:4608
s_lshl_b32 s38, s25, 14
s_add_u32 s38, s38, 0x101c00
buffer_load_dwordx4 a[56:59], v5, s[4:7], s38 offen sc1
s_lshl_b32 s38, s25, 14
s_add_u32 s38, s38, 0x105c00
buffer_load_dwordx4 a[60:63], v5, s[4:7], s38 offen sc1
v_mfma_f32_16x16x32_bf16 v[96:99], a[96:99], v[16:19], v[96:99]
ds_read_b64_tr_b16 v[48:49], v6 offset:8192
v_mfma_f32_16x16x32_bf16 v[112:115], a[100:103], v[16:19], v[112:115]
ds_read_b64_tr_b16 v[50:51], v6 offset:8704
v_mfma_f32_16x16x32_bf16 v[100:103], a[96:99], v[20:23], v[100:103]
ds_read_b64_tr_b16 v[52:53], v7 offset:8192
v_mfma_f32_16x16x32_bf16 v[116:119], a[100:103], v[20:23], v[116:119]
ds_read_b64_tr_b16 v[54:55], v7 offset:8704
v_mfma_f32_16x16x32_bf16 v[104:107], a[96:99], v[24:27], v[104:107]
ds_read_b64_tr_b16 v[56:57], v8 offset:8192
v_mfma_f32_16x16x32_bf16 v[120:123], a[100:103], v[24:27], v[120:123]
ds_read_b64_tr_b16 v[58:59], v8 offset:8704
v_mfma_f32_16x16x32_bf16 v[108:111], a[96:99], v[28:31], v[108:111]
ds_read_b64_tr_b16 v[60:61], v9 offset:8192
v_mfma_f32_16x16x32_bf16 v[124:127], a[100:103], v[28:31], v[124:127]
s_waitcnt lgkmcnt(7)
ds_read_b64_tr_b16 v[62:63], v9 offset:8704
s_lshl_b32 s38, s25, 14
s_add_u32 s38, s38, 0x102000
buffer_load_dwordx4 a[64:67], v5, s[4:7], s38 offen sc1
s_lshl_b32 s38, s25, 14
s_add_u32 s38, s38, 0x106000
buffer_load_dwordx4 a[68:71], v5, s[4:7], s38 offen sc1
v_mfma_f32_16x16x32_bf16 v[96:99], a[104:107], v[32:35], v[96:99]
ds_read_b64_tr_b16 v[16:17], v6 offset:12288
v_mfma_f32_16x16x32_bf16 v[112:115], a[108:111], v[32:35], v[112:115]
ds_read_b64_tr_b16 v[18:19], v6 offset:12800
v_mfma_f32_16x16x32_bf16 v[100:103], a[104:107], v[36:39], v[100:103]
ds_read_b64_tr_b16 v[20:21], v7 offset:12288
v_mfma_f32_16x16x32_bf16 v[116:119], a[108:111], v[36:39], v[116:119]
ds_read_b64_tr_b16 v[22:23], v7 offset:12800
v_mfma_f32_16x16x32_bf16 v[104:107], a[104:107], v[40:43], v[104:107]
ds_read_b64_tr_b16 v[24:25], v8 offset:12288
v_mfma_f32_16x16x32_bf16 v[120:123], a[108:111], v[40:43], v[120:123]
ds_read_b64_tr_b16 v[26:27], v8 offset:12800
v_mfma_f32_16x16x32_bf16 v[108:111], a[104:107], v[44:47], v[108:111]
ds_read_b64_tr_b16 v[28:29], v9 offset:12288
v_mfma_f32_16x16x32_bf16 v[124:127], a[108:111], v[44:47], v[124:127]
s_waitcnt lgkmcnt(7)
ds_read_b64_tr_b16 v[30:31], v9 offset:12800
s_lshl_b32 s38, s25, 14
s_add_u32 s38, s38, 0x102400
buffer_load_dwordx4 a[72:75], v5, s[4:7], s38 offen sc1
s_lshl_b32 s38, s25, 14
s_add_u32 s38, s38, 0x106400
buffer_load_dwordx4 a[76:79], v5, s[4:7], s38 offen sc1
s_barrier
v_add_u32 v6, 0x4000, v6
v_add_u32 v7, 0x4000, v7
v_add_u32 v8, 0x4000, v8
v_add_u32 v9, 0x4000, v9
v_mfma_f32_16x16x32_bf16 v[96:99], a[112:115], v[48:51], v[96:99]
ds_read_b64_tr_b16 v[32:33], v6 offset:0
v_mfma_f32_16x16x32_bf16 v[112:115], a[116:119], v[48:51], v[112:115]
ds_read_b64_tr_b16 v[34:35], v6 offset:512
v_mfma_f32_16x16x32_bf16 v[100:103], a[112:115], v[52:55], v[100:103]
ds_read_b64_tr_b16 v[36:37], v7 offset:0
s_add_u32 m0, s53, 0x24000
s_add_u32 s38, s52, 0x300080
buffer_load_dwordx4 v3, s[16:19], s38 offen lds
buffer_load_dwordx4 v4, s[16:19], s38 offen offset:1024 lds
v_mfma_f32_16x16x32_bf16 v[116:119], a[116:119], v[52:55], v[116:119]
ds_read_b64_tr_b16 v[38:39], v7 offset:512
v_mfma_f32_16x16x32_bf16 v[104:107], a[112:115], v[56:59], v[104:107]
ds_read_b64_tr_b16 v[40:41], v8 offset:0
v_mfma_f32_16x16x32_bf16 v[120:123], a[116:119], v[56:59], v[120:123]
ds_read_b64_tr_b16 v[42:43], v8 offset:512
v_mfma_f32_16x16x32_bf16 v[108:111], a[112:115], v[60:63], v[108:111]
ds_read_b64_tr_b16 v[44:45], v9 offset:0
v_mfma_f32_16x16x32_bf16 v[124:127], a[116:119], v[60:63], v[124:127]
s_waitcnt lgkmcnt(7)
ds_read_b64_tr_b16 v[46:47], v9 offset:512
s_lshl_b32 s38, s25, 14
s_add_u32 s38, s38, 0x102800
buffer_load_dwordx4 a[80:83], v5, s[4:7], s38 offen sc1
s_lshl_b32 s38, s25, 14
s_add_u32 s38, s38, 0x106800
buffer_load_dwordx4 a[84:87], v5, s[4:7], s38 offen sc1
v_mfma_f32_16x16x32_bf16 v[96:99], a[120:123], v[16:19], v[96:99]
ds_read_b64_tr_b16 v[48:49], v6 offset:4096
v_mfma_f32_16x16x32_bf16 v[112:115], a[124:127], v[16:19], v[112:115]
ds_read_b64_tr_b16 v[50:51], v6 offset:4608
v_cvt_pk_bf16_f32 v76, v76, v77
v_mfma_f32_16x16x32_bf16 v[100:103], a[120:123], v[20:23], v[100:103]
ds_read_b64_tr_b16 v[52:53], v7 offset:4096
v_cvt_pk_bf16_f32 v77, v78, v79
v_mfma_f32_16x16x32_bf16 v[116:119], a[124:127], v[20:23], v[116:119]
ds_read_b64_tr_b16 v[54:55], v7 offset:4608
v_cvt_pk_bf16_f32 v78, v92, v93
v_mfma_f32_16x16x32_bf16 v[104:107], a[120:123], v[24:27], v[104:107]
ds_read_b64_tr_b16 v[56:57], v8 offset:4096
v_cvt_pk_bf16_f32 v79, v94, v95
v_mfma_f32_16x16x32_bf16 v[120:123], a[124:127], v[24:27], v[120:123]
ds_read_b64_tr_b16 v[58:59], v8 offset:4608
s_add_u32 s38, s54, 0x3100c00
buffer_store_dwordx4 v[76:79], v5, s[4:7], s38 offen sc1
v_mfma_f32_16x16x32_bf16 v[108:111], a[120:123], v[28:31], v[108:111]
ds_read_b64_tr_b16 v[60:61], v9 offset:4096
v_mfma_f32_16x16x32_bf16 v[124:127], a[124:127], v[28:31], v[124:127]
s_waitcnt lgkmcnt(7)
ds_read_b64_tr_b16 v[62:63], v9 offset:4608
s_lshl_b32 s38, s25, 14
s_add_u32 s38, s38, 0x102c00
buffer_load_dwordx4 a[88:91], v5, s[4:7], s38 offen sc1
s_lshl_b32 s38, s25, 14
s_add_u32 s38, s38, 0x106c00
buffer_load_dwordx4 a[92:95], v5, s[4:7], s38 offen sc1
s_waitcnt vmcnt(31)
v_mfma_f32_16x16x32_bf16 v[64:67], v[32:35], a[0:3], 0
ds_read_b64_tr_b16 v[16:17], v6 offset:8192
v_mfma_f32_16x16x32_bf16 v[80:83], v[32:35], a[4:7], 0
ds_read_b64_tr_b16 v[18:19], v6 offset:8704
v_mfma_f32_16x16x32_bf16 v[68:71], v[36:39], a[0:3], 0
ds_read_b64_tr_b16 v[20:21], v7 offset:8192
v_mfma_f32_16x16x32_bf16 v[84:87], v[36:39], a[4:7], 0
ds_read_b64_tr_b16 v[22:23], v7 offset:8704
v_mfma_f32_16x16x32_bf16 v[72:75], v[40:43], a[0:3], 0
ds_read_b64_tr_b16 v[24:25], v8 offset:8192
v_mfma_f32_16x16x32_bf16 v[88:91], v[40:43], a[4:7], 0
ds_read_b64_tr_b16 v[26:27], v8 offset:8704
v_mfma_f32_16x16x32_bf16 v[76:79], v[44:47], a[0:3], 0
ds_read_b64_tr_b16 v[28:29], v9 offset:8192
v_mfma_f32_16x16x32_bf16 v[92:95], v[44:47], a[4:7], 0
s_waitcnt lgkmcnt(7)
ds_read_b64_tr_b16 v[30:31], v9 offset:8704
s_lshl_b32 s38, s25, 14
s_add_u32 s38, s38, 0x103000
buffer_load_dwordx4 a[96:99], v5, s[4:7], s38 offen sc1
s_lshl_b32 s38, s25, 14
s_add_u32 s38, s38, 0x107000
buffer_load_dwordx4 a[100:103], v5, s[4:7], s38 offen sc1
s_waitcnt vmcnt(31)
v_mfma_f32_16x16x32_bf16 v[64:67], v[48:51], a[8:11], v[64:67]
ds_read_b64_tr_b16 v[32:33], v6 offset:12288
v_mfma_f32_16x16x32_bf16 v[80:83], v[48:51], a[12:15], v[80:83]
ds_read_b64_tr_b16 v[34:35], v6 offset:12800
v_mfma_f32_16x16x32_bf16 v[68:71], v[52:55], a[8:11], v[68:71]
ds_read_b64_tr_b16 v[36:37], v7 offset:12288
v_mfma_f32_16x16x32_bf16 v[84:87], v[52:55], a[12:15], v[84:87]
ds_read_b64_tr_b16 v[38:39], v7 offset:12800
v_mfma_f32_16x16x32_bf16 v[72:75], v[56:59], a[8:11], v[72:75]
ds_read_b64_tr_b16 v[40:41], v8 offset:12288
v_mfma_f32_16x16x32_bf16 v[88:91], v[56:59], a[12:15], v[88:91]
ds_read_b64_tr_b16 v[42:43], v8 offset:12800
v_mfma_f32_16x16x32_bf16 v[76:79], v[60:63], a[8:11], v[76:79]
ds_read_b64_tr_b16 v[44:45], v9 offset:12288
v_mfma_f32_16x16x32_bf16 v[92:95], v[60:63], a[12:15], v[92:95]
s_waitcnt lgkmcnt(7)
ds_read_b64_tr_b16 v[46:47], v9 offset:12800
s_lshl_b32 s38, s25, 14
s_add_u32 s38, s38, 0x103400
buffer_load_dwordx4 a[104:107], v5, s[4:7], s38 offen sc1
s_lshl_b32 s38, s25, 14
s_add_u32 s38, s38, 0x107400
buffer_load_dwordx4 a[108:111], v5, s[4:7], s38 offen sc1
s_barrier
v_add_u32 v6, 0x8000, v6
v_add_u32 v7, 0x8000, v7
v_add_u32 v8, 0x8000, v8
v_add_u32 v9, 0x8000, v9
s_waitcnt vmcnt(29)
v_mfma_f32_16x16x32_bf16 v[64:67], v[16:19], a[16:19], v[64:67]
ds_read_b64_tr_b16 v[48:49], v6 offset:0
v_mfma_f32_16x16x32_bf16 v[80:83], v[16:19], a[20:23], v[80:83]
ds_read_b64_tr_b16 v[50:51], v6 offset:512
v_mfma_f32_16x16x32_bf16 v[68:71], v[20:23], a[16:19], v[68:71]
ds_read_b64_tr_b16 v[52:53], v7 offset:0
v_mfma_f32_16x16x32_bf16 v[84:87], v[20:23], a[20:23], v[84:87]
ds_read_b64_tr_b16 v[54:55], v7 offset:512
v_mfma_f32_16x16x32_bf16 v[72:75], v[24:27], a[16:19], v[72:75]
ds_read_b64_tr_b16 v[56:57], v8 offset:0
v_mfma_f32_16x16x32_bf16 v[88:91], v[24:27], a[20:23], v[88:91]
ds_read_b64_tr_b16 v[58:59], v8 offset:512
v_mfma_f32_16x16x32_bf16 v[76:79], v[28:31], a[16:19], v[76:79]
ds_read_b64_tr_b16 v[60:61], v9 offset:0
v_mfma_f32_16x16x32_bf16 v[92:95], v[28:31], a[20:23], v[92:95]
s_waitcnt lgkmcnt(7)
ds_read_b64_tr_b16 v[62:63], v9 offset:512
s_lshl_b32 s38, s25, 14
s_add_u32 s38, s38, 0x103800
buffer_load_dwordx4 a[112:115], v5, s[4:7], s38 offen sc1
s_lshl_b32 s38, s25, 14
s_add_u32 s38, s38, 0x107800
buffer_load_dwordx4 a[116:119], v5, s[4:7], s38 offen sc1
s_waitcnt vmcnt(28)
v_mfma_f32_16x16x32_bf16 v[64:67], v[32:35], a[24:27], v[64:67]
ds_read_b64_tr_b16 v[16:17], v6 offset:4096
v_mfma_f32_16x16x32_bf16 v[80:83], v[32:35], a[28:31], v[80:83]
ds_read_b64_tr_b16 v[18:19], v6 offset:4608
v_cvt_pk_bf16_f32 v96, v96, v97
v_mfma_f32_16x16x32_bf16 v[68:71], v[36:39], a[24:27], v[68:71]
ds_read_b64_tr_b16 v[20:21], v7 offset:4096
v_cvt_pk_bf16_f32 v97, v98, v99
v_mfma_f32_16x16x32_bf16 v[84:87], v[36:39], a[28:31], v[84:87]
ds_read_b64_tr_b16 v[22:23], v7 offset:4608
v_cvt_pk_bf16_f32 v98, v112, v113
v_mfma_f32_16x16x32_bf16 v[72:75], v[40:43], a[24:27], v[72:75]
ds_read_b64_tr_b16 v[24:25], v8 offset:4096
v_cvt_pk_bf16_f32 v99, v114, v115
v_mfma_f32_16x16x32_bf16 v[88:91], v[40:43], a[28:31], v[88:91]
ds_read_b64_tr_b16 v[26:27], v8 offset:4608
s_add_u32 s38, s54, 0x3101000
buffer_store_dwordx4 v[96:99], v5, s[4:7], s38 offen sc1
v_mfma_f32_16x16x32_bf16 v[76:79], v[44:47], a[24:27], v[76:79]
ds_read_b64_tr_b16 v[28:29], v9 offset:4096
v_mfma_f32_16x16x32_bf16 v[92:95], v[44:47], a[28:31], v[92:95]
s_waitcnt lgkmcnt(7)
ds_read_b64_tr_b16 v[30:31], v9 offset:4608
s_lshl_b32 s38, s25, 14
s_add_u32 s38, s38, 0x103c00
buffer_load_dwordx4 a[120:123], v5, s[4:7], s38 offen sc1
s_lshl_b32 s38, s25, 14
s_add_u32 s38, s38, 0x107c00
buffer_load_dwordx4 a[124:127], v5, s[4:7], s38 offen sc1
s_waitcnt vmcnt(29)
v_mfma_f32_16x16x32_bf16 v[64:67], v[48:51], a[32:35], v[64:67]
ds_read_b64_tr_b16 v[32:33], v6 offset:8192
v_mfma_f32_16x16x32_bf16 v[80:83], v[48:51], a[36:39], v[80:83]
ds_read_b64_tr_b16 v[34:35], v6 offset:8704
v_mfma_f32_16x16x32_bf16 v[68:71], v[52:55], a[32:35], v[68:71]
ds_read_b64_tr_b16 v[36:37], v7 offset:8192
v_mfma_f32_16x16x32_bf16 v[84:87], v[52:55], a[36:39], v[84:87]
ds_read_b64_tr_b16 v[38:39], v7 offset:8704
v_mfma_f32_16x16x32_bf16 v[72:75], v[56:59], a[32:35], v[72:75]
ds_read_b64_tr_b16 v[40:41], v8 offset:8192
v_mfma_f32_16x16x32_bf16 v[88:91], v[56:59], a[36:39], v[88:91]
ds_read_b64_tr_b16 v[42:43], v8 offset:8704
v_mfma_f32_16x16x32_bf16 v[76:79], v[60:63], a[32:35], v[76:79]
ds_read_b64_tr_b16 v[44:45], v9 offset:8192
v_mfma_f32_16x16x32_bf16 v[92:95], v[60:63], a[36:39], v[92:95]
s_waitcnt lgkmcnt(7)
ds_read_b64_tr_b16 v[46:47], v9 offset:8704
s_waitcnt vmcnt(27)
v_mfma_f32_16x16x32_bf16 v[64:67], v[16:19], a[40:43], v[64:67]
ds_read_b64_tr_b16 v[48:49], v6 offset:12288
v_mfma_f32_16x16x32_bf16 v[80:83], v[16:19], a[44:47], v[80:83]
ds_read_b64_tr_b16 v[50:51], v6 offset:12800
v_mfma_f32_16x16x32_bf16 v[68:71], v[20:23], a[40:43], v[68:71]
ds_read_b64_tr_b16 v[52:53], v7 offset:12288
v_mfma_f32_16x16x32_bf16 v[84:87], v[20:23], a[44:47], v[84:87]
ds_read_b64_tr_b16 v[54:55], v7 offset:12800
v_mfma_f32_16x16x32_bf16 v[72:75], v[24:27], a[40:43], v[72:75]
ds_read_b64_tr_b16 v[56:57], v8 offset:12288
v_mfma_f32_16x16x32_bf16 v[88:91], v[24:27], a[44:47], v[88:91]
ds_read_b64_tr_b16 v[58:59], v8 offset:12800
v_mfma_f32_16x16x32_bf16 v[76:79], v[28:31], a[40:43], v[76:79]
ds_read_b64_tr_b16 v[60:61], v9 offset:12288
v_mfma_f32_16x16x32_bf16 v[92:95], v[28:31], a[44:47], v[92:95]
s_waitcnt lgkmcnt(7)
ds_read_b64_tr_b16 v[62:63], v9 offset:12800
s_barrier
v_add_u32 v6, 0x4000, v6
v_add_u32 v7, 0x4000, v7
v_add_u32 v8, 0x4000, v8
v_add_u32 v9, 0x4000, v9
s_waitcnt vmcnt(23)
v_mfma_f32_16x16x32_bf16 v[64:67], v[32:35], a[48:51], v[64:67]
ds_read_b64_tr_b16 v[16:17], v6 offset:0
v_mfma_f32_16x16x32_bf16 v[80:83], v[32:35], a[52:55], v[80:83]
ds_read_b64_tr_b16 v[18:19], v6 offset:512
v_mfma_f32_16x16x32_bf16 v[68:71], v[36:39], a[48:51], v[68:71]
ds_read_b64_tr_b16 v[20:21], v7 offset:0
v_mfma_f32_16x16x32_bf16 v[84:87], v[36:39], a[52:55], v[84:87]
ds_read_b64_tr_b16 v[22:23], v7 offset:512
v_mfma_f32_16x16x32_bf16 v[72:75], v[40:43], a[48:51], v[72:75]
ds_read_b64_tr_b16 v[24:25], v8 offset:0
v_mfma_f32_16x16x32_bf16 v[88:91], v[40:43], a[52:55], v[88:91]
ds_read_b64_tr_b16 v[26:27], v8 offset:512
v_mfma_f32_16x16x32_bf16 v[76:79], v[44:47], a[48:51], v[76:79]
ds_read_b64_tr_b16 v[28:29], v9 offset:0
v_mfma_f32_16x16x32_bf16 v[92:95], v[44:47], a[52:55], v[92:95]
s_waitcnt lgkmcnt(7)
ds_read_b64_tr_b16 v[30:31], v9 offset:512
s_waitcnt vmcnt(20)
v_mfma_f32_16x16x32_bf16 v[64:67], v[48:51], a[56:59], v[64:67]
ds_read_b64_tr_b16 v[32:33], v6 offset:4096
v_mfma_f32_16x16x32_bf16 v[80:83], v[48:51], a[60:63], v[80:83]
ds_read_b64_tr_b16 v[34:35], v6 offset:4608
v_cvt_pk_bf16_f32 v100, v100, v101
v_mfma_f32_16x16x32_bf16 v[68:71], v[52:55], a[56:59], v[68:71]
ds_read_b64_tr_b16 v[36:37], v7 offset:4096
v_cvt_pk_bf16_f32 v101, v102, v103
v_mfma_f32_16x16x32_bf16 v[84:87], v[52:55], a[60:63], v[84:87]
ds_read_b64_tr_b16 v[38:39], v7 offset:4608
v_cvt_pk_bf16_f32 v102, v116, v117
v_mfma_f32_16x16x32_bf16 v[72:75], v[56:59], a[56:59], v[72:75]
ds_read_b64_tr_b16 v[40:41], v8 offset:4096
v_cvt_pk_bf16_f32 v103, v118, v119
v_mfma_f32_16x16x32_bf16 v[88:91], v[56:59], a[60:63], v[88:91]
ds_read_b64_tr_b16 v[42:43], v8 offset:4608
s_add_u32 s38, s54, 0x3101400
buffer_store_dwordx4 v[100:103], v5, s[4:7], s38 offen sc1
v_mfma_f32_16x16x32_bf16 v[76:79], v[60:63], a[56:59], v[76:79]
ds_read_b64_tr_b16 v[44:45], v9 offset:4096
v_mfma_f32_16x16x32_bf16 v[92:95], v[60:63], a[60:63], v[92:95]
s_waitcnt lgkmcnt(7)
ds_read_b64_tr_b16 v[46:47], v9 offset:4608
s_waitcnt vmcnt(19)
v_mfma_f32_16x16x32_bf16 v[64:67], v[16:19], a[64:67], v[64:67]
ds_read_b64_tr_b16 v[48:49], v6 offset:8192
v_mfma_f32_16x16x32_bf16 v[80:83], v[16:19], a[68:71], v[80:83]
ds_read_b64_tr_b16 v[50:51], v6 offset:8704
v_mfma_f32_16x16x32_bf16 v[68:71], v[20:23], a[64:67], v[68:71]
ds_read_b64_tr_b16 v[52:53], v7 offset:8192
v_mfma_f32_16x16x32_bf16 v[84:87], v[20:23], a[68:71], v[84:87]
ds_read_b64_tr_b16 v[54:55], v7 offset:8704
v_mfma_f32_16x16x32_bf16 v[72:75], v[24:27], a[64:67], v[72:75]
ds_read_b64_tr_b16 v[56:57], v8 offset:8192
v_mfma_f32_16x16x32_bf16 v[88:91], v[24:27], a[68:71], v[88:91]
ds_read_b64_tr_b16 v[58:59], v8 offset:8704
v_mfma_f32_16x16x32_bf16 v[76:79], v[28:31], a[64:67], v[76:79]
ds_read_b64_tr_b16 v[60:61], v9 offset:8192
v_mfma_f32_16x16x32_bf16 v[92:95], v[28:31], a[68:71], v[92:95]
s_waitcnt lgkmcnt(7)
ds_read_b64_tr_b16 v[62:63], v9 offset:8704
s_waitcnt vmcnt(17)
v_mfma_f32_16x16x32_bf16 v[64:67], v[32:35], a[72:75], v[64:67]
ds_read_b64_tr_b16 v[16:17], v6 offset:12288
v_mfma_f32_16x16x32_bf16 v[80:83], v[32:35], a[76:79], v[80:83]
ds_read_b64_tr_b16 v[18:19], v6 offset:12800
v_mfma_f32_16x16x32_bf16 v[68:71], v[36:39], a[72:75], v[68:71]
ds_read_b64_tr_b16 v[20:21], v7 offset:12288
v_mfma_f32_16x16x32_bf16 v[84:87], v[36:39], a[76:79], v[84:87]
ds_read_b64_tr_b16 v[22:23], v7 offset:12800
v_mfma_f32_16x16x32_bf16 v[72:75], v[40:43], a[72:75], v[72:75]
ds_read_b64_tr_b16 v[24:25], v8 offset:12288
v_mfma_f32_16x16x32_bf16 v[88:91], v[40:43], a[76:79], v[88:91]
ds_read_b64_tr_b16 v[26:27], v8 offset:12800
v_mfma_f32_16x16x32_bf16 v[76:79], v[44:47], a[72:75], v[76:79]
ds_read_b64_tr_b16 v[28:29], v9 offset:12288
v_mfma_f32_16x16x32_bf16 v[92:95], v[44:47], a[76:79], v[92:95]
s_waitcnt lgkmcnt(7)
ds_read_b64_tr_b16 v[30:31], v9 offset:12800
s_barrier
v_add_u32 v6, 0xffff8000, v6
v_add_u32 v7, 0xffff8000, v7
v_add_u32 v8, 0xffff8000, v8
v_add_u32 v9, 0xffff8000, v9
s_waitcnt vmcnt(13)
v_mfma_f32_16x16x32_bf16 v[64:67], v[48:51], a[80:83], v[64:67]
ds_read_b64_tr_b16 v[32:33], v6 offset:0
v_mfma_f32_16x16x32_bf16 v[80:83], v[48:51], a[84:87], v[80:83]
ds_read_b64_tr_b16 v[34:35], v6 offset:512
v_mfma_f32_16x16x32_bf16 v[68:71], v[52:55], a[80:83], v[68:71]
ds_read_b64_tr_b16 v[36:37], v7 offset:0
v_mfma_f32_16x16x32_bf16 v[84:87], v[52:55], a[84:87], v[84:87]
ds_read_b64_tr_b16 v[38:39], v7 offset:512
v_mfma_f32_16x16x32_bf16 v[72:75], v[56:59], a[80:83], v[72:75]
ds_read_b64_tr_b16 v[40:41], v8 offset:0
v_mfma_f32_16x16x32_bf16 v[88:91], v[56:59], a[84:87], v[88:91]
ds_read_b64_tr_b16 v[42:43], v8 offset:512
v_mfma_f32_16x16x32_bf16 v[76:79], v[60:63], a[80:83], v[76:79]
ds_read_b64_tr_b16 v[44:45], v9 offset:0
v_mfma_f32_16x16x32_bf16 v[92:95], v[60:63], a[84:87], v[92:95]
s_waitcnt lgkmcnt(7)
ds_read_b64_tr_b16 v[46:47], v9 offset:512
s_waitcnt vmcnt(10)
v_mfma_f32_16x16x32_bf16 v[64:67], v[16:19], a[88:91], v[64:67]
ds_read_b64_tr_b16 v[48:49], v6 offset:4096
v_mfma_f32_16x16x32_bf16 v[80:83], v[16:19], a[92:95], v[80:83]
ds_read_b64_tr_b16 v[50:51], v6 offset:4608
v_cvt_pk_bf16_f32 v104, v104, v105
v_mfma_f32_16x16x32_bf16 v[68:71], v[20:23], a[88:91], v[68:71]
ds_read_b64_tr_b16 v[52:53], v7 offset:4096
v_cvt_pk_bf16_f32 v105, v106, v107
v_mfma_f32_16x16x32_bf16 v[84:87], v[20:23], a[92:95], v[84:87]
ds_read_b64_tr_b16 v[54:55], v7 offset:4608
v_cvt_pk_bf16_f32 v106, v120, v121
v_mfma_f32_16x16x32_bf16 v[72:75], v[24:27], a[88:91], v[72:75]
ds_read_b64_tr_b16 v[56:57], v8 offset:4096
v_cvt_pk_bf16_f32 v107, v122, v123
v_mfma_f32_16x16x32_bf16 v[88:91], v[24:27], a[92:95], v[88:91]
ds_read_b64_tr_b16 v[58:59], v8 offset:4608
s_add_u32 s38, s54, 0x3101800
buffer_store_dwordx4 v[104:107], v5, s[4:7], s38 offen sc1
v_mfma_f32_16x16x32_bf16 v[76:79], v[28:31], a[88:91], v[76:79]
ds_read_b64_tr_b16 v[60:61], v9 offset:4096
v_mfma_f32_16x16x32_bf16 v[92:95], v[28:31], a[92:95], v[92:95]
s_waitcnt lgkmcnt(7)
ds_read_b64_tr_b16 v[62:63], v9 offset:4608
s_waitcnt vmcnt(9)
v_mfma_f32_16x16x32_bf16 v[64:67], v[32:35], a[96:99], v[64:67]
ds_read_b64_tr_b16 v[16:17], v6 offset:8192
v_mfma_f32_16x16x32_bf16 v[80:83], v[32:35], a[100:103], v[80:83]
ds_read_b64_tr_b16 v[18:19], v6 offset:8704
v_mfma_f32_16x16x32_bf16 v[68:71], v[36:39], a[96:99], v[68:71]
ds_read_b64_tr_b16 v[20:21], v7 offset:8192
v_mfma_f32_16x16x32_bf16 v[84:87], v[36:39], a[100:103], v[84:87]
ds_read_b64_tr_b16 v[22:23], v7 offset:8704
v_mfma_f32_16x16x32_bf16 v[72:75], v[40:43], a[96:99], v[72:75]
ds_read_b64_tr_b16 v[24:25], v8 offset:8192
v_mfma_f32_16x16x32_bf16 v[88:91], v[40:43], a[100:103], v[88:91]
ds_read_b64_tr_b16 v[26:27], v8 offset:8704
v_mfma_f32_16x16x32_bf16 v[76:79], v[44:47], a[96:99], v[76:79]
ds_read_b64_tr_b16 v[28:29], v9 offset:8192
v_mfma_f32_16x16x32_bf16 v[92:95], v[44:47], a[100:103], v[92:95]
s_waitcnt lgkmcnt(7)
ds_read_b64_tr_b16 v[30:31], v9 offset:8704
s_waitcnt vmcnt(7)
v_mfma_f32_16x16x32_bf16 v[64:67], v[48:51], a[104:107], v[64:67]
ds_read_b64_tr_b16 v[32:33], v6 offset:12288
v_mfma_f32_16x16x32_bf16 v[80:83], v[48:51], a[108:111], v[80:83]
ds_read_b64_tr_b16 v[34:35], v6 offset:12800
v_mfma_f32_16x16x32_bf16 v[68:71], v[52:55], a[104:107], v[68:71]
ds_read_b64_tr_b16 v[36:37], v7 offset:12288
v_mfma_f32_16x16x32_bf16 v[84:87], v[52:55], a[108:111], v[84:87]
ds_read_b64_tr_b16 v[38:39], v7 offset:12800
v_mfma_f32_16x16x32_bf16 v[72:75], v[56:59], a[104:107], v[72:75]
ds_read_b64_tr_b16 v[40:41], v8 offset:12288
v_mfma_f32_16x16x32_bf16 v[88:91], v[56:59], a[108:111], v[88:91]
ds_read_b64_tr_b16 v[42:43], v8 offset:12800
v_mfma_f32_16x16x32_bf16 v[76:79], v[60:63], a[104:107], v[76:79]
ds_read_b64_tr_b16 v[44:45], v9 offset:12288
v_mfma_f32_16x16x32_bf16 v[92:95], v[60:63], a[108:111], v[92:95]
s_waitcnt lgkmcnt(7)
ds_read_b64_tr_b16 v[46:47], v9 offset:12800
s_barrier
v_add_u32 v6, 0xc000, v6
v_add_u32 v7, 0xc000, v7
v_add_u32 v8, 0xc000, v8
v_add_u32 v9, 0xc000, v9
s_waitcnt vmcnt(5)
v_mfma_f32_16x16x32_bf16 v[64:67], v[16:19], a[112:115], v[64:67]
ds_read_b64_tr_b16 v[48:49], v6 offset:0
v_mfma_f32_16x16x32_bf16 v[80:83], v[16:19], a[116:119], v[80:83]
ds_read_b64_tr_b16 v[50:51], v6 offset:512
v_mfma_f32_16x16x32_bf16 v[68:71], v[20:23], a[112:115], v[68:71]
ds_read_b64_tr_b16 v[52:53], v7 offset:0
v_mfma_f32_16x16x32_bf16 v[84:87], v[20:23], a[116:119], v[84:87]
ds_read_b64_tr_b16 v[54:55], v7 offset:512
v_mfma_f32_16x16x32_bf16 v[72:75], v[24:27], a[112:115], v[72:75]
ds_read_b64_tr_b16 v[56:57], v8 offset:0
v_mfma_f32_16x16x32_bf16 v[88:91], v[24:27], a[116:119], v[88:91]
ds_read_b64_tr_b16 v[58:59], v8 offset:512
v_mfma_f32_16x16x32_bf16 v[76:79], v[28:31], a[112:115], v[76:79]
ds_read_b64_tr_b16 v[60:61], v9 offset:0
v_mfma_f32_16x16x32_bf16 v[92:95], v[28:31], a[116:119], v[92:95]
s_waitcnt lgkmcnt(7)
ds_read_b64_tr_b16 v[62:63], v9 offset:512
s_waitcnt vmcnt(2)
v_mfma_f32_16x16x32_bf16 v[64:67], v[32:35], a[120:123], v[64:67]
ds_read_b64_tr_b16 v[16:17], v6 offset:4096
v_mfma_f32_16x16x32_bf16 v[80:83], v[32:35], a[124:127], v[80:83]
ds_read_b64_tr_b16 v[18:19], v6 offset:4608
v_cvt_pk_bf16_f32 v108, v108, v109
v_mfma_f32_16x16x32_bf16 v[68:71], v[36:39], a[120:123], v[68:71]
ds_read_b64_tr_b16 v[20:21], v7 offset:4096
v_cvt_pk_bf16_f32 v109, v110, v111
v_mfma_f32_16x16x32_bf16 v[84:87], v[36:39], a[124:127], v[84:87]
ds_read_b64_tr_b16 v[22:23], v7 offset:4608
v_cvt_pk_bf16_f32 v110, v124, v125
v_mfma_f32_16x16x32_bf16 v[72:75], v[40:43], a[120:123], v[72:75]
ds_read_b64_tr_b16 v[24:25], v8 offset:4096
v_cvt_pk_bf16_f32 v111, v126, v127
v_mfma_f32_16x16x32_bf16 v[88:91], v[40:43], a[124:127], v[88:91]
ds_read_b64_tr_b16 v[26:27], v8 offset:4608
s_add_u32 s38, s54, 0x3101c00
buffer_store_dwordx4 v[108:111], v5, s[4:7], s38 offen sc1
v_mfma_f32_16x16x32_bf16 v[76:79], v[44:47], a[120:123], v[76:79]
ds_read_b64_tr_b16 v[28:29], v9 offset:4096
v_mfma_f32_16x16x32_bf16 v[92:95], v[44:47], a[124:127], v[92:95]
s_waitcnt lgkmcnt(7)
ds_read_b64_tr_b16 v[30:31], v9 offset:4608
v_mfma_f32_16x16x32_bf16 v[96:99], v[48:51], a[0:3], 0
ds_read_b64_tr_b16 v[32:33], v6 offset:8192
v_mfma_f32_16x16x32_bf16 v[112:115], v[48:51], a[4:7], 0
ds_read_b64_tr_b16 v[34:35], v6 offset:8704
v_mfma_f32_16x16x32_bf16 v[100:103], v[52:55], a[0:3], 0
ds_read_b64_tr_b16 v[36:37], v7 offset:8192
v_mfma_f32_16x16x32_bf16 v[116:119], v[52:55], a[4:7], 0
ds_read_b64_tr_b16 v[38:39], v7 offset:8704
v_mfma_f32_16x16x32_bf16 v[104:107], v[56:59], a[0:3], 0
ds_read_b64_tr_b16 v[40:41], v8 offset:8192
v_mfma_f32_16x16x32_bf16 v[120:123], v[56:59], a[4:7], 0
ds_read_b64_tr_b16 v[42:43], v8 offset:8704
v_mfma_f32_16x16x32_bf16 v[108:111], v[60:63], a[0:3], 0
ds_read_b64_tr_b16 v[44:45], v9 offset:8192
v_mfma_f32_16x16x32_bf16 v[124:127], v[60:63], a[4:7], 0
s_waitcnt lgkmcnt(7)
ds_read_b64_tr_b16 v[46:47], v9 offset:8704
v_mfma_f32_16x16x32_bf16 v[96:99], v[16:19], a[8:11], v[96:99]
ds_read_b64_tr_b16 v[48:49], v6 offset:12288
v_mfma_f32_16x16x32_bf16 v[112:115], v[16:19], a[12:15], v[112:115]
ds_read_b64_tr_b16 v[50:51], v6 offset:12800
v_mfma_f32_16x16x32_bf16 v[100:103], v[20:23], a[8:11], v[100:103]
ds_read_b64_tr_b16 v[52:53], v7 offset:12288
v_mfma_f32_16x16x32_bf16 v[116:119], v[20:23], a[12:15], v[116:119]
ds_read_b64_tr_b16 v[54:55], v7 offset:12800
v_mfma_f32_16x16x32_bf16 v[104:107], v[24:27], a[8:11], v[104:107]
ds_read_b64_tr_b16 v[56:57], v8 offset:12288
v_mfma_f32_16x16x32_bf16 v[120:123], v[24:27], a[12:15], v[120:123]
ds_read_b64_tr_b16 v[58:59], v8 offset:12800
v_mfma_f32_16x16x32_bf16 v[108:111], v[28:31], a[8:11], v[108:111]
ds_read_b64_tr_b16 v[60:61], v9 offset:12288
v_mfma_f32_16x16x32_bf16 v[124:127], v[28:31], a[12:15], v[124:127]
s_waitcnt lgkmcnt(7)
ds_read_b64_tr_b16 v[62:63], v9 offset:12800
s_waitcnt vmcnt(0)
s_barrier
s_lshl_b32 s40, s84, 7
s_add_u32 s40, s40, 0x20400
s_cmp_eq_u32 s20, 0
s_cselect_b32 s38, s40, s86
v_mov_b32 v1, 1
s_mov_b64 exec, 1
buffer_atomic_add v1, off, s[4:7], s38 sc1
s_mov_b64 exec, -1
v_add_u32 v6, 0x4000, v6
v_add_u32 v7, 0x4000, v7
v_add_u32 v8, 0x4000, v8
v_add_u32 v9, 0x4000, v9
v_mfma_f32_16x16x32_bf16 v[96:99], v[32:35], a[16:19], v[96:99]
ds_read_b64_tr_b16 v[16:17], v6 offset:0
v_mfma_f32_16x16x32_bf16 v[112:115], v[32:35], a[20:23], v[112:115]
ds_read_b64_tr_b16 v[18:19], v6 offset:512
v_mfma_f32_16x16x32_bf16 v[100:103], v[36:39], a[16:19], v[100:103]
ds_read_b64_tr_b16 v[20:21], v7 offset:0
v_mfma_f32_16x16x32_bf16 v[116:119], v[36:39], a[20:23], v[116:119]
ds_read_b64_tr_b16 v[22:23], v7 offset:512
v_mfma_f32_16x16x32_bf16 v[104:107], v[40:43], a[16:19], v[104:107]
ds_read_b64_tr_b16 v[24:25], v8 offset:0
v_mfma_f32_16x16x32_bf16 v[120:123], v[40:43], a[20:23], v[120:123]
ds_read_b64_tr_b16 v[26:27], v8 offset:512
v_mfma_f32_16x16x32_bf16 v[108:111], v[44:47], a[16:19], v[108:111]
ds_read_b64_tr_b16 v[28:29], v9 offset:0
v_mfma_f32_16x16x32_bf16 v[124:127], v[44:47], a[20:23], v[124:127]
s_waitcnt lgkmcnt(7)
ds_read_b64_tr_b16 v[30:31], v9 offset:512
v_mfma_f32_16x16x32_bf16 v[96:99], v[48:51], a[24:27], v[96:99]
ds_read_b64_tr_b16 v[32:33], v6 offset:4096
v_mfma_f32_16x16x32_bf16 v[112:115], v[48:51], a[28:31], v[112:115]
ds_read_b64_tr_b16 v[34:35], v6 offset:4608
v_mfma_f32_16x16x32_bf16 v[100:103], v[52:55], a[24:27], v[100:103]
ds_read_b64_tr_b16 v[36:37], v7 offset:4096
v_mfma_f32_16x16x32_bf16 v[116:119], v[52:55], a[28:31], v[116:119]
ds_read_b64_tr_b16 v[38:39], v7 offset:4608
v_mfma_f32_16x16x32_bf16 v[104:107], v[56:59], a[24:27], v[104:107]
ds_read_b64_tr_b16 v[40:41], v8 offset:4096
v_mfma_f32_16x16x32_bf16 v[120:123], v[56:59], a[28:31], v[120:123]
ds_read_b64_tr_b16 v[42:43], v8 offset:4608
v_mfma_f32_16x16x32_bf16 v[108:111], v[60:63], a[24:27], v[108:111]
ds_read_b64_tr_b16 v[44:45], v9 offset:4096
v_mfma_f32_16x16x32_bf16 v[124:127], v[60:63], a[28:31], v[124:127]
s_waitcnt lgkmcnt(7)
ds_read_b64_tr_b16 v[46:47], v9 offset:4608
v_mfma_f32_16x16x32_bf16 v[96:99], v[16:19], a[32:35], v[96:99]
ds_read_b64_tr_b16 v[48:49], v6 offset:8192
v_cvt_pk_bf16_f32 v12, v64, v65
v_cvt_pk_bf16_f32 v13, v66, v67
v_mfma_f32_16x16x32_bf16 v[112:115], v[16:19], a[36:39], v[112:115]
ds_read_b64_tr_b16 v[50:51], v6 offset:8704
v_cvt_pk_bf16_f32 v14, v68, v69
v_cvt_pk_bf16_f32 v15, v70, v71
v_mfma_f32_16x16x32_bf16 v[100:103], v[20:23], a[32:35], v[100:103]
ds_read_b64_tr_b16 v[52:53], v7 offset:8192
v_accvgpr_write_b32 a0, v12
v_accvgpr_write_b32 a1, v13
v_mfma_f32_16x16x32_bf16 v[116:119], v[20:23], a[36:39], v[116:119]
ds_read_b64_tr_b16 v[54:55], v7 offset:8704
v_accvgpr_write_b32 a2, v14
v_accvgpr_write_b32 a3, v15
v_mfma_f32_16x16x32_bf16 v[104:107], v[24:27], a[32:35], v[104:107]
ds_read_b64_tr_b16 v[56:57], v8 offset:8192
v_cvt_pk_bf16_f32 v12, v72, v73
v_cvt_pk_bf16_f32 v13, v74, v75
v_mfma_f32_16x16x32_bf16 v[120:123], v[24:27], a[36:39], v[120:123]
ds_read_b64_tr_b16 v[58:59], v8 offset:8704
v_cvt_pk_bf16_f32 v14, v76, v77
v_cvt_pk_bf16_f32 v15, v78, v79
v_mfma_f32_16x16x32_bf16 v[108:111], v[28:31], a[32:35], v[108:111]
ds_read_b64_tr_b16 v[60:61], v9 offset:8192
v_accvgpr_write_b32 a4, v12
v_accvgpr_write_b32 a5, v13
v_mfma_f32_16x16x32_bf16 v[124:127], v[28:31], a[36:39], v[124:127]
s_waitcnt lgkmcnt(7)
ds_read_b64_tr_b16 v[62:63], v9 offset:8704
v_accvgpr_write_b32 a6, v14
v_accvgpr_write_b32 a7, v15
v_mfma_f32_16x16x32_bf16 v[96:99], v[32:35], a[40:43], v[96:99]
ds_read_b64_tr_b16 v[16:17], v6 offset:12288
v_cvt_pk_bf16_f32 v12, v80, v81
v_cvt_pk_bf16_f32 v13, v82, v83
v_mfma_f32_16x16x32_bf16 v[112:115], v[32:35], a[44:47], v[112:115]
ds_read_b64_tr_b16 v[18:19], v6 offset:12800
v_cvt_pk_bf16_f32 v14, v84, v85
v_cvt_pk_bf16_f32 v15, v86, v87
v_mfma_f32_16x16x32_bf16 v[100:103], v[36:39], a[40:43], v[100:103]
ds_read_b64_tr_b16 v[20:21], v7 offset:12288
v_accvgpr_write_b32 a16, v12
v_accvgpr_write_b32 a17, v13
v_mfma_f32_16x16x32_bf16 v[116:119], v[36:39], a[44:47], v[116:119]
ds_read_b64_tr_b16 v[22:23], v7 offset:12800
v_accvgpr_write_b32 a18, v14
v_accvgpr_write_b32 a19, v15
v_mfma_f32_16x16x32_bf16 v[104:107], v[40:43], a[40:43], v[104:107]
ds_read_b64_tr_b16 v[24:25], v8 offset:12288
v_cvt_pk_bf16_f32 v12, v88, v89
v_cvt_pk_bf16_f32 v13, v90, v91
v_mfma_f32_16x16x32_bf16 v[120:123], v[40:43], a[44:47], v[120:123]
ds_read_b64_tr_b16 v[26:27], v8 offset:12800
v_cvt_pk_bf16_f32 v14, v92, v93
v_cvt_pk_bf16_f32 v15, v94, v95
v_mfma_f32_16x16x32_bf16 v[108:111], v[44:47], a[40:43], v[108:111]
ds_read_b64_tr_b16 v[28:29], v9 offset:12288
v_accvgpr_write_b32 a20, v12
v_accvgpr_write_b32 a21, v13
v_mfma_f32_16x16x32_bf16 v[124:127], v[44:47], a[44:47], v[124:127]
s_waitcnt lgkmcnt(7)
ds_read_b64_tr_b16 v[30:31], v9 offset:12800
v_accvgpr_write_b32 a22, v14
v_accvgpr_write_b32 a23, v15
s_barrier
s_lshl_b32 s37, s21, 7
s_add_u32 s37, s37, 0x20400
s_cmp_eq_u32 s20, 0
s_cselect_b32 s38, s37, s86
buffer_load_dword v2, off, s[4:7], s38 sc1
v_add_u32 v6, 0x4000, v6
v_add_u32 v7, 0x4000, v7
v_add_u32 v8, 0x4000, v8
v_add_u32 v9, 0x4000, v9
v_mfma_f32_16x16x32_bf16 v[96:99], v[48:51], a[48:51], v[96:99]
ds_read_b64_tr_b16 v[32:33], v6 offset:0
v_mfma_f32_16x16x32_bf16 v[112:115], v[48:51], a[52:55], v[112:115]
ds_read_b64_tr_b16 v[34:35], v6 offset:512
v_mfma_f32_16x16x32_bf16 v[100:103], v[52:55], a[48:51], v[100:103]
ds_read_b64_tr_b16 v[36:37], v7 offset:0
v_mfma_f32_16x16x32_bf16 v[116:119], v[52:55], a[52:55], v[116:119]
ds_read_b64_tr_b16 v[38:39], v7 offset:512
v_mfma_f32_16x16x32_bf16 v[104:107], v[56:59], a[48:51], v[104:107]
ds_read_b64_tr_b16 v[40:41], v8 offset:0
v_mfma_f32_16x16x32_bf16 v[120:123], v[56:59], a[52:55], v[120:123]
ds_read_b64_tr_b16 v[42:43], v8 offset:512
v_mfma_f32_16x16x32_bf16 v[108:111], v[60:63], a[48:51], v[108:111]
ds_read_b64_tr_b16 v[44:45], v9 offset:0
v_mfma_f32_16x16x32_bf16 v[124:127], v[60:63], a[52:55], v[124:127]
s_waitcnt lgkmcnt(7)
ds_read_b64_tr_b16 v[46:47], v9 offset:512
v_mfma_f32_16x16x32_bf16 v[96:99], v[16:19], a[56:59], v[96:99]
ds_read_b64_tr_b16 v[48:49], v6 offset:4096
v_mfma_f32_16x16x32_bf16 v[112:115], v[16:19], a[60:63], v[112:115]
ds_read_b64_tr_b16 v[50:51], v6 offset:4608
v_mfma_f32_16x16x32_bf16 v[100:103], v[20:23], a[56:59], v[100:103]
ds_read_b64_tr_b16 v[52:53], v7 offset:4096
v_mfma_f32_16x16x32_bf16 v[116:119], v[20:23], a[60:63], v[116:119]
ds_read_b64_tr_b16 v[54:55], v7 offset:4608
v_mfma_f32_16x16x32_bf16 v[104:107], v[24:27], a[56:59], v[104:107]
ds_read_b64_tr_b16 v[56:57], v8 offset:4096
v_mfma_f32_16x16x32_bf16 v[120:123], v[24:27], a[60:63], v[120:123]
ds_read_b64_tr_b16 v[58:59], v8 offset:4608
v_mfma_f32_16x16x32_bf16 v[108:111], v[28:31], a[56:59], v[108:111]
ds_read_b64_tr_b16 v[60:61], v9 offset:4096
v_mfma_f32_16x16x32_bf16 v[124:127], v[28:31], a[60:63], v[124:127]
s_waitcnt lgkmcnt(7)
ds_read_b64_tr_b16 v[62:63], v9 offset:4608
v_mfma_f32_16x16x32_bf16 v[96:99], v[32:35], a[64:67], v[96:99]
ds_read_b64_tr_b16 v[16:17], v6 offset:8192
v_mfma_f32_16x16x32_bf16 v[112:115], v[32:35], a[68:71], v[112:115]
ds_read_b64_tr_b16 v[18:19], v6 offset:8704
v_mfma_f32_16x16x32_bf16 v[100:103], v[36:39], a[64:67], v[100:103]
ds_read_b64_tr_b16 v[20:21], v7 offset:8192
v_mfma_f32_16x16x32_bf16 v[116:119], v[36:39], a[68:71], v[116:119]
ds_read_b64_tr_b16 v[22:23], v7 offset:8704
v_mfma_f32_16x16x32_bf16 v[104:107], v[40:43], a[64:67], v[104:107]
ds_read_b64_tr_b16 v[24:25], v8 offset:8192
v_mfma_f32_16x16x32_bf16 v[120:123], v[40:43], a[68:71], v[120:123]
ds_read_b64_tr_b16 v[26:27], v8 offset:8704
v_mfma_f32_16x16x32_bf16 v[108:111], v[44:47], a[64:67], v[108:111]
ds_read_b64_tr_b16 v[28:29], v9 offset:8192
v_mfma_f32_16x16x32_bf16 v[124:127], v[44:47], a[68:71], v[124:127]
s_waitcnt lgkmcnt(7)
ds_read_b64_tr_b16 v[30:31], v9 offset:8704
v_mfma_f32_16x16x32_bf16 v[96:99], v[48:51], a[72:75], v[96:99]
ds_read_b64_tr_b16 v[32:33], v6 offset:12288
v_mfma_f32_16x16x32_bf16 v[112:115], v[48:51], a[76:79], v[112:115]
ds_read_b64_tr_b16 v[34:35], v6 offset:12800
v_mfma_f32_16x16x32_bf16 v[100:103], v[52:55], a[72:75], v[100:103]
ds_read_b64_tr_b16 v[36:37], v7 offset:12288
v_mfma_f32_16x16x32_bf16 v[116:119], v[52:55], a[76:79], v[116:119]
ds_read_b64_tr_b16 v[38:39], v7 offset:12800
v_mfma_f32_16x16x32_bf16 v[104:107], v[56:59], a[72:75], v[104:107]
ds_read_b64_tr_b16 v[40:41], v8 offset:12288
v_mfma_f32_16x16x32_bf16 v[120:123], v[56:59], a[76:79], v[120:123]
ds_read_b64_tr_b16 v[42:43], v8 offset:12800
v_mfma_f32_16x16x32_bf16 v[108:111], v[60:63], a[72:75], v[108:111]
ds_read_b64_tr_b16 v[44:45], v9 offset:12288
v_mfma_f32_16x16x32_bf16 v[124:127], v[60:63], a[76:79], v[124:127]
s_waitcnt lgkmcnt(7)
ds_read_b64_tr_b16 v[46:47], v9 offset:12800
s_waitcnt vmcnt(0)
s_cmp_lg_u32 s20, 0
s_cbranch_scc1 L_pok_1009
v_readfirstlane_b32 s38, v2
s_nop 3
s_cmp_ge_u32 s38, 8
s_cbranch_scc1 L_pok_1009
s_mov_b32 s39, 0x40000
L_ploop_1010:
s_sleep 4
buffer_load_dword v2, off, s[4:7], s37 sc1
s_waitcnt vmcnt(0)
v_readfirstlane_b32 s38, v2
s_nop 3
s_cmp_ge_u32 s38, 8
s_cbranch_scc1 L_pok_1009
s_sub_u32 s39, s39, 1
s_cmp_lg_u32 s39, 0
s_cbranch_scc1 L_ploop_1010
L_pok_1009:
s_barrier
s_add_u32 s35, s30, 0
s_add_u32 s36, s31, 0
s_cmp_eq_u32 s23, 0
s_cselect_b32 s35, s35, s36
s_lshl_b32 s38, s23, 14
s_add_u32 s38, s38, s34
s_add_u32 m0, s38, 0
s_nop 0
buffer_load_dwordx4 v5, s[4:7], s35 offen offset:0 sc1 lds
buffer_load_dwordx4 v5, s[4:7], s35 offen offset:1024 sc1 lds
buffer_load_dwordx4 v5, s[4:7], s35 offen offset:2048 sc1 lds
buffer_load_dwordx4 v5, s[4:7], s35 offen offset:3072 sc1 lds
s_add_u32 s35, s30, 16384
s_add_u32 s36, s31, 0
s_cmp_eq_u32 s23, 0
s_cselect_b32 s35, s35, s36
s_lshl_b32 s38, s23, 14
s_add_u32 s38, s38, s34
s_add_u32 m0, s38, 32768
s_nop 0
buffer_load_dwordx4 v5, s[4:7], s35 offen offset:0 sc1 lds
buffer_load_dwordx4 v5, s[4:7], s35 offen offset:1024 sc1 lds
buffer_load_dwordx4 v5, s[4:7], s35 offen offset:2048 sc1 lds
buffer_load_dwordx4 v5, s[4:7], s35 offen offset:3072 sc1 lds
s_add_u32 s35, s30, 32768
s_add_u32 s36, s31, 16384
s_cmp_eq_u32 s23, 0
s_cselect_b32 s35, s35, s36
s_lshl_b32 s38, s23, 14
s_add_u32 s38, s38, s34
s_add_u32 m0, s38, 65536
s_nop 0
buffer_load_dwordx4 v5, s[4:7], s35 offen offset:0 sc1 lds
buffer_load_dwordx4 v5, s[4:7], s35 offen offset:1024 sc1 lds
buffer_load_dwordx4 v5, s[4:7], s35 offen offset:2048 sc1 lds
buffer_load_dwordx4 v5, s[4:7], s35 offen offset:3072 sc1 lds
v_add_u32 v6, 0x4000, v6
v_add_u32 v7, 0x4000, v7
v_add_u32 v8, 0x4000, v8
v_add_u32 v9, 0x4000, v9
v_mfma_f32_16x16x32_bf16 v[96:99], v[16:19], a[80:83], v[96:99]
ds_read_b64_tr_b16 v[48:49], v6 offset:0
v_mfma_f32_16x16x32_bf16 v[112:115], v[16:19], a[84:87], v[112:115]
ds_read_b64_tr_b16 v[50:51], v6 offset:512
v_mfma_f32_16x16x32_bf16 v[100:103], v[20:23], a[80:83], v[100:103]
ds_read_b64_tr_b16 v[52:53], v7 offset:0
v_mfma_f32_16x16x32_bf16 v[116:119], v[20:23], a[84:87], v[116:119]
ds_read_b64_tr_b16 v[54:55], v7 offset:512
v_mfma_f32_16x16x32_bf16 v[104:107], v[24:27], a[80:83], v[104:107]
ds_read_b64_tr_b16 v[56:57], v8 offset:0
v_mfma_f32_16x16x32_bf16 v[120:123], v[24:27], a[84:87], v[120:123]
ds_read_b64_tr_b16 v[58:59], v8 offset:512
v_mfma_f32_16x16x32_bf16 v[108:111], v[28:31], a[80:83], v[108:111]
ds_read_b64_tr_b16 v[60:61], v9 offset:0
v_mfma_f32_16x16x32_bf16 v[124:127], v[28:31], a[84:87], v[124:127]
s_waitcnt lgkmcnt(7)
ds_read_b64_tr_b16 v[62:63], v9 offset:512
v_mfma_f32_16x16x32_bf16 v[96:99], v[32:35], a[88:91], v[96:99]
ds_read_b64_tr_b16 v[16:17], v6 offset:4096
v_mfma_f32_16x16x32_bf16 v[112:115], v[32:35], a[92:95], v[112:115]
ds_read_b64_tr_b16 v[18:19], v6 offset:4608
v_mfma_f32_16x16x32_bf16 v[100:103], v[36:39], a[88:91], v[100:103]
ds_read_b64_tr_b16 v[20:21], v7 offset:4096
v_mfma_f32_16x16x32_bf16 v[116:119], v[36:39], a[92:95], v[116:119]
ds_read_b64_tr_b16 v[22:23], v7 offset:4608
v_mfma_f32_16x16x32_bf16 v[104:107], v[40:43], a[88:91], v[104:107]
ds_read_b64_tr_b16 v[24:25], v8 offset:4096
v_mfma_f32_16x16x32_bf16 v[120:123], v[40:43], a[92:95], v[120:123]
ds_read_b64_tr_b16 v[26:27], v8 offset:4608
v_mfma_f32_16x16x32_bf16 v[108:111], v[44:47], a[88:91], v[108:111]
ds_read_b64_tr_b16 v[28:29], v9 offset:4096
v_mfma_f32_16x16x32_bf16 v[124:127], v[44:47], a[92:95], v[124:127]
s_waitcnt lgkmcnt(7)
ds_read_b64_tr_b16 v[30:31], v9 offset:4608
v_mfma_f32_16x16x32_bf16 v[96:99], v[48:51], a[96:99], v[96:99]
ds_read_b64_tr_b16 v[32:33], v6 offset:8192
v_mfma_f32_16x16x32_bf16 v[112:115], v[48:51], a[100:103], v[112:115]
ds_read_b64_tr_b16 v[34:35], v6 offset:8704
v_mfma_f32_16x16x32_bf16 v[100:103], v[52:55], a[96:99], v[100:103]
ds_read_b64_tr_b16 v[36:37], v7 offset:8192
v_mfma_f32_16x16x32_bf16 v[116:119], v[52:55], a[100:103], v[116:119]
ds_read_b64_tr_b16 v[38:39], v7 offset:8704
v_mfma_f32_16x16x32_bf16 v[104:107], v[56:59], a[96:99], v[104:107]
ds_read_b64_tr_b16 v[40:41], v8 offset:8192
v_mfma_f32_16x16x32_bf16 v[120:123], v[56:59], a[100:103], v[120:123]
ds_read_b64_tr_b16 v[42:43], v8 offset:8704
v_mfma_f32_16x16x32_bf16 v[108:111], v[60:63], a[96:99], v[108:111]
ds_read_b64_tr_b16 v[44:45], v9 offset:8192
v_mfma_f32_16x16x32_bf16 v[124:127], v[60:63], a[100:103], v[124:127]
s_waitcnt lgkmcnt(7)
ds_read_b64_tr_b16 v[46:47], v9 offset:8704
v_mfma_f32_16x16x32_bf16 v[96:99], v[16:19], a[104:107], v[96:99]
ds_read_b64_tr_b16 v[48:49], v6 offset:12288
v_mfma_f32_16x16x32_bf16 v[112:115], v[16:19], a[108:111], v[112:115]
ds_read_b64_tr_b16 v[50:51], v6 offset:12800
v_mfma_f32_16x16x32_bf16 v[100:103], v[20:23], a[104:107], v[100:103]
ds_read_b64_tr_b16 v[52:53], v7 offset:12288
v_mfma_f32_16x16x32_bf16 v[116:119], v[20:23], a[108:111], v[116:119]
ds_read_b64_tr_b16 v[54:55], v7 offset:12800
v_mfma_f32_16x16x32_bf16 v[104:107], v[24:27], a[104:107], v[104:107]
ds_read_b64_tr_b16 v[56:57], v8 offset:12288
v_mfma_f32_16x16x32_bf16 v[120:123], v[24:27], a[108:111], v[120:123]
ds_read_b64_tr_b16 v[58:59], v8 offset:12800
v_mfma_f32_16x16x32_bf16 v[108:111], v[28:31], a[104:107], v[108:111]
ds_read_b64_tr_b16 v[60:61], v9 offset:12288
v_mfma_f32_16x16x32_bf16 v[124:127], v[28:31], a[108:111], v[124:127]
s_waitcnt lgkmcnt(7)
ds_read_b64_tr_b16 v[62:63], v9 offset:12800
v_mfma_f32_16x16x32_bf16 v[96:99], v[32:35], a[112:115], v[96:99]
v_mfma_f32_16x16x32_bf16 v[112:115], v[32:35], a[116:119], v[112:115]
v_mfma_f32_16x16x32_bf16 v[100:103], v[36:39], a[112:115], v[100:103]
v_mfma_f32_16x16x32_bf16 v[116:119], v[36:39], a[116:119], v[116:119]
v_mfma_f32_16x16x32_bf16 v[104:107], v[40:43], a[112:115], v[104:107]
v_mfma_f32_16x16x32_bf16 v[120:123], v[40:43], a[116:119], v[120:123]
v_mfma_f32_16x16x32_bf16 v[108:111], v[44:47], a[112:115], v[108:111]
v_mfma_f32_16x16x32_bf16 v[124:127], v[44:47], a[116:119], v[124:127]
s_waitcnt lgkmcnt(0)
v_mfma_f32_16x16x32_bf16 v[96:99], v[48:51], a[120:123], v[96:99]
v_mfma_f32_16x16x32_bf16 v[112:115], v[48:51], a[124:127], v[112:115]
v_mfma_f32_16x16x32_bf16 v[100:103], v[52:55], a[120:123], v[100:103]
v_mfma_f32_16x16x32_bf16 v[116:119], v[52:55], a[124:127], v[116:119]
v_mfma_f32_16x16x32_bf16 v[104:107], v[56:59], a[120:123], v[104:107]
v_mfma_f32_16x16x32_bf16 v[120:123], v[56:59], a[124:127], v[120:123]
v_mfma_f32_16x16x32_bf16 v[108:111], v[60:63], a[120:123], v[108:111]
v_mfma_f32_16x16x32_bf16 v[124:127], v[60:63], a[124:127], v[124:127]
s_nop 7
v_cvt_pk_bf16_f32 v16, v96, v97
v_cvt_pk_bf16_f32 v17, v98, v99
v_cvt_pk_bf16_f32 v18, v100, v101
v_cvt_pk_bf16_f32 v19, v102, v103
v_accvgpr_write_b32 a8, v16
v_accvgpr_write_b32 a9, v17
v_accvgpr_write_b32 a10, v18
v_accvgpr_write_b32 a11, v19
v_cvt_pk_bf16_f32 v16, v104, v105
v_cvt_pk_bf16_f32 v17, v106, v107
v_cvt_pk_bf16_f32 v18, v108, v109
v_cvt_pk_bf16_f32 v19, v110, v111
v_accvgpr_write_b32 a12, v16
v_accvgpr_write_b32 a13, v17
v_accvgpr_write_b32 a14, v18
v_accvgpr_write_b32 a15, v19
v_cvt_pk_bf16_f32 v16, v112, v113
v_cvt_pk_bf16_f32 v17, v114, v115
v_cvt_pk_bf16_f32 v18, v116, v117
v_cvt_pk_bf16_f32 v19, v118, v119
v_accvgpr_write_b32 a24, v16
v_accvgpr_write_b32 a25, v17
v_accvgpr_write_b32 a26, v18
v_accvgpr_write_b32 a27, v19
v_cvt_pk_bf16_f32 v16, v120, v121
v_cvt_pk_bf16_f32 v17, v122, v123
v_cvt_pk_bf16_f32 v18, v124, v125
v_cvt_pk_bf16_f32 v19, v126, v127
v_accvgpr_write_b32 a28, v16
v_accvgpr_write_b32 a29, v17
v_accvgpr_write_b32 a30, v18
v_accvgpr_write_b32 a31, v19
L_att_start_1011:
s_load_dwordx2 s[88:89], s[0:1], 40
s_load_dwordx2 s[90:91], s[0:1], 56
s_load_dwordx2 s[92:93], s[0:1], 64
s_load_dwordx2 s[94:95], s[0:1], 72
v_mov_b32 v3, 0
v_mov_b32 v4, 0
v_mov_b32 v1, v5
s_mov_b32 s41, 0
s_mov_b32 s28, 0
s_mov_b32 s53, 98304
s_waitcnt vmcnt(0) lgkmcnt(0)
s_barrier
s_cmp_lg_u32 s23, 0
s_cbranch_scc1 L_pathA_1012
ds_read_b128 a[32:35], v1 offset:0
ds_read_b128 a[36:39], v1 offset:16384
ds_read_b128 a[40:43], v1 offset:1024
ds_read_b128 a[44:47], v1 offset:17408
s_waitcnt lgkmcnt(2)
v_mfma_f32_16x16x32_bf16 v[16:19], a[32:35], a[0:3], 0
ds_read_b128 a[48:51], v1 offset:2048
v_mfma_f32_16x16x32_bf16 v[24:27], a[32:35], a[16:19], 0
ds_read_b128 a[52:55], v1 offset:18432
s_waitcnt lgkmcnt(2)
v_mfma_f32_16x16x32_bf16 v[16:19], a[40:43], a[4:7], v[16:19]
ds_read_b128 a[56:59], v1 offset:3072
v_mfma_f32_16x16x32_bf16 v[24:27], a[40:43], a[20:23], v[24:27]
ds_read_b128 a[60:63], v1 offset:19456
s_waitcnt lgkmcnt(2)
v_mfma_f32_16x16x32_bf16 v[16:19], a[48:51], a[8:11], v[16:19]
ds_read_b128 a[32:35], v1 offset:4096
v_mfma_f32_16x16x32_bf16 v[24:27], a[48:51], a[24:27], v[24:27]
ds_read_b128 a[36:39], v1 offset:20480
s_waitcnt lgkmcnt(2)
v_mfma_f32_16x16x32_bf16 v[16:19], a[56:59], a[12:15], v[16:19]
ds_read_b128 a[40:43], v1 offset:5120
v_mfma_f32_16x16x32_bf16 v[24:27], a[56:59], a[28:31], v[24:27]
ds_read_b128 a[44:47], v1 offset:21504
s_waitcnt lgkmcnt(2)
v_mfma_f32_16x16x32_bf16 v[20:23], a[32:35], a[0:3], 0
ds_read_b128 a[48:51], v1 offset:6144
v_mfma_f32_16x16x32_bf16 v[28:31], a[32:35], a[16:19], 0
ds_read_b128 a[52:55], v1 offset:22528
s_waitcnt lgkmcnt(2)
v_mfma_f32_16x16x32_bf16 v[20:23], a[40:43], a[4:7], v[20:23]
ds_read_b128 a[56:59], v1 offset:7168
v_mfma_f32_16x16x32_bf16 v[28:31], a[40:43], a[20:23], v[28:31]
ds_read_b128 a[60:63], v1 offset:23552
s_waitcnt lgkmcnt(2)
v_mfma_f32_16x16x32_bf16 v[20:23], a[48:51], a[8:11], v[20:23]
ds_read_b128 a[32:35], v1 offset:8192
v_mfma_f32_16x16x32_bf16 v[28:31], a[48:51], a[24:27], v[28:31]
ds_read_b128 a[36:39], v1 offset:24576
s_waitcnt lgkmcnt(2)
v_mfma_f32_16x16x32_bf16 v[20:23], a[56:59], a[12:15], v[20:23]
ds_read_b128 a[40:43], v1 offset:9216
v_mfma_f32_16x16x32_bf16 v[28:31], a[56:59], a[28:31], v[28:31]
ds_read_b128 a[44:47], v1 offset:25600
s_waitcnt lgkmcnt(2)
s_nop 7
s_cmp_lg_u32 s42, 0
s_cbranch_scc1 L_nomax_1015
v_max3_f32 v6, v16, v17, v18
v_max3_f32 v6, v6, v19, v20
v_max3_f32 v6, v6, v21, v22
v_max_f32 v6, v6, v23
v_mov_b32 v7, v6
s_nop 1
v_permlane16_swap_b32 v6, v7
v_max_f32 v6, v6, v7
v_mov_b32 v7, v6
s_nop 1
v_permlane32_swap_b32 v6, v7
v_max_f32 v6, v6, v7
v_sub_f32 v8, 0, v6
v_sub_f32 v9, 0, v6
v_sub_f32 v10, 0, v6
v_sub_f32 v11, 0, v6
v_max3_f32 v6, v24, v25, v26
v_max3_f32 v6, v6, v27, v28
v_max3_f32 v6, v6, v29, v30
v_max_f32 v6, v6, v31
v_mov_b32 v7, v6
s_nop 1
v_permlane16_swap_b32 v6, v7
v_max_f32 v6, v6, v7
v_mov_b32 v7, v6
s_nop 1
v_permlane32_swap_b32 v6, v7
v_max_f32 v6, v6, v7
v_sub_f32 v12, 0, v6
v_sub_f32 v13, 0, v6
v_sub_f32 v14, 0, v6
v_sub_f32 v15, 0, v6
L_nomax_1015:
v_add_f32 v16, v16, v8
v_add_f32 v17, v17, v8
v_add_f32 v18, v18, v8
v_add_f32 v19, v19, v8
v_add_f32 v20, v20, v8
v_add_f32 v21, v21, v8
v_add_f32 v22, v22, v8
v_add_f32 v23, v23, v8
v_add_f32 v24, v24, v12
v_add_f32 v25, v25, v12
v_add_f32 v26, v26, v12
v_add_f32 v27, v27, v12
v_add_f32 v28, v28, v12
v_add_f32 v29, v29, v12
v_add_f32 v30, v30, v12
v_add_f32 v31, v31, v12
s_nop 1
v_mfma_f32_16x16x32_bf16 v[32:35], a[32:35], a[0:3], v[8:11]
ds_read_b128 a[48:51], v1 offset:10240
v_exp_f32 v16, v16
v_mfma_f32_16x16x32_bf16 v[40:43], a[32:35], a[16:19], v[12:15]
ds_read_b128 a[52:55], v1 offset:26624
v_exp_f32 v17, v17
s_waitcnt lgkmcnt(2)
v_mfma_f32_16x16x32_bf16 v[32:35], a[40:43], a[4:7], v[32:35]
ds_read_b128 a[56:59], v1 offset:11264
v_exp_f32 v18, v18
v_mfma_f32_16x16x32_bf16 v[40:43], a[40:43], a[20:23], v[40:43]
ds_read_b128 a[60:63], v1 offset:27648
v_cvt_pk_bf16_f32 v48, v16, v17
v_exp_f32 v19, v19
s_waitcnt lgkmcnt(2)
v_add_f32 v3, v3, v16
v_add_f32 v3, v3, v17
v_mfma_f32_16x16x32_bf16 v[32:35], a[48:51], a[8:11], v[32:35]
ds_read_b128 a[32:35], v1 offset:12288
v_exp_f32 v20, v20
v_mfma_f32_16x16x32_bf16 v[40:43], a[48:51], a[24:27], v[40:43]
ds_read_b128 a[36:39], v1 offset:28672
v_cvt_pk_bf16_f32 v49, v18, v19
v_exp_f32 v21, v21
s_waitcnt lgkmcnt(2)
v_add_f32 v3, v3, v18
v_add_f32 v3, v3, v19
v_mfma_f32_16x16x32_bf16 v[32:35], a[56:59], a[12:15], v[32:35]
ds_read_b128 a[40:43], v1 offset:13312
v_exp_f32 v22, v22
v_mfma_f32_16x16x32_bf16 v[40:43], a[56:59], a[28:31], v[40:43]
ds_read_b128 a[44:47], v1 offset:29696
v_cvt_pk_bf16_f32 v50, v20, v21
v_exp_f32 v23, v23
s_waitcnt lgkmcnt(2)
v_add_f32 v3, v3, v20
v_add_f32 v3, v3, v21
v_mfma_f32_16x16x32_bf16 v[36:39], a[32:35], a[0:3], v[8:11]
ds_read_b128 a[48:51], v1 offset:14336
v_exp_f32 v24, v24
v_mfma_f32_16x16x32_bf16 v[44:47], a[32:35], a[16:19], v[12:15]
ds_read_b128 a[52:55], v1 offset:30720
v_cvt_pk_bf16_f32 v51, v22, v23
s_add_u32 s41, s41, 32768
v_exp_f32 v25, v25
s_waitcnt lgkmcnt(2)
v_add_f32 v3, v3, v22
v_add_f32 v3, v3, v23
v_mfma_f32_16x16x32_bf16 v[36:39], a[40:43], a[4:7], v[36:39]
ds_read_b128 a[56:59], v1 offset:15360
v_exp_f32 v26, v26
v_mfma_f32_16x16x32_bf16 v[44:47], a[40:43], a[20:23], v[44:47]
ds_read_b128 a[60:63], v1 offset:31744
v_cvt_pk_bf16_f32 v52, v24, v25
s_cmp_eq_u32 s41, 0x28000
s_cselect_b32 s41, 0, s41
v_exp_f32 v27, v27
s_waitcnt lgkmcnt(2)
v_add_f32 v4, v4, v24
v_add_f32 v4, v4, v25
v_add_u32 v1, s41, v5
v_mfma_f32_16x16x32_bf16 v[36:39], a[48:51], a[8:11], v[36:39]
ds_read_b128 a[32:35], v1 offset:0
v_exp_f32 v28, v28
v_mfma_f32_16x16x32_bf16 v[44:47], a[48:51], a[24:27], v[44:47]
ds_read_b128 a[36:39], v1 offset:16384
v_cvt_pk_bf16_f32 v53, v26, v27
v_exp_f32 v29, v29
s_waitcnt lgkmcnt(2)
v_add_f32 v4, v4, v26
v_add_f32 v4, v4, v27
v_mfma_f32_16x16x32_bf16 v[36:39], a[56:59], a[12:15], v[36:39]
ds_read_b128 a[40:43], v1 offset:1024
v_exp_f32 v30, v30
v_mfma_f32_16x16x32_bf16 v[44:47], a[56:59], a[28:31], v[44:47]
ds_read_b128 a[44:47], v1 offset:17408
v_cvt_pk_bf16_f32 v54, v28, v29
v_exp_f32 v31, v31
s_waitcnt lgkmcnt(2)
v_add_f32 v4, v4, v28
v_add_f32 v4, v4, v29
s_cmp_lg_u32 s42, 0
s_cbranch_scc1 L_nopf_1016
s_lshl_b32 s38, s2, 2
s_add_u32 s38, s38, s20
v_lshlrev_b32 v6, 3, v5
s_mov_b32 s96, s88
s_mov_b32 s97, s89
s_mov_b32 s98, 0x400000
s_mov_b32 s99, 0x20000
s_sub_u32 s39, s38, 0
s_lshl_b32 s39, s39, 13
v_add_u32 v7, s39, v6
buffer_load_dword v0, v7, s[96:99], 0 offen
s_mov_b32 s96, s90
s_mov_b32 s97, s91
s_mov_b32 s98, 0x1c0000
s_mov_b32 s99, 0x20000
s_sub_u32 s39, s38, 512
s_lshl_b32 s39, s39, 13
v_add_u32 v7, s39, v6
buffer_load_dword v0, v7, s[96:99], 0 offen
s_mov_b32 s96, s92
s_mov_b32 s97, s93
s_mov_b32 s98, 0x1c0000
s_mov_b32 s99, 0x20000
s_sub_u32 s39, s38, 736
s_lshl_b32 s39, s39, 13
v_add_u32 v7, s39, v6
buffer_load_dword v0, v7, s[96:99], 0 offen
s_mov_b32 s96, s94
s_mov_b32 s97, s95
s_mov_b32 s98, 0x1c0000
s_mov_b32 s99, 0x20000
s_sub_u32 s39, s38, 288
s_lshl_b32 s39, s39, 13
v_add_u32 v7, s39, v6
buffer_load_dword v0, v7, s[96:99], 0 offen
s_cmp_eq_u32 s20, 0
s_cselect_b32 s38, 128, s86
v_mov_b32 v6, 1
s_mov_b64 exec, 1
buffer_atomic_add v6, off, s[8:11], s38 sc1
s_mov_b64 exec, -1
L_nopf_1016:
v_mfma_f32_16x16x32_bf16 v[16:19], a[32:35], a[0:3], v[8:11]
ds_read_b128 a[48:51], v1 offset:2048
v_exp_f32 v32, v32
v_mfma_f32_16x16x32_bf16 v[24:27], a[32:35], a[16:19], v[12:15]
ds_read_b128 a[52:55], v1 offset:18432
v_cvt_pk_bf16_f32 v55, v30, v31
v_mfma_f32_16x16x32_bf16 v[64:67], a[36:39], v[48:51], 0
v_exp_f32 v33, v33
v_mfma_f32_16x16x32_bf16 v[96:99], a[36:39], v[52:55], 0
s_waitcnt lgkmcnt(2)
v_add_f32 v4, v4, v30
v_add_f32 v4, v4, v31
v_mfma_f32_16x16x32_bf16 v[16:19], a[40:43], a[4:7], v[16:19]
ds_read_b128 a[56:59], v1 offset:3072
v_exp_f32 v34, v34
v_mfma_f32_16x16x32_bf16 v[24:27], a[40:43], a[20:23], v[24:27]
ds_read_b128 a[60:63], v1 offset:19456
v_cvt_pk_bf16_f32 v56, v32, v33
v_mfma_f32_16x16x32_bf16 v[68:71], a[44:47], v[48:51], 0
v_exp_f32 v35, v35
v_mfma_f32_16x16x32_bf16 v[100:103], a[44:47], v[52:55], 0
s_waitcnt lgkmcnt(2)
v_add_f32 v3, v3, v32
v_add_f32 v3, v3, v33
v_mfma_f32_16x16x32_bf16 v[16:19], a[48:51], a[8:11], v[16:19]
ds_read_b128 a[32:35], v1 offset:4096
v_exp_f32 v36, v36
v_mfma_f32_16x16x32_bf16 v[24:27], a[48:51], a[24:27], v[24:27]
ds_read_b128 a[36:39], v1 offset:20480
v_cvt_pk_bf16_f32 v57, v34, v35
v_mfma_f32_16x16x32_bf16 v[72:75], a[52:55], v[48:51], 0
v_exp_f32 v37, v37
v_mfma_f32_16x16x32_bf16 v[104:107], a[52:55], v[52:55], 0
s_waitcnt lgkmcnt(2)
v_add_f32 v3, v3, v34
v_add_f32 v3, v3, v35
v_mfma_f32_16x16x32_bf16 v[16:19], a[56:59], a[12:15], v[16:19]
ds_read_b128 a[40:43], v1 offset:5120
v_exp_f32 v38, v38
v_mfma_f32_16x16x32_bf16 v[24:27], a[56:59], a[28:31], v[24:27]
ds_read_b128 a[44:47], v1 offset:21504
v_cvt_pk_bf16_f32 v58, v36, v37
v_mfma_f32_16x16x32_bf16 v[76:79], a[60:63], v[48:51], 0
v_exp_f32 v39, v39
v_mfma_f32_16x16x32_bf16 v[108:111], a[60:63], v[52:55], 0
s_waitcnt lgkmcnt(2)
v_add_f32 v3, v3, v36
v_add_f32 v3, v3, v37
v_mfma_f32_16x16x32_bf16 v[20:23], a[32:35], a[0:3], v[8:11]
ds_read_b128 a[48:51], v1 offset:6144
v_exp_f32 v40, v40
v_mfma_f32_16x16x32_bf16 v[28:31], a[32:35], a[16:19], v[12:15]
ds_read_b128 a[52:55], v1 offset:22528
v_cvt_pk_bf16_f32 v59, v38, v39
v_mfma_f32_16x16x32_bf16 v[80:83], a[36:39], v[48:51], 0
v_exp_f32 v41, v41
v_mfma_f32_16x16x32_bf16 v[112:115], a[36:39], v[52:55], 0
s_waitcnt lgkmcnt(2)
v_add_f32 v3, v3, v38
v_add_f32 v3, v3, v39
v_mfma_f32_16x16x32_bf16 v[20:23], a[40:43], a[4:7], v[20:23]
ds_read_b128 a[56:59], v1 offset:7168
v_exp_f32 v42, v42
v_mfma_f32_16x16x32_bf16 v[28:31], a[40:43], a[20:23], v[28:31]
ds_read_b128 a[60:63], v1 offset:23552
v_cvt_pk_bf16_f32 v60, v40, v41
v_mfma_f32_16x16x32_bf16 v[84:87], a[44:47], v[48:51], 0
v_exp_f32 v43, v43
v_mfma_f32_16x16x32_bf16 v[116:119], a[44:47], v[52:55], 0
s_waitcnt lgkmcnt(2)
v_add_f32 v4, v4, v40
v_add_f32 v4, v4, v41
v_mfma_f32_16x16x32_bf16 v[20:23], a[48:51], a[8:11], v[20:23]
ds_read_b128 a[32:35], v1 offset:8192
v_exp_f32 v44, v44
v_mfma_f32_16x16x32_bf16 v[28:31], a[48:51], a[24:27], v[28:31]
ds_read_b128 a[36:39], v1 offset:24576
v_cvt_pk_bf16_f32 v61, v42, v43
v_mfma_f32_16x16x32_bf16 v[88:91], a[52:55], v[48:51], 0
v_exp_f32 v45, v45
v_mfma_f32_16x16x32_bf16 v[120:123], a[52:55], v[52:55], 0
s_waitcnt lgkmcnt(2)
v_add_f32 v4, v4, v42
v_add_f32 v4, v4, v43
v_mfma_f32_16x16x32_bf16 v[20:23], a[56:59], a[12:15], v[20:23]
ds_read_b128 a[40:43], v1 offset:9216
v_exp_f32 v46, v46
v_mfma_f32_16x16x32_bf16 v[28:31], a[56:59], a[28:31], v[28:31]
ds_read_b128 a[44:47], v1 offset:25600
v_cvt_pk_bf16_f32 v62, v44, v45
v_mfma_f32_16x16x32_bf16 v[92:95], a[60:63], v[48:51], 0
v_exp_f32 v47, v47
v_mfma_f32_16x16x32_bf16 v[124:127], a[60:63], v[52:55], 0
s_waitcnt lgkmcnt(2)
v_add_f32 v4, v4, v44
v_add_f32 v4, v4, v45
v_mfma_f32_16x16x32_bf16 v[32:35], a[32:35], a[0:3], v[8:11]
ds_read_b128 a[48:51], v1 offset:10240
v_exp_f32 v16, v16
v_mfma_f32_16x16x32_bf16 v[40:43], a[32:35], a[16:19], v[12:15]
ds_read_b128 a[52:55], v1 offset:26624
v_cvt_pk_bf16_f32 v63, v46, v47
v_mfma_f32_16x16x32_bf16 v[64:67], a[36:39], v[56:59], v[64:67]
v_exp_f32 v17, v17
v_mfma_f32_16x16x32_bf16 v[96:99], a[36:39], v[60:63], v[96:99]
s_waitcnt lgkmcnt(2)
v_add_f32 v4, v4, v46
v_add_f32 v4, v4, v47
v_mfma_f32_16x16x32_bf16 v[32:35], a[40:43], a[4:7], v[32:35]
ds_read_b128 a[56:59], v1 offset:11264
v_exp_f32 v18, v18
v_mfma_f32_16x16x32_bf16 v[40:43], a[40:43], a[20:23], v[40:43]
ds_read_b128 a[60:63], v1 offset:27648
v_cvt_pk_bf16_f32 v48, v16, v17
v_mfma_f32_16x16x32_bf16 v[68:71], a[44:47], v[56:59], v[68:71]
v_exp_f32 v19, v19
v_mfma_f32_16x16x32_bf16 v[100:103], a[44:47], v[60:63], v[100:103]
s_waitcnt lgkmcnt(2)
v_add_f32 v3, v3, v16
v_add_f32 v3, v3, v17
v_mfma_f32_16x16x32_bf16 v[32:35], a[48:51], a[8:11], v[32:35]
ds_read_b128 a[32:35], v1 offset:12288
v_exp_f32 v20, v20
v_mfma_f32_16x16x32_bf16 v[40:43], a[48:51], a[24:27], v[40:43]
ds_read_b128 a[36:39], v1 offset:28672
v_cvt_pk_bf16_f32 v49, v18, v19
v_mfma_f32_16x16x32_bf16 v[72:75], a[52:55], v[56:59], v[72:75]
v_exp_f32 v21, v21
v_mfma_f32_16x16x32_bf16 v[104:107], a[52:55], v[60:63], v[104:107]
s_waitcnt lgkmcnt(2)
v_add_f32 v3, v3, v18
v_add_f32 v3, v3, v19
v_mfma_f32_16x16x32_bf16 v[32:35], a[56:59], a[12:15], v[32:35]
ds_read_b128 a[40:43], v1 offset:13312
v_exp_f32 v22, v22
v_mfma_f32_16x16x32_bf16 v[40:43], a[56:59], a[28:31], v[40:43]
ds_read_b128 a[44:47], v1 offset:29696
v_cvt_pk_bf16_f32 v50, v20, v21
v_mfma_f32_16x16x32_bf16 v[76:79], a[60:63], v[56:59], v[76:79]
v_exp_f32 v23, v23
v_mfma_f32_16x16x32_bf16 v[108:111], a[60:63], v[60:63], v[108:111]
s_waitcnt lgkmcnt(2)
v_add_f32 v3, v3, v20
v_add_f32 v3, v3, v21
v_mfma_f32_16x16x32_bf16 v[36:39], a[32:35], a[0:3], v[8:11]
ds_read_b128 a[48:51], v1 offset:14336
v_exp_f32 v24, v24
v_mfma_f32_16x16x32_bf16 v[44:47], a[32:35], a[16:19], v[12:15]
ds_read_b128 a[52:55], v1 offset:30720
v_cvt_pk_bf16_f32 v51, v22, v23
v_mfma_f32_16x16x32_bf16 v[80:83], a[36:39], v[56:59], v[80:83]
s_add_u32 s41, s41, 32768
v_exp_f32 v25, v25
v_mfma_f32_16x16x32_bf16 v[112:115], a[36:39], v[60:63], v[112:115]
s_waitcnt lgkmcnt(2)
v_add_f32 v3, v3, v22
v_add_f32 v3, v3, v23
v_mfma_f32_16x16x32_bf16 v[36:39], a[40:43], a[4:7], v[36:39]
ds_read_b128 a[56:59], v1 offset:15360
v_exp_f32 v26, v26
v_mfma_f32_16x16x32_bf16 v[44:47], a[40:43], a[20:23], v[44:47]
ds_read_b128 a[60:63], v1 offset:31744
v_cvt_pk_bf16_f32 v52, v24, v25
v_mfma_f32_16x16x32_bf16 v[84:87], a[44:47], v[56:59], v[84:87]
s_cmp_eq_u32 s41, 0x28000
s_cselect_b32 s41, 0, s41
v_exp_f32 v27, v27
v_mfma_f32_16x16x32_bf16 v[116:119], a[44:47], v[60:63], v[116:119]
s_waitcnt lgkmcnt(2)
v_add_f32 v4, v4, v24
v_add_f32 v4, v4, v25
v_add_u32 v1, s41, v5
v_mfma_f32_16x16x32_bf16 v[36:39], a[48:51], a[8:11], v[36:39]
ds_read_b128 a[32:35], v1 offset:0
v_exp_f32 v28, v28
v_mfma_f32_16x16x32_bf16 v[44:47], a[48:51], a[24:27], v[44:47]
ds_read_b128 a[36:39], v1 offset:16384
v_cvt_pk_bf16_f32 v53, v26, v27
v_mfma_f32_16x16x32_bf16 v[88:91], a[52:55], v[56:59], v[88:91]
v_exp_f32 v29, v29
v_mfma_f32_16x16x32_bf16 v[120:123], a[52:55], v[60:63], v[120:123]
s_waitcnt lgkmcnt(2)
v_add_f32 v4, v4, v26
v_add_f32 v4, v4, v27
v_mfma_f32_16x16x32_bf16 v[36:39], a[56:59], a[12:15], v[36:39]
ds_read_b128 a[40:43], v1 offset:1024
v_exp_f32 v30, v30
v_mfma_f32_16x16x32_bf16 v[44:47], a[56:59], a[28:31], v[44:47]
ds_read_b128 a[44:47], v1 offset:17408
v_cvt_pk_bf16_f32 v54, v28, v29
v_mfma_f32_16x16x32_bf16 v[92:95], a[60:63], v[56:59], v[92:95]
v_exp_f32 v31, v31
v_mfma_f32_16x16x32_bf16 v[124:127], a[60:63], v[60:63], v[124:127]
s_waitcnt lgkmcnt(2)
v_add_f32 v4, v4, v28
v_add_f32 v4, v4, v29
s_lshr_b32 s29, s26, 1
s_sub_u32 s29, s29, 1
L_Bloop_1017:
s_barrier
v_mfma_f32_16x16x32_bf16 v[16:19], a[32:35], a[0:3], v[8:11]
ds_read_b128 a[48:51], v1 offset:2048
v_exp_f32 v32, v32
v_mfma_f32_16x16x32_bf16 v[24:27], a[32:35], a[16:19], v[12:15]
ds_read_b128 a[52:55], v1 offset:18432
v_cvt_pk_bf16_f32 v55, v30, v31
v_mfma_f32_16x16x32_bf16 v[64:67], a[36:39], v[48:51], v[64:67]
v_exp_f32 v33, v33
v_mfma_f32_16x16x32_bf16 v[96:99], a[36:39], v[52:55], v[96:99]
s_waitcnt lgkmcnt(2)
v_add_f32 v4, v4, v30
v_add_f32 v4, v4, v31
v_mfma_f32_16x16x32_bf16 v[16:19], a[40:43], a[4:7], v[16:19]
ds_read_b128 a[56:59], v1 offset:3072
v_exp_f32 v34, v34
v_mfma_f32_16x16x32_bf16 v[24:27], a[40:43], a[20:23], v[24:27]
ds_read_b128 a[60:63], v1 offset:19456
v_cvt_pk_bf16_f32 v56, v32, v33
v_mfma_f32_16x16x32_bf16 v[68:71], a[44:47], v[48:51], v[68:71]
v_exp_f32 v35, v35
v_mfma_f32_16x16x32_bf16 v[100:103], a[44:47], v[52:55], v[100:103]
s_waitcnt lgkmcnt(2)
v_add_f32 v3, v3, v32
v_add_f32 v3, v3, v33
v_mfma_f32_16x16x32_bf16 v[16:19], a[48:51], a[8:11], v[16:19]
ds_read_b128 a[32:35], v1 offset:4096
v_exp_f32 v36, v36
v_mfma_f32_16x16x32_bf16 v[24:27], a[48:51], a[24:27], v[24:27]
ds_read_b128 a[36:39], v1 offset:20480
v_cvt_pk_bf16_f32 v57, v34, v35
v_mfma_f32_16x16x32_bf16 v[72:75], a[52:55], v[48:51], v[72:75]
v_exp_f32 v37, v37
v_mfma_f32_16x16x32_bf16 v[104:107], a[52:55], v[52:55], v[104:107]
s_waitcnt lgkmcnt(2)
v_add_f32 v3, v3, v34
v_add_f32 v3, v3, v35
v_mfma_f32_16x16x32_bf16 v[16:19], a[56:59], a[12:15], v[16:19]
ds_read_b128 a[40:43], v1 offset:5120
v_exp_f32 v38, v38
v_mfma_f32_16x16x32_bf16 v[24:27], a[56:59], a[28:31], v[24:27]
ds_read_b128 a[44:47], v1 offset:21504
v_cvt_pk_bf16_f32 v58, v36, v37
v_mfma_f32_16x16x32_bf16 v[76:79], a[60:63], v[48:51], v[76:79]
v_exp_f32 v39, v39
v_mfma_f32_16x16x32_bf16 v[108:111], a[60:63], v[52:55], v[108:111]
s_waitcnt lgkmcnt(2)
v_add_f32 v3, v3, v36
v_add_f32 v3, v3, v37
v_mfma_f32_16x16x32_bf16 v[20:23], a[32:35], a[0:3], v[8:11]
ds_read_b128 a[48:51], v1 offset:6144
v_exp_f32 v40, v40
v_mfma_f32_16x16x32_bf16 v[28:31], a[32:35], a[16:19], v[12:15]
ds_read_b128 a[52:55], v1 offset:22528
v_cvt_pk_bf16_f32 v59, v38, v39
v_mfma_f32_16x16x32_bf16 v[80:83], a[36:39], v[48:51], v[80:83]
v_exp_f32 v41, v41
v_mfma_f32_16x16x32_bf16 v[112:115], a[36:39], v[52:55], v[112:115]
s_waitcnt lgkmcnt(2)
v_add_f32 v3, v3, v38
v_add_f32 v3, v3, v39
v_mfma_f32_16x16x32_bf16 v[20:23], a[40:43], a[4:7], v[20:23]
ds_read_b128 a[56:59], v1 offset:7168
v_exp_f32 v42, v42
v_mfma_f32_16x16x32_bf16 v[28:31], a[40:43], a[20:23], v[28:31]
ds_read_b128 a[60:63], v1 offset:23552
v_cvt_pk_bf16_f32 v60, v40, v41
v_mfma_f32_16x16x32_bf16 v[84:87], a[44:47], v[48:51], v[84:87]
v_exp_f32 v43, v43
v_mfma_f32_16x16x32_bf16 v[116:119], a[44:47], v[52:55], v[116:119]
s_waitcnt lgkmcnt(2)
v_add_f32 v4, v4, v40
v_add_f32 v4, v4, v41
v_mfma_f32_16x16x32_bf16 v[20:23], a[48:51], a[8:11], v[20:23]
ds_read_b128 a[32:35], v1 offset:8192
v_exp_f32 v44, v44
v_mfma_f32_16x16x32_bf16 v[28:31], a[48:51], a[24:27], v[28:31]
ds_read_b128 a[36:39], v1 offset:24576
v_cvt_pk_bf16_f32 v61, v42, v43
v_mfma_f32_16x16x32_bf16 v[88:91], a[52:55], v[48:51], v[88:91]
v_exp_f32 v45, v45
v_mfma_f32_16x16x32_bf16 v[120:123], a[52:55], v[52:55], v[120:123]
s_waitcnt lgkmcnt(2)
v_add_f32 v4, v4, v42
v_add_f32 v4, v4, v43
v_mfma_f32_16x16x32_bf16 v[20:23], a[56:59], a[12:15], v[20:23]
ds_read_b128 a[40:43], v1 offset:9216
v_exp_f32 v46, v46
v_mfma_f32_16x16x32_bf16 v[28:31], a[56:59], a[28:31], v[28:31]
ds_read_b128 a[44:47], v1 offset:25600
v_cvt_pk_bf16_f32 v62, v44, v45
v_mfma_f32_16x16x32_bf16 v[92:95], a[60:63], v[48:51], v[92:95]
v_exp_f32 v47, v47
v_mfma_f32_16x16x32_bf16 v[124:127], a[60:63], v[52:55], v[124:127]
s_waitcnt lgkmcnt(2)
v_add_f32 v4, v4, v44
v_add_f32 v4, v4, v45
v_mfma_f32_16x16x32_bf16 v[32:35], a[32:35], a[0:3], v[8:11]
ds_read_b128 a[48:51], v1 offset:10240
v_exp_f32 v16, v16
v_mfma_f32_16x16x32_bf16 v[40:43], a[32:35], a[16:19], v[12:15]
ds_read_b128 a[52:55], v1 offset:26624
v_cvt_pk_bf16_f32 v63, v46, v47
v_mfma_f32_16x16x32_bf16 v[64:67], a[36:39], v[56:59], v[64:67]
v_exp_f32 v17, v17
v_mfma_f32_16x16x32_bf16 v[96:99], a[36:39], v[60:63], v[96:99]
s_waitcnt lgkmcnt(2)
v_add_f32 v4, v4, v46
v_add_f32 v4, v4, v47
v_mfma_f32_16x16x32_bf16 v[32:35], a[40:43], a[4:7], v[32:35]
ds_read_b128 a[56:59], v1 offset:11264
v_exp_f32 v18, v18
v_mfma_f32_16x16x32_bf16 v[40:43], a[40:43], a[20:23], v[40:43]
ds_read_b128 a[60:63], v1 offset:27648
v_cvt_pk_bf16_f32 v48, v16, v17
v_mfma_f32_16x16x32_bf16 v[68:71], a[44:47], v[56:59], v[68:71]
v_exp_f32 v19, v19
v_mfma_f32_16x16x32_bf16 v[100:103], a[44:47], v[60:63], v[100:103]
s_waitcnt lgkmcnt(2)
v_add_f32 v3, v3, v16
v_add_f32 v3, v3, v17
v_mfma_f32_16x16x32_bf16 v[32:35], a[48:51], a[8:11], v[32:35]
ds_read_b128 a[32:35], v1 offset:12288
v_exp_f32 v20, v20
v_mfma_f32_16x16x32_bf16 v[40:43], a[48:51], a[24:27], v[40:43]
ds_read_b128 a[36:39], v1 offset:28672
v_cvt_pk_bf16_f32 v49, v18, v19
v_mfma_f32_16x16x32_bf16 v[72:75], a[52:55], v[56:59], v[72:75]
v_exp_f32 v21, v21
v_mfma_f32_16x16x32_bf16 v[104:107], a[52:55], v[60:63], v[104:107]
s_waitcnt lgkmcnt(2)
v_add_f32 v3, v3, v18
v_add_f32 v3, v3, v19
v_mfma_f32_16x16x32_bf16 v[32:35], a[56:59], a[12:15], v[32:35]
ds_read_b128 a[40:43], v1 offset:13312
v_exp_f32 v22, v22
v_mfma_f32_16x16x32_bf16 v[40:43], a[56:59], a[28:31], v[40:43]
ds_read_b128 a[44:47], v1 offset:29696
v_cvt_pk_bf16_f32 v50, v20, v21
v_mfma_f32_16x16x32_bf16 v[76:79], a[60:63], v[56:59], v[76:79]
v_exp_f32 v23, v23
v_mfma_f32_16x16x32_bf16 v[108:111], a[60:63], v[60:63], v[108:111]
s_waitcnt lgkmcnt(2)
v_add_f32 v3, v3, v20
v_add_f32 v3, v3, v21
v_mfma_f32_16x16x32_bf16 v[36:39], a[32:35], a[0:3], v[8:11]
ds_read_b128 a[48:51], v1 offset:14336
v_exp_f32 v24, v24
v_mfma_f32_16x16x32_bf16 v[44:47], a[32:35], a[16:19], v[12:15]
ds_read_b128 a[52:55], v1 offset:30720
v_cvt_pk_bf16_f32 v51, v22, v23
v_mfma_f32_16x16x32_bf16 v[80:83], a[36:39], v[56:59], v[80:83]
s_add_u32 s41, s41, 32768
v_exp_f32 v25, v25
v_mfma_f32_16x16x32_bf16 v[112:115], a[36:39], v[60:63], v[112:115]
s_waitcnt lgkmcnt(2)
v_add_f32 v3, v3, v22
v_add_f32 v3, v3, v23
v_mfma_f32_16x16x32_bf16 v[36:39], a[40:43], a[4:7], v[36:39]
ds_read_b128 a[56:59], v1 offset:15360
v_exp_f32 v26, v26
v_mfma_f32_16x16x32_bf16 v[44:47], a[40:43], a[20:23], v[44:47]
ds_read_b128 a[60:63], v1 offset:31744
v_cvt_pk_bf16_f32 v52, v24, v25
v_mfma_f32_16x16x32_bf16 v[84:87], a[44:47], v[56:59], v[84:87]
s_cmp_eq_u32 s41, 0x28000
s_cselect_b32 s41, 0, s41
v_exp_f32 v27, v27
v_mfma_f32_16x16x32_bf16 v[116:119], a[44:47], v[60:63], v[116:119]
s_waitcnt lgkmcnt(2)
v_add_f32 v4, v4, v24
v_add_f32 v4, v4, v25
v_add_u32 v1, s41, v5
v_mfma_f32_16x16x32_bf16 v[36:39], a[48:51], a[8:11], v[36:39]
ds_read_b128 a[32:35], v1 offset:0
v_exp_f32 v28, v28
v_mfma_f32_16x16x32_bf16 v[44:47], a[48:51], a[24:27], v[44:47]
ds_read_b128 a[36:39], v1 offset:16384
v_cvt_pk_bf16_f32 v53, v26, v27
v_mfma_f32_16x16x32_bf16 v[88:91], a[52:55], v[56:59], v[88:91]
v_exp_f32 v29, v29
v_mfma_f32_16x16x32_bf16 v[120:123], a[52:55], v[60:63], v[120:123]
s_waitcnt lgkmcnt(2)
v_add_f32 v4, v4, v26
v_add_f32 v4, v4, v27
v_mfma_f32_16x16x32_bf16 v[36:39], a[56:59], a[12:15], v[36:39]
ds_read_b128 a[40:43], v1 offset:1024
v_exp_f32 v30, v30
v_mfma_f32_16x16x32_bf16 v[44:47], a[56:59], a[28:31], v[44:47]
ds_read_b128 a[44:47], v1 offset:17408
v_cvt_pk_bf16_f32 v54, v28, v29
v_mfma_f32_16x16x32_bf16 v[92:95], a[60:63], v[56:59], v[92:95]
v_exp_f32 v31, v31
v_mfma_f32_16x16x32_bf16 v[124:127], a[60:63], v[60:63], v[124:127]
s_waitcnt lgkmcnt(2)
v_add_f32 v4, v4, v28
v_add_f32 v4, v4, v29
v_mfma_f32_16x16x32_bf16 v[16:19], a[32:35], a[0:3], v[8:11]
ds_read_b128 a[48:51], v1 offset:2048
v_exp_f32 v32, v32
v_mfma_f32_16x16x32_bf16 v[24:27], a[32:35], a[16:19], v[12:15]
ds_read_b128 a[52:55], v1 offset:18432
v_cvt_pk_bf16_f32 v55, v30, v31
v_mfma_f32_16x16x32_bf16 v[64:67], a[36:39], v[48:51], v[64:67]
v_exp_f32 v33, v33
v_mfma_f32_16x16x32_bf16 v[96:99], a[36:39], v[52:55], v[96:99]
s_waitcnt lgkmcnt(2)
v_add_f32 v4, v4, v30
v_add_f32 v4, v4, v31
v_mfma_f32_16x16x32_bf16 v[16:19], a[40:43], a[4:7], v[16:19]
ds_read_b128 a[56:59], v1 offset:3072
v_exp_f32 v34, v34
v_mfma_f32_16x16x32_bf16 v[24:27], a[40:43], a[20:23], v[24:27]
ds_read_b128 a[60:63], v1 offset:19456
v_cvt_pk_bf16_f32 v56, v32, v33
v_mfma_f32_16x16x32_bf16 v[68:71], a[44:47], v[48:51], v[68:71]
v_exp_f32 v35, v35
v_mfma_f32_16x16x32_bf16 v[100:103], a[44:47], v[52:55], v[100:103]
s_waitcnt lgkmcnt(2)
v_add_f32 v3, v3, v32
v_add_f32 v3, v3, v33
v_mfma_f32_16x16x32_bf16 v[16:19], a[48:51], a[8:11], v[16:19]
ds_read_b128 a[32:35], v1 offset:4096
v_exp_f32 v36, v36
v_mfma_f32_16x16x32_bf16 v[24:27], a[48:51], a[24:27], v[24:27]
ds_read_b128 a[36:39], v1 offset:20480
v_cvt_pk_bf16_f32 v57, v34, v35
v_mfma_f32_16x16x32_bf16 v[72:75], a[52:55], v[48:51], v[72:75]
v_exp_f32 v37, v37
v_mfma_f32_16x16x32_bf16 v[104:107], a[52:55], v[52:55], v[104:107]
s_waitcnt lgkmcnt(2)
v_add_f32 v3, v3, v34
v_add_f32 v3, v3, v35
v_mfma_f32_16x16x32_bf16 v[16:19], a[56:59], a[12:15], v[16:19]
ds_read_b128 a[40:43], v1 offset:5120
v_exp_f32 v38, v38
v_mfma_f32_16x16x32_bf16 v[24:27], a[56:59], a[28:31], v[24:27]
ds_read_b128 a[44:47], v1 offset:21504
v_cvt_pk_bf16_f32 v58, v36, v37
v_mfma_f32_16x16x32_bf16 v[76:79], a[60:63], v[48:51], v[76:79]
v_exp_f32 v39, v39
v_mfma_f32_16x16x32_bf16 v[108:111], a[60:63], v[52:55], v[108:111]
s_waitcnt lgkmcnt(2)
v_add_f32 v3, v3, v36
v_add_f32 v3, v3, v37
v_mfma_f32_16x16x32_bf16 v[20:23], a[32:35], a[0:3], v[8:11]
ds_read_b128 a[48:51], v1 offset:6144
v_exp_f32 v40, v40
v_mfma_f32_16x16x32_bf16 v[28:31], a[32:35], a[16:19], v[12:15]
ds_read_b128 a[52:55], v1 offset:22528
v_cvt_pk_bf16_f32 v59, v38, v39
v_mfma_f32_16x16x32_bf16 v[80:83], a[36:39], v[48:51], v[80:83]
v_exp_f32 v41, v41
v_mfma_f32_16x16x32_bf16 v[112:115], a[36:39], v[52:55], v[112:115]
s_waitcnt lgkmcnt(2)
v_add_f32 v3, v3, v38
v_add_f32 v3, v3, v39
v_mfma_f32_16x16x32_bf16 v[20:23], a[40:43], a[4:7], v[20:23]
ds_read_b128 a[56:59], v1 offset:7168
v_exp_f32 v42, v42
v_mfma_f32_16x16x32_bf16 v[28:31], a[40:43], a[20:23], v[28:31]
ds_read_b128 a[60:63], v1 offset:23552
v_cvt_pk_bf16_f32 v60, v40, v41
v_mfma_f32_16x16x32_bf16 v[84:87], a[44:47], v[48:51], v[84:87]
v_exp_f32 v43, v43
v_mfma_f32_16x16x32_bf16 v[116:119], a[44:47], v[52:55], v[116:119]
s_waitcnt lgkmcnt(2)
v_add_f32 v4, v4, v40
v_add_f32 v4, v4, v41
v_mfma_f32_16x16x32_bf16 v[20:23], a[48:51], a[8:11], v[20:23]
ds_read_b128 a[32:35], v1 offset:8192
v_exp_f32 v44, v44
v_mfma_f32_16x16x32_bf16 v[28:31], a[48:51], a[24:27], v[28:31]
ds_read_b128 a[36:39], v1 offset:24576
v_cvt_pk_bf16_f32 v61, v42, v43
v_mfma_f32_16x16x32_bf16 v[88:91], a[52:55], v[48:51], v[88:91]
v_exp_f32 v45, v45
v_mfma_f32_16x16x32_bf16 v[120:123], a[52:55], v[52:55], v[120:123]
s_waitcnt lgkmcnt(2)
v_add_f32 v4, v4, v42
v_add_f32 v4, v4, v43
v_mfma_f32_16x16x32_bf16 v[20:23], a[56:59], a[12:15], v[20:23]
ds_read_b128 a[40:43], v1 offset:9216
v_exp_f32 v46, v46
v_mfma_f32_16x16x32_bf16 v[28:31], a[56:59], a[28:31], v[28:31]
ds_read_b128 a[44:47], v1 offset:25600
v_cvt_pk_bf16_f32 v62, v44, v45
v_mfma_f32_16x16x32_bf16 v[92:95], a[60:63], v[48:51], v[92:95]
v_exp_f32 v47, v47
v_mfma_f32_16x16x32_bf16 v[124:127], a[60:63], v[52:55], v[124:127]
s_waitcnt lgkmcnt(2)
v_add_f32 v4, v4, v44
v_add_f32 v4, v4, v45
v_mfma_f32_16x16x32_bf16 v[32:35], a[32:35], a[0:3], v[8:11]
ds_read_b128 a[48:51], v1 offset:10240
v_exp_f32 v16, v16
v_mfma_f32_16x16x32_bf16 v[40:43], a[32:35], a[16:19], v[12:15]
ds_read_b128 a[52:55], v1 offset:26624
v_cvt_pk_bf16_f32 v63, v46, v47
v_mfma_f32_16x16x32_bf16 v[64:67], a[36:39], v[56:59], v[64:67]
v_exp_f32 v17, v17
v_mfma_f32_16x16x32_bf16 v[96:99], a[36:39], v[60:63], v[96:99]
s_waitcnt lgkmcnt(2)
v_add_f32 v4, v4, v46
v_add_f32 v4, v4, v47
v_mfma_f32_16x16x32_bf16 v[32:35], a[40:43], a[4:7], v[32:35]
ds_read_b128 a[56:59], v1 offset:11264
v_exp_f32 v18, v18
v_mfma_f32_16x16x32_bf16 v[40:43], a[40:43], a[20:23], v[40:43]
ds_read_b128 a[60:63], v1 offset:27648
v_cvt_pk_bf16_f32 v48, v16, v17
v_mfma_f32_16x16x32_bf16 v[68:71], a[44:47], v[56:59], v[68:71]
v_exp_f32 v19, v19
v_mfma_f32_16x16x32_bf16 v[100:103], a[44:47], v[60:63], v[100:103]
s_waitcnt lgkmcnt(2)
v_add_f32 v3, v3, v16
v_add_f32 v3, v3, v17
v_mfma_f32_16x16x32_bf16 v[32:35], a[48:51], a[8:11], v[32:35]
ds_read_b128 a[32:35], v1 offset:12288
v_exp_f32 v20, v20
v_mfma_f32_16x16x32_bf16 v[40:43], a[48:51], a[24:27], v[40:43]
ds_read_b128 a[36:39], v1 offset:28672
v_cvt_pk_bf16_f32 v49, v18, v19
v_mfma_f32_16x16x32_bf16 v[72:75], a[52:55], v[56:59], v[72:75]
s_sub_u32 s29, s29, 1
v_exp_f32 v21, v21
v_mfma_f32_16x16x32_bf16 v[104:107], a[52:55], v[60:63], v[104:107]
s_waitcnt lgkmcnt(2)
v_add_f32 v3, v3, v18
v_add_f32 v3, v3, v19
v_mfma_f32_16x16x32_bf16 v[32:35], a[56:59], a[12:15], v[32:35]
ds_read_b128 a[40:43], v1 offset:13312
v_exp_f32 v22, v22
v_mfma_f32_16x16x32_bf16 v[40:43], a[56:59], a[28:31], v[40:43]
ds_read_b128 a[44:47], v1 offset:29696
v_cvt_pk_bf16_f32 v50, v20, v21
v_mfma_f32_16x16x32_bf16 v[76:79], a[60:63], v[56:59], v[76:79]
v_exp_f32 v23, v23
v_mfma_f32_16x16x32_bf16 v[108:111], a[60:63], v[60:63], v[108:111]
s_waitcnt lgkmcnt(2)
v_add_f32 v3, v3, v20
v_add_f32 v3, v3, v21
v_mfma_f32_16x16x32_bf16 v[36:39], a[32:35], a[0:3], v[8:11]
ds_read_b128 a[48:51], v1 offset:14336
v_exp_f32 v24, v24
v_mfma_f32_16x16x32_bf16 v[44:47], a[32:35], a[16:19], v[12:15]
ds_read_b128 a[52:55], v1 offset:30720
v_cvt_pk_bf16_f32 v51, v22, v23
v_mfma_f32_16x16x32_bf16 v[80:83], a[36:39], v[56:59], v[80:83]
s_add_u32 s41, s41, 32768
v_exp_f32 v25, v25
v_mfma_f32_16x16x32_bf16 v[112:115], a[36:39], v[60:63], v[112:115]
s_waitcnt lgkmcnt(2)
v_add_f32 v3, v3, v22
v_add_f32 v3, v3, v23
v_mfma_f32_16x16x32_bf16 v[36:39], a[40:43], a[4:7], v[36:39]
ds_read_b128 a[56:59], v1 offset:15360
v_exp_f32 v26, v26
v_mfma_f32_16x16x32_bf16 v[44:47], a[40:43], a[20:23], v[44:47]
ds_read_b128 a[60:63], v1 offset:31744
v_cvt_pk_bf16_f32 v52, v24, v25
v_mfma_f32_16x16x32_bf16 v[84:87], a[44:47], v[56:59], v[84:87]
s_cmp_eq_u32 s41, 0x28000
s_cselect_b32 s41, 0, s41
v_exp_f32 v27, v27
v_mfma_f32_16x16x32_bf16 v[116:119], a[44:47], v[60:63], v[116:119]
s_waitcnt lgkmcnt(2)
v_add_f32 v4, v4, v24
v_add_f32 v4, v4, v25
v_add_u32 v1, s41, v5
v_mfma_f32_16x16x32_bf16 v[36:39], a[48:51], a[8:11], v[36:39]
ds_read_b128 a[32:35], v1 offset:0
v_exp_f32 v28, v28
v_mfma_f32_16x16x32_bf16 v[44:47], a[48:51], a[24:27], v[44:47]
ds_read_b128 a[36:39], v1 offset:16384
v_cvt_pk_bf16_f32 v53, v26, v27
v_mfma_f32_16x16x32_bf16 v[88:91], a[52:55], v[56:59], v[88:91]
v_exp_f32 v29, v29
v_mfma_f32_16x16x32_bf16 v[120:123], a[52:55], v[60:63], v[120:123]
s_waitcnt lgkmcnt(2)
v_add_f32 v4, v4, v26
v_add_f32 v4, v4, v27
v_mfma_f32_16x16x32_bf16 v[36:39], a[56:59], a[12:15], v[36:39]
ds_read_b128 a[40:43], v1 offset:1024
v_exp_f32 v30, v30
v_mfma_f32_16x16x32_bf16 v[44:47], a[56:59], a[28:31], v[44:47]
ds_read_b128 a[44:47], v1 offset:17408
v_cvt_pk_bf16_f32 v54, v28, v29
v_mfma_f32_16x16x32_bf16 v[92:95], a[60:63], v[56:59], v[92:95]
v_exp_f32 v31, v31
v_mfma_f32_16x16x32_bf16 v[124:127], a[60:63], v[60:63], v[124:127]
s_waitcnt lgkmcnt(2)
v_add_f32 v4, v4, v28
v_add_f32 v4, v4, v29
s_cmp_lg_u32 s29, 0
s_cbranch_scc1 L_Bloop_1017
s_barrier
ds_read_b128 a[48:51], v1 offset:2048
v_exp_f32 v32, v32
ds_read_b128 a[52:55], v1 offset:18432
v_cvt_pk_bf16_f32 v55, v30, v31
v_mfma_f32_16x16x32_bf16 v[64:67], a[36:39], v[48:51], v[64:67]
v_exp_f32 v33, v33
v_mfma_f32_16x16x32_bf16 v[96:99], a[36:39], v[52:55], v[96:99]
s_waitcnt lgkmcnt(2)
v_add_f32 v4, v4, v30
v_add_f32 v4, v4, v31
ds_read_b128 a[56:59], v1 offset:3072
v_exp_f32 v34, v34
ds_read_b128 a[60:63], v1 offset:19456
v_cvt_pk_bf16_f32 v56, v32, v33
v_mfma_f32_16x16x32_bf16 v[68:71], a[44:47], v[48:51], v[68:71]
v_exp_f32 v35, v35
v_mfma_f32_16x16x32_bf16 v[100:103], a[44:47], v[52:55], v[100:103]
s_waitcnt lgkmcnt(2)
v_add_f32 v3, v3, v32
v_add_f32 v3, v3, v33
ds_read_b128 a[32:35], v1 offset:4096
v_exp_f32 v36, v36
ds_read_b128 a[36:39], v1 offset:20480
v_cvt_pk_bf16_f32 v57, v34, v35
v_mfma_f32_16x16x32_bf16 v[72:75], a[52:55], v[48:51], v[72:75]
v_exp_f32 v37, v37
v_mfma_f32_16x16x32_bf16 v[104:107], a[52:55], v[52:55], v[104:107]
s_waitcnt lgkmcnt(2)
v_add_f32 v3, v3, v34
v_add_f32 v3, v3, v35
ds_read_b128 a[40:43], v1 offset:5120
v_exp_f32 v38, v38
ds_read_b128 a[44:47], v1 offset:21504
v_cvt_pk_bf16_f32 v58, v36, v37
v_mfma_f32_16x16x32_bf16 v[76:79], a[60:63], v[48:51], v[76:79]
v_exp_f32 v39, v39
v_mfma_f32_16x16x32_bf16 v[108:111], a[60:63], v[52:55], v[108:111]
s_waitcnt lgkmcnt(2)
v_add_f32 v3, v3, v36
v_add_f32 v3, v3, v37
ds_read_b128 a[48:51], v1 offset:6144
v_exp_f32 v40, v40
ds_read_b128 a[52:55], v1 offset:22528
v_cvt_pk_bf16_f32 v59, v38, v39
v_mfma_f32_16x16x32_bf16 v[80:83], a[36:39], v[48:51], v[80:83]
v_exp_f32 v41, v41
v_mfma_f32_16x16x32_bf16 v[112:115], a[36:39], v[52:55], v[112:115]
s_waitcnt lgkmcnt(2)
v_add_f32 v3, v3, v38
v_add_f32 v3, v3, v39
ds_read_b128 a[56:59], v1 offset:7168
v_exp_f32 v42, v42
ds_read_b128 a[60:63], v1 offset:23552
v_cvt_pk_bf16_f32 v60, v40, v41
v_mfma_f32_16x16x32_bf16 v[84:87], a[44:47], v[48:51], v[84:87]
v_exp_f32 v43, v43
v_mfma_f32_16x16x32_bf16 v[116:119], a[44:47], v[52:55], v[116:119]
s_waitcnt lgkmcnt(2)
v_add_f32 v4, v4, v40
v_add_f32 v4, v4, v41
ds_read_b128 a[32:35], v1 offset:8192
v_exp_f32 v44, v44
ds_read_b128 a[36:39], v1 offset:24576
v_cvt_pk_bf16_f32 v61, v42, v43
v_mfma_f32_16x16x32_bf16 v[88:91], a[52:55], v[48:51], v[88:91]
v_exp_f32 v45, v45
v_mfma_f32_16x16x32_bf16 v[120:123], a[52:55], v[52:55], v[120:123]
s_waitcnt lgkmcnt(2)
v_add_f32 v4, v4, v42
v_add_f32 v4, v4, v43
ds_read_b128 a[40:43], v1 offset:9216
v_exp_f32 v46, v46
ds_read_b128 a[44:47], v1 offset:25600
v_cvt_pk_bf16_f32 v62, v44, v45
v_mfma_f32_16x16x32_bf16 v[92:95], a[60:63], v[48:51], v[92:95]
v_exp_f32 v47, v47
v_mfma_f32_16x16x32_bf16 v[124:127], a[60:63], v[52:55], v[124:127]
s_waitcnt lgkmcnt(2)
v_add_f32 v4, v4, v44
v_add_f32 v4, v4, v45
ds_read_b128 a[48:51], v1 offset:10240
ds_read_b128 a[52:55], v1 offset:26624
v_cvt_pk_bf16_f32 v63, v46, v47
v_mfma_f32_16x16x32_bf16 v[64:67], a[36:39], v[56:59], v[64:67]
s_nop 1
v_mfma_f32_16x16x32_bf16 v[96:99], a[36:39], v[60:63], v[96:99]
s_waitcnt lgkmcnt(2)
v_add_f32 v4, v4, v46
v_add_f32 v4, v4, v47
ds_read_b128 a[56:59], v1 offset:11264
ds_read_b128 a[60:63], v1 offset:27648
v_mfma_f32_16x16x32_bf16 v[68:71], a[44:47], v[56:59], v[68:71]
v_mfma_f32_16x16x32_bf16 v[100:103], a[44:47], v[60:63], v[100:103]
s_waitcnt lgkmcnt(2)
ds_read_b128 a[32:35], v1 offset:12288
ds_read_b128 a[36:39], v1 offset:28672
v_mfma_f32_16x16x32_bf16 v[72:75], a[52:55], v[56:59], v[72:75]
v_mfma_f32_16x16x32_bf16 v[104:107], a[52:55], v[60:63], v[104:107]
s_waitcnt lgkmcnt(2)
ds_read_b128 a[40:43], v1 offset:13312
ds_read_b128 a[44:47], v1 offset:29696
v_mfma_f32_16x16x32_bf16 v[76:79], a[60:63], v[56:59], v[76:79]
v_mfma_f32_16x16x32_bf16 v[108:111], a[60:63], v[60:63], v[108:111]
s_waitcnt lgkmcnt(2)
ds_read_b128 a[48:51], v1 offset:14336
ds_read_b128 a[52:55], v1 offset:30720
v_mfma_f32_16x16x32_bf16 v[80:83], a[36:39], v[56:59], v[80:83]
v_mfma_f32_16x16x32_bf16 v[112:115], a[36:39], v[60:63], v[112:115]
s_waitcnt lgkmcnt(2)
ds_read_b128 a[56:59], v1 offset:15360
ds_read_b128 a[60:63], v1 offset:31744
v_mfma_f32_16x16x32_bf16 v[84:87], a[44:47], v[56:59], v[84:87]
v_mfma_f32_16x16x32_bf16 v[116:119], a[44:47], v[60:63], v[116:119]
s_waitcnt lgkmcnt(2)
v_mfma_f32_16x16x32_bf16 v[88:91], a[52:55], v[56:59], v[88:91]
v_mfma_f32_16x16x32_bf16 v[120:123], a[52:55], v[60:63], v[120:123]
s_waitcnt lgkmcnt(0)
v_mfma_f32_16x16x32_bf16 v[92:95], a[60:63], v[56:59], v[92:95]
v_mfma_f32_16x16x32_bf16 v[124:127], a[60:63], v[60:63], v[124:127]
s_waitcnt lgkmcnt(0)
s_branch L_diag_1014
L_pathA_1012:
s_setprio 1
s_cmp_eq_u32 s27, 0
s_cbranch_scc1 L_Azero_1022
s_add_u32 s38, s28, 3
s_lshl_b32 s35, s38, 14
s_sub_u32 s36, s35, 16384
s_sub_u32 s39, s38, s26
s_sub_u32 s39, s39, 1
s_bitcmp1_b32 s39, 0
s_cselect_b32 s40, s32, s33
s_and_b32 s39, s39, 2
s_lshl_b32 s39, s39, 13
s_add_u32 s40, s40, s39
s_cmp_le_u32 s38, s26
s_cselect_b32 s35, s35, s40
s_cselect_b32 s36, s36, s40
s_add_u32 s35, s35, s30
s_add_u32 s36, s36, s31
s_add_u32 s37, s53, s34
s_add_u32 s53, s53, 32768
s_cmp_eq_u32 s53, 0x28000
s_cselect_b32 s53, 0, s53
ds_read_b128 a[32:35], v1 offset:0
ds_read_b128 a[36:39], v1 offset:16384
ds_read_b128 a[40:43], v1 offset:1024
ds_read_b128 a[44:47], v1 offset:17408
s_waitcnt lgkmcnt(2)
v_mfma_f32_16x16x32_bf16 v[16:19], a[32:35], a[0:3], 0
ds_read_b128 a[48:51], v1 offset:2048
v_mfma_f32_16x16x32_bf16 v[24:27], a[32:35], a[16:19], 0
ds_read_b128 a[52:55], v1 offset:18432
s_mov_b32 m0, s37
s_nop 0
buffer_load_dwordx4 v5, s[4:7], s35 offen offset:0 sc1 lds
s_waitcnt lgkmcnt(2)
v_mfma_f32_16x16x32_bf16 v[16:19], a[40:43], a[4:7], v[16:19]
ds_read_b128 a[56:59], v1 offset:3072
v_mfma_f32_16x16x32_bf16 v[24:27], a[40:43], a[20:23], v[24:27]
ds_read_b128 a[60:63], v1 offset:19456
buffer_load_dwordx4 v5, s[4:7], s35 offen offset:1024 sc1 lds
s_waitcnt lgkmcnt(2)
v_mfma_f32_16x16x32_bf16 v[16:19], a[48:51], a[8:11], v[16:19]
ds_read_b128 a[32:35], v1 offset:4096
v_mfma_f32_16x16x32_bf16 v[24:27], a[48:51], a[24:27], v[24:27]
ds_read_b128 a[36:39], v1 offset:20480
buffer_load_dwordx4 v5, s[4:7], s35 offen offset:2048 sc1 lds
s_waitcnt lgkmcnt(2)
v_mfma_f32_16x16x32_bf16 v[16:19], a[56:59], a[12:15], v[16:19]
ds_read_b128 a[40:43], v1 offset:5120
v_mfma_f32_16x16x32_bf16 v[24:27], a[56:59], a[28:31], v[24:27]
ds_read_b128 a[44:47], v1 offset:21504
buffer_load_dwordx4 v5, s[4:7], s35 offen offset:3072 sc1 lds
s_waitcnt lgkmcnt(2)
v_mfma_f32_16x16x32_bf16 v[20:23], a[32:35], a[0:3], 0
ds_read_b128 a[48:51], v1 offset:6144
v_mfma_f32_16x16x32_bf16 v[28:31], a[32:35], a[16:19], 0
ds_read_b128 a[52:55], v1 offset:22528
s_add_u32 m0, s37, 16384
s_nop 0
buffer_load_dwordx4 v5, s[4:7], s36 offen offset:0 sc1 lds
s_waitcnt lgkmcnt(2)
v_mfma_f32_16x16x32_bf16 v[20:23], a[40:43], a[4:7], v[20:23]
ds_read_b128 a[56:59], v1 offset:7168
v_mfma_f32_16x16x32_bf16 v[28:31], a[40:43], a[20:23], v[28:31]
ds_read_b128 a[60:63], v1 offset:23552
buffer_load_dwordx4 v5, s[4:7], s36 offen offset:1024 sc1 lds
s_waitcnt lgkmcnt(2)
v_mfma_f32_16x16x32_bf16 v[20:23], a[48:51], a[8:11], v[20:23]
ds_read_b128 a[32:35], v1 offset:8192
v_mfma_f32_16x16x32_bf16 v[28:31], a[48:51], a[24:27], v[28:31]
ds_read_b128 a[36:39], v1 offset:24576
buffer_load_dwordx4 v5, s[4:7], s36 offen offset:2048 sc1 lds
s_waitcnt lgkmcnt(2)
v_mfma_f32_16x16x32_bf16 v[20:23], a[56:59], a[12:15], v[20:23]
ds_read_b128 a[40:43], v1 offset:9216
v_mfma_f32_16x16x32_bf16 v[28:31], a[56:59], a[28:31], v[28:31]
ds_read_b128 a[44:47], v1 offset:25600
buffer_load_dwordx4 v5, s[4:7], s36 offen offset:3072 sc1 lds
s_waitcnt lgkmcnt(2)
s_nop 7
s_cmp_lg_u32 s42, 0
s_cbranch_scc1 L_nomax_1023
v_max3_f32 v6, v16, v17, v18
v_max3_f32 v6, v6, v19, v20
v_max3_f32 v6, v6, v21, v22
v_max_f32 v6, v6, v23
v_mov_b32 v7, v6
s_nop 1
v_permlane16_swap_b32 v6, v7
v_max_f32 v6, v6, v7
v_mov_b32 v7, v6
s_nop 1
v_permlane32_swap_b32 v6, v7
v_max_f32 v6, v6, v7
v_sub_f32 v8, 0, v6
v_sub_f32 v9, 0, v6
v_sub_f32 v10, 0, v6
v_sub_f32 v11, 0, v6
v_max3_f32 v6, v24, v25, v26
v_max3_f32 v6, v6, v27, v28
v_max3_f32 v6, v6, v29, v30
v_max_f32 v6, v6, v31
v_mov_b32 v7, v6
s_nop 1
v_permlane16_swap_b32 v6, v7
v_max_f32 v6, v6, v7
v_mov_b32 v7, v6
s_nop 1
v_permlane32_swap_b32 v6, v7
v_max_f32 v6, v6, v7
v_sub_f32 v12, 0, v6
v_sub_f32 v13, 0, v6
v_sub_f32 v14, 0, v6
v_sub_f32 v15, 0, v6
L_nomax_1023:
v_add_f32 v16, v16, v8
v_add_f32 v17, v17, v8
v_add_f32 v18, v18, v8
v_add_f32 v19, v19, v8
v_add_f32 v20, v20, v8
v_add_f32 v21, v21, v8
v_add_f32 v22, v22, v8
v_add_f32 v23, v23, v8
v_add_f32 v24, v24, v12
v_add_f32 v25, v25, v12
v_add_f32 v26, v26, v12
v_add_f32 v27, v27, v12
v_add_f32 v28, v28, v12
v_add_f32 v29, v29, v12
v_add_f32 v30, v30, v12
v_add_f32 v31, v31, v12
s_nop 1
s_add_u32 s38, s28, 4
s_lshl_b32 s35, s38, 14
s_sub_u32 s36, s35, 16384
s_sub_u32 s39, s38, s26
s_sub_u32 s39, s39, 1
s_bitcmp1_b32 s39, 0
s_cselect_b32 s40, s32, s33
s_and_b32 s39, s39, 2
s_lshl_b32 s39, s39, 13
s_add_u32 s40, s40, s39
s_cmp_le_u32 s38, s26
s_cselect_b32 s35, s35, s40
s_cselect_b32 s36, s36, s40
s_add_u32 s35, s35, s30
s_add_u32 s36, s36, s31
s_add_u32 s37, s53, s34
s_add_u32 s53, s53, 32768
s_cmp_eq_u32 s53, 0x28000
s_cselect_b32 s53, 0, s53
v_mfma_f32_16x16x32_bf16 v[32:35], a[32:35], a[0:3], v[8:11]
ds_read_b128 a[48:51], v1 offset:10240
v_exp_f32 v16, v16
v_mfma_f32_16x16x32_bf16 v[40:43], a[32:35], a[16:19], v[12:15]
ds_read_b128 a[52:55], v1 offset:26624
s_mov_b32 m0, s37
s_nop 0
buffer_load_dwordx4 v5, s[4:7], s35 offen offset:0 sc1 lds
v_exp_f32 v17, v17
s_waitcnt lgkmcnt(2)
v_mfma_f32_16x16x32_bf16 v[32:35], a[40:43], a[4:7], v[32:35]
ds_read_b128 a[56:59], v1 offset:11264
v_exp_f32 v18, v18
v_mfma_f32_16x16x32_bf16 v[40:43], a[40:43], a[20:23], v[40:43]
ds_read_b128 a[60:63], v1 offset:27648
v_cvt_pk_bf16_f32 v48, v16, v17
buffer_load_dwordx4 v5, s[4:7], s35 offen offset:1024 sc1 lds
v_exp_f32 v19, v19
s_waitcnt lgkmcnt(2)
v_add_f32 v3, v3, v16
v_add_f32 v3, v3, v17
v_mfma_f32_16x16x32_bf16 v[32:35], a[48:51], a[8:11], v[32:35]
ds_read_b128 a[32:35], v1 offset:12288
v_exp_f32 v20, v20
v_mfma_f32_16x16x32_bf16 v[40:43], a[48:51], a[24:27], v[40:43]
ds_read_b128 a[36:39], v1 offset:28672
v_cvt_pk_bf16_f32 v49, v18, v19
buffer_load_dwordx4 v5, s[4:7], s35 offen offset:2048 sc1 lds
v_exp_f32 v21, v21
s_waitcnt lgkmcnt(2)
v_add_f32 v3, v3, v18
v_add_f32 v3, v3, v19
v_mfma_f32_16x16x32_bf16 v[32:35], a[56:59], a[12:15], v[32:35]
ds_read_b128 a[40:43], v1 offset:13312
v_exp_f32 v22, v22
v_mfma_f32_16x16x32_bf16 v[40:43], a[56:59], a[28:31], v[40:43]
ds_read_b128 a[44:47], v1 offset:29696
v_cvt_pk_bf16_f32 v50, v20, v21
buffer_load_dwordx4 v5, s[4:7], s35 offen offset:3072 sc1 lds
v_exp_f32 v23, v23
s_waitcnt lgkmcnt(2)
v_add_f32 v3, v3, v20
v_add_f32 v3, v3, v21
v_mfma_f32_16x16x32_bf16 v[36:39], a[32:35], a[0:3], v[8:11]
ds_read_b128 a[48:51], v1 offset:14336
v_exp_f32 v24, v24
v_mfma_f32_16x16x32_bf16 v[44:47], a[32:35], a[16:19], v[12:15]
ds_read_b128 a[52:55], v1 offset:30720
v_cvt_pk_bf16_f32 v51, v22, v23
s_add_u32 s41, s41, 32768
s_add_u32 m0, s37, 16384
s_nop 0
buffer_load_dwordx4 v5, s[4:7], s36 offen offset:0 sc1 lds
v_exp_f32 v25, v25
s_waitcnt lgkmcnt(2)
v_add_f32 v3, v3, v22
v_add_f32 v3, v3, v23
v_mfma_f32_16x16x32_bf16 v[36:39], a[40:43], a[4:7], v[36:39]
ds_read_b128 a[56:59], v1 offset:15360
v_exp_f32 v26, v26
v_mfma_f32_16x16x32_bf16 v[44:47], a[40:43], a[20:23], v[44:47]
ds_read_b128 a[60:63], v1 offset:31744
v_cvt_pk_bf16_f32 v52, v24, v25
s_cmp_eq_u32 s41, 0x28000
s_cselect_b32 s41, 0, s41
buffer_load_dwordx4 v5, s[4:7], s36 offen offset:1024 sc1 lds
v_exp_f32 v27, v27
s_waitcnt lgkmcnt(2)
v_add_f32 v4, v4, v24
v_add_f32 v4, v4, v25
v_add_u32 v1, s41, v5
v_mfma_f32_16x16x32_bf16 v[36:39], a[48:51], a[8:11], v[36:39]
ds_read_b128 a[32:35], v1 offset:0
v_exp_f32 v28, v28
v_mfma_f32_16x16x32_bf16 v[44:47], a[48:51], a[24:27], v[44:47]
ds_read_b128 a[36:39], v1 offset:16384
v_cvt_pk_bf16_f32 v53, v26, v27
buffer_load_dwordx4 v5, s[4:7], s36 offen offset:2048 sc1 lds
v_exp_f32 v29, v29
s_waitcnt lgkmcnt(2)
v_add_f32 v4, v4, v26
v_add_f32 v4, v4, v27
v_mfma_f32_16x16x32_bf16 v[36:39], a[56:59], a[12:15], v[36:39]
ds_read_b128 a[40:43], v1 offset:1024
v_exp_f32 v30, v30
v_mfma_f32_16x16x32_bf16 v[44:47], a[56:59], a[28:31], v[44:47]
ds_read_b128 a[44:47], v1 offset:17408
v_cvt_pk_bf16_f32 v54, v28, v29
buffer_load_dwordx4 v5, s[4:7], s36 offen offset:3072 sc1 lds
v_exp_f32 v31, v31
s_waitcnt lgkmcnt(2)
v_add_f32 v4, v4, v28
v_add_f32 v4, v4, v29
v_mfma_f32_16x16x32_bf16 v[16:19], a[32:35], a[0:3], v[8:11]
ds_read_b128 a[48:51], v1 offset:2048
v_exp_f32 v32, v32
v_mfma_f32_16x16x32_bf16 v[24:27], a[32:35], a[16:19], v[12:15]
ds_read_b128 a[52:55], v1 offset:18432
v_cvt_pk_bf16_f32 v55, v30, v31
v_mfma_f32_16x16x32_bf16 v[64:67], a[36:39], v[48:51], 0
v_exp_f32 v33, v33
v_mfma_f32_16x16x32_bf16 v[96:99], a[36:39], v[52:55], 0
s_waitcnt lgkmcnt(2)
v_add_f32 v4, v4, v30
v_add_f32 v4, v4, v31
v_mfma_f32_16x16x32_bf16 v[16:19], a[40:43], a[4:7], v[16:19]
ds_read_b128 a[56:59], v1 offset:3072
v_exp_f32 v34, v34
v_mfma_f32_16x16x32_bf16 v[24:27], a[40:43], a[20:23], v[24:27]
ds_read_b128 a[60:63], v1 offset:19456
v_cvt_pk_bf16_f32 v56, v32, v33
v_mfma_f32_16x16x32_bf16 v[68:71], a[44:47], v[48:51], 0
v_exp_f32 v35, v35
v_mfma_f32_16x16x32_bf16 v[100:103], a[44:47], v[52:55], 0
s_waitcnt lgkmcnt(2)
v_add_f32 v3, v3, v32
v_add_f32 v3, v3, v33
v_mfma_f32_16x16x32_bf16 v[16:19], a[48:51], a[8:11], v[16:19]
ds_read_b128 a[32:35], v1 offset:4096
v_exp_f32 v36, v36
v_mfma_f32_16x16x32_bf16 v[24:27], a[48:51], a[24:27], v[24:27]
ds_read_b128 a[36:39], v1 offset:20480
v_cvt_pk_bf16_f32 v57, v34, v35
v_mfma_f32_16x16x32_bf16 v[72:75], a[52:55], v[48:51], 0
v_exp_f32 v37, v37
v_mfma_f32_16x16x32_bf16 v[104:107], a[52:55], v[52:55], 0
s_waitcnt lgkmcnt(2)
v_add_f32 v3, v3, v34
v_add_f32 v3, v3, v35
v_mfma_f32_16x16x32_bf16 v[16:19], a[56:59], a[12:15], v[16:19]
ds_read_b128 a[40:43], v1 offset:5120
v_exp_f32 v38, v38
v_mfma_f32_16x16x32_bf16 v[24:27], a[56:59], a[28:31], v[24:27]
ds_read_b128 a[44:47], v1 offset:21504
v_cvt_pk_bf16_f32 v58, v36, v37
v_mfma_f32_16x16x32_bf16 v[76:79], a[60:63], v[48:51], 0
v_exp_f32 v39, v39
v_mfma_f32_16x16x32_bf16 v[108:111], a[60:63], v[52:55], 0
s_waitcnt lgkmcnt(2)
v_add_f32 v3, v3, v36
v_add_f32 v3, v3, v37
v_mfma_f32_16x16x32_bf16 v[20:23], a[32:35], a[0:3], v[8:11]
ds_read_b128 a[48:51], v1 offset:6144
v_exp_f32 v40, v40
v_mfma_f32_16x16x32_bf16 v[28:31], a[32:35], a[16:19], v[12:15]
ds_read_b128 a[52:55], v1 offset:22528
v_cvt_pk_bf16_f32 v59, v38, v39
v_mfma_f32_16x16x32_bf16 v[80:83], a[36:39], v[48:51], 0
v_exp_f32 v41, v41
v_mfma_f32_16x16x32_bf16 v[112:115], a[36:39], v[52:55], 0
s_waitcnt lgkmcnt(2)
v_add_f32 v3, v3, v38
v_add_f32 v3, v3, v39
v_mfma_f32_16x16x32_bf16 v[20:23], a[40:43], a[4:7], v[20:23]
ds_read_b128 a[56:59], v1 offset:7168
v_exp_f32 v42, v42
v_mfma_f32_16x16x32_bf16 v[28:31], a[40:43], a[20:23], v[28:31]
ds_read_b128 a[60:63], v1 offset:23552
v_cvt_pk_bf16_f32 v60, v40, v41
v_mfma_f32_16x16x32_bf16 v[84:87], a[44:47], v[48:51], 0
v_exp_f32 v43, v43
v_mfma_f32_16x16x32_bf16 v[116:119], a[44:47], v[52:55], 0
s_waitcnt lgkmcnt(2)
v_add_f32 v4, v4, v40
v_add_f32 v4, v4, v41
v_mfma_f32_16x16x32_bf16 v[20:23], a[48:51], a[8:11], v[20:23]
ds_read_b128 a[32:35], v1 offset:8192
v_exp_f32 v44, v44
v_mfma_f32_16x16x32_bf16 v[28:31], a[48:51], a[24:27], v[28:31]
ds_read_b128 a[36:39], v1 offset:24576
v_cvt_pk_bf16_f32 v61, v42, v43
v_mfma_f32_16x16x32_bf16 v[88:91], a[52:55], v[48:51], 0
v_exp_f32 v45, v45
v_mfma_f32_16x16x32_bf16 v[120:123], a[52:55], v[52:55], 0
s_waitcnt lgkmcnt(2)
v_add_f32 v4, v4, v42
v_add_f32 v4, v4, v43
v_mfma_f32_16x16x32_bf16 v[20:23], a[56:59], a[12:15], v[20:23]
ds_read_b128 a[40:43], v1 offset:9216
v_exp_f32 v46, v46
v_mfma_f32_16x16x32_bf16 v[28:31], a[56:59], a[28:31], v[28:31]
ds_read_b128 a[44:47], v1 offset:25600
v_cvt_pk_bf16_f32 v62, v44, v45
v_mfma_f32_16x16x32_bf16 v[92:95], a[60:63], v[48:51], 0
v_exp_f32 v47, v47
v_mfma_f32_16x16x32_bf16 v[124:127], a[60:63], v[52:55], 0
s_waitcnt lgkmcnt(2)
v_add_f32 v4, v4, v44
v_add_f32 v4, v4, v45
v_mfma_f32_16x16x32_bf16 v[32:35], a[32:35], a[0:3], v[8:11]
ds_read_b128 a[48:51], v1 offset:10240
v_exp_f32 v16, v16
v_mfma_f32_16x16x32_bf16 v[40:43], a[32:35], a[16:19], v[12:15]
ds_read_b128 a[52:55], v1 offset:26624
v_cvt_pk_bf16_f32 v63, v46, v47
v_mfma_f32_16x16x32_bf16 v[64:67], a[36:39], v[56:59], v[64:67]
v_exp_f32 v17, v17
v_mfma_f32_16x16x32_bf16 v[96:99], a[36:39], v[60:63], v[96:99]
s_waitcnt lgkmcnt(2)
v_add_f32 v4, v4, v46
v_add_f32 v4, v4, v47
v_mfma_f32_16x16x32_bf16 v[32:35], a[40:43], a[4:7], v[32:35]
ds_read_b128 a[56:59], v1 offset:11264
v_exp_f32 v18, v18
v_mfma_f32_16x16x32_bf16 v[40:43], a[40:43], a[20:23], v[40:43]
ds_read_b128 a[60:63], v1 offset:27648
v_cvt_pk_bf16_f32 v48, v16, v17
v_mfma_f32_16x16x32_bf16 v[68:71], a[44:47], v[56:59], v[68:71]
v_exp_f32 v19, v19
v_mfma_f32_16x16x32_bf16 v[100:103], a[44:47], v[60:63], v[100:103]
s_waitcnt lgkmcnt(2)
v_add_f32 v3, v3, v16
v_add_f32 v3, v3, v17
v_mfma_f32_16x16x32_bf16 v[32:35], a[48:51], a[8:11], v[32:35]
ds_read_b128 a[32:35], v1 offset:12288
v_exp_f32 v20, v20
v_mfma_f32_16x16x32_bf16 v[40:43], a[48:51], a[24:27], v[40:43]
ds_read_b128 a[36:39], v1 offset:28672
v_cvt_pk_bf16_f32 v49, v18, v19
v_mfma_f32_16x16x32_bf16 v[72:75], a[52:55], v[56:59], v[72:75]
v_exp_f32 v21, v21
v_mfma_f32_16x16x32_bf16 v[104:107], a[52:55], v[60:63], v[104:107]
s_waitcnt lgkmcnt(2)
v_add_f32 v3, v3, v18
v_add_f32 v3, v3, v19
v_mfma_f32_16x16x32_bf16 v[32:35], a[56:59], a[12:15], v[32:35]
ds_read_b128 a[40:43], v1 offset:13312
v_exp_f32 v22, v22
v_mfma_f32_16x16x32_bf16 v[40:43], a[56:59], a[28:31], v[40:43]
ds_read_b128 a[44:47], v1 offset:29696
v_cvt_pk_bf16_f32 v50, v20, v21
v_mfma_f32_16x16x32_bf16 v[76:79], a[60:63], v[56:59], v[76:79]
v_exp_f32 v23, v23
v_mfma_f32_16x16x32_bf16 v[108:111], a[60:63], v[60:63], v[108:111]
s_waitcnt lgkmcnt(2)
v_add_f32 v3, v3, v20
v_add_f32 v3, v3, v21
v_mfma_f32_16x16x32_bf16 v[36:39], a[32:35], a[0:3], v[8:11]
ds_read_b128 a[48:51], v1 offset:14336
v_exp_f32 v24, v24
v_mfma_f32_16x16x32_bf16 v[44:47], a[32:35], a[16:19], v[12:15]
ds_read_b128 a[52:55], v1 offset:30720
v_cvt_pk_bf16_f32 v51, v22, v23
v_mfma_f32_16x16x32_bf16 v[80:83], a[36:39], v[56:59], v[80:83]
s_add_u32 s41, s41, 32768
v_exp_f32 v25, v25
v_mfma_f32_16x16x32_bf16 v[112:115], a[36:39], v[60:63], v[112:115]
s_waitcnt lgkmcnt(2)
v_add_f32 v3, v3, v22
v_add_f32 v3, v3, v23
v_mfma_f32_16x16x32_bf16 v[36:39], a[40:43], a[4:7], v[36:39]
ds_read_b128 a[56:59], v1 offset:15360
v_exp_f32 v26, v26
v_mfma_f32_16x16x32_bf16 v[44:47], a[40:43], a[20:23], v[44:47]
ds_read_b128 a[60:63], v1 offset:31744
v_cvt_pk_bf16_f32 v52, v24, v25
v_mfma_f32_16x16x32_bf16 v[84:87], a[44:47], v[56:59], v[84:87]
s_cmp_eq_u32 s41, 0x28000
s_cselect_b32 s41, 0, s41
v_exp_f32 v27, v27
v_mfma_f32_16x16x32_bf16 v[116:119], a[44:47], v[60:63], v[116:119]
s_waitcnt lgkmcnt(2)
v_add_f32 v4, v4, v24
v_add_f32 v4, v4, v25
v_add_u32 v1, s41, v5
v_mfma_f32_16x16x32_bf16 v[36:39], a[48:51], a[8:11], v[36:39]
ds_read_b128 a[32:35], v1 offset:0
v_exp_f32 v28, v28
v_mfma_f32_16x16x32_bf16 v[44:47], a[48:51], a[24:27], v[44:47]
ds_read_b128 a[36:39], v1 offset:16384
v_cvt_pk_bf16_f32 v53, v26, v27
v_mfma_f32_16x16x32_bf16 v[88:91], a[52:55], v[56:59], v[88:91]
v_exp_f32 v29, v29
v_mfma_f32_16x16x32_bf16 v[120:123], a[52:55], v[60:63], v[120:123]
s_waitcnt lgkmcnt(2)
v_add_f32 v4, v4, v26
v_add_f32 v4, v4, v27
v_mfma_f32_16x16x32_bf16 v[36:39], a[56:59], a[12:15], v[36:39]
ds_read_b128 a[40:43], v1 offset:1024
v_exp_f32 v30, v30
v_mfma_f32_16x16x32_bf16 v[44:47], a[56:59], a[28:31], v[44:47]
ds_read_b128 a[44:47], v1 offset:17408
v_cvt_pk_bf16_f32 v54, v28, v29
v_mfma_f32_16x16x32_bf16 v[92:95], a[60:63], v[56:59], v[92:95]
v_exp_f32 v31, v31
v_mfma_f32_16x16x32_bf16 v[124:127], a[60:63], v[60:63], v[124:127]
s_waitcnt lgkmcnt(2)
v_add_f32 v4, v4, v28
v_add_f32 v4, v4, v29
s_lshr_b32 s29, s27, 1
s_sub_u32 s29, s29, 1
s_cmp_eq_u32 s29, 0
s_cbranch_scc1 L_Adrain_1020
L_Aloop_1021:
s_add_u32 s28, s28, 2
s_waitcnt vmcnt(0)
s_barrier
s_add_u32 s38, s28, 3
s_lshl_b32 s35, s38, 14
s_sub_u32 s36, s35, 16384
s_sub_u32 s39, s38, s26
s_sub_u32 s39, s39, 1
s_bitcmp1_b32 s39, 0
s_cselect_b32 s40, s32, s33
s_and_b32 s39, s39, 2
s_lshl_b32 s39, s39, 13
s_add_u32 s40, s40, s39
s_cmp_le_u32 s38, s26
s_cselect_b32 s35, s35, s40
s_cselect_b32 s36, s36, s40
s_add_u32 s35, s35, s30
s_add_u32 s36, s36, s31
s_add_u32 s37, s53, s34
s_add_u32 s53, s53, 32768
s_cmp_eq_u32 s53, 0x28000
s_cselect_b32 s53, 0, s53
v_mfma_f32_16x16x32_bf16 v[16:19], a[32:35], a[0:3], v[8:11]
ds_read_b128 a[48:51], v1 offset:2048
v_exp_f32 v32, v32
v_mfma_f32_16x16x32_bf16 v[24:27], a[32:35], a[16:19], v[12:15]
ds_read_b128 a[52:55], v1 offset:18432
v_cvt_pk_bf16_f32 v55, v30, v31
v_mfma_f32_16x16x32_bf16 v[64:67], a[36:39], v[48:51], v[64:67]
s_mov_b32 m0, s37
s_nop 0
buffer_load_dwordx4 v5, s[4:7], s35 offen offset:0 sc1 lds
v_exp_f32 v33, v33
v_mfma_f32_16x16x32_bf16 v[96:99], a[36:39], v[52:55], v[96:99]
s_waitcnt lgkmcnt(2)
v_add_f32 v4, v4, v30
v_add_f32 v4, v4, v31
v_mfma_f32_16x16x32_bf16 v[16:19], a[40:43], a[4:7], v[16:19]
ds_read_b128 a[56:59], v1 offset:3072
v_exp_f32 v34, v34
v_mfma_f32_16x16x32_bf16 v[24:27], a[40:43], a[20:23], v[24:27]
ds_read_b128 a[60:63], v1 offset:19456
v_cvt_pk_bf16_f32 v56, v32, v33
v_mfma_f32_16x16x32_bf16 v[68:71], a[44:47], v[48:51], v[68:71]
buffer_load_dwordx4 v5, s[4:7], s35 offen offset:1024 sc1 lds
v_exp_f32 v35, v35
v_mfma_f32_16x16x32_bf16 v[100:103], a[44:47], v[52:55], v[100:103]
s_waitcnt lgkmcnt(2)
v_add_f32 v3, v3, v32
v_add_f32 v3, v3, v33
v_mfma_f32_16x16x32_bf16 v[16:19], a[48:51], a[8:11], v[16:19]
ds_read_b128 a[32:35], v1 offset:4096
v_exp_f32 v36, v36
v_mfma_f32_16x16x32_bf16 v[24:27], a[48:51], a[24:27], v[24:27]
ds_read_b128 a[36:39], v1 offset:20480
v_cvt_pk_bf16_f32 v57, v34, v35
v_mfma_f32_16x16x32_bf16 v[72:75], a[52:55], v[48:51], v[72:75]
buffer_load_dwordx4 v5, s[4:7], s35 offen offset:2048 sc1 lds
v_exp_f32 v37, v37
v_mfma_f32_16x16x32_bf16 v[104:107], a[52:55], v[52:55], v[104:107]
s_waitcnt lgkmcnt(2)
v_add_f32 v3, v3, v34
v_add_f32 v3, v3, v35
v_mfma_f32_16x16x32_bf16 v[16:19], a[56:59], a[12:15], v[16:19]
ds_read_b128 a[40:43], v1 offset:5120
v_exp_f32 v38, v38
v_mfma_f32_16x16x32_bf16 v[24:27], a[56:59], a[28:31], v[24:27]
ds_read_b128 a[44:47], v1 offset:21504
v_cvt_pk_bf16_f32 v58, v36, v37
v_mfma_f32_16x16x32_bf16 v[76:79], a[60:63], v[48:51], v[76:79]
buffer_load_dwordx4 v5, s[4:7], s35 offen offset:3072 sc1 lds
v_exp_f32 v39, v39
v_mfma_f32_16x16x32_bf16 v[108:111], a[60:63], v[52:55], v[108:111]
s_waitcnt lgkmcnt(2)
v_add_f32 v3, v3, v36
v_add_f32 v3, v3, v37
v_mfma_f32_16x16x32_bf16 v[20:23], a[32:35], a[0:3], v[8:11]
ds_read_b128 a[48:51], v1 offset:6144
v_exp_f32 v40, v40
v_mfma_f32_16x16x32_bf16 v[28:31], a[32:35], a[16:19], v[12:15]
ds_read_b128 a[52:55], v1 offset:22528
v_cvt_pk_bf16_f32 v59, v38, v39
v_mfma_f32_16x16x32_bf16 v[80:83], a[36:39], v[48:51], v[80:83]
s_add_u32 m0, s37, 16384
s_nop 0
buffer_load_dwordx4 v5, s[4:7], s36 offen offset:0 sc1 lds
v_exp_f32 v41, v41
v_mfma_f32_16x16x32_bf16 v[112:115], a[36:39], v[52:55], v[112:115]
s_waitcnt lgkmcnt(2)
v_add_f32 v3, v3, v38
v_add_f32 v3, v3, v39
v_mfma_f32_16x16x32_bf16 v[20:23], a[40:43], a[4:7], v[20:23]
ds_read_b128 a[56:59], v1 offset:7168
v_exp_f32 v42, v42
v_mfma_f32_16x16x32_bf16 v[28:31], a[40:43], a[20:23], v[28:31]
ds_read_b128 a[60:63], v1 offset:23552
v_cvt_pk_bf16_f32 v60, v40, v41
v_mfma_f32_16x16x32_bf16 v[84:87], a[44:47], v[48:51], v[84:87]
buffer_load_dwordx4 v5, s[4:7], s36 offen offset:1024 sc1 lds
v_exp_f32 v43, v43
v_mfma_f32_16x16x32_bf16 v[116:119], a[44:47], v[52:55], v[116:119]
s_waitcnt lgkmcnt(2)
v_add_f32 v4, v4, v40
v_add_f32 v4, v4, v41
v_mfma_f32_16x16x32_bf16 v[20:23], a[48:51], a[8:11], v[20:23]
ds_read_b128 a[32:35], v1 offset:8192
v_exp_f32 v44, v44
v_mfma_f32_16x16x32_bf16 v[28:31], a[48:51], a[24:27], v[28:31]
ds_read_b128 a[36:39], v1 offset:24576
v_cvt_pk_bf16_f32 v61, v42, v43
v_mfma_f32_16x16x32_bf16 v[88:91], a[52:55], v[48:51], v[88:91]
buffer_load_dwordx4 v5, s[4:7], s36 offen offset:2048 sc1 lds
v_exp_f32 v45, v45
v_mfma_f32_16x16x32_bf16 v[120:123], a[52:55], v[52:55], v[120:123]
s_waitcnt lgkmcnt(2)
v_add_f32 v4, v4, v42
v_add_f32 v4, v4, v43
v_mfma_f32_16x16x32_bf16 v[20:23], a[56:59], a[12:15], v[20:23]
ds_read_b128 a[40:43], v1 offset:9216
v_exp_f32 v46, v46
v_mfma_f32_16x16x32_bf16 v[28:31], a[56:59], a[28:31], v[28:31]
ds_read_b128 a[44:47], v1 offset:25600
v_cvt_pk_bf16_f32 v62, v44, v45
v_mfma_f32_16x16x32_bf16 v[92:95], a[60:63], v[48:51], v[92:95]
buffer_load_dwordx4 v5, s[4:7], s36 offen offset:3072 sc1 lds
v_exp_f32 v47, v47
v_mfma_f32_16x16x32_bf16 v[124:127], a[60:63], v[52:55], v[124:127]
s_waitcnt lgkmcnt(2)
v_add_f32 v4, v4, v44
v_add_f32 v4, v4, v45
s_add_u32 s38, s28, 4
s_lshl_b32 s35, s38, 14
s_sub_u32 s36, s35, 16384
s_sub_u32 s39, s38, s26
s_sub_u32 s39, s39, 1
s_bitcmp1_b32 s39, 0
s_cselect_b32 s40, s32, s33
s_and_b32 s39, s39, 2
s_lshl_b32 s39, s39, 13
s_add_u32 s40, s40, s39
s_cmp_le_u32 s38, s26
s_cselect_b32 s35, s35, s40
s_cselect_b32 s36, s36, s40
s_add_u32 s35, s35, s30
s_add_u32 s36, s36, s31
s_add_u32 s37, s53, s34
s_add_u32 s53, s53, 32768
s_cmp_eq_u32 s53, 0x28000
s_cselect_b32 s53, 0, s53
v_mfma_f32_16x16x32_bf16 v[32:35], a[32:35], a[0:3], v[8:11]
ds_read_b128 a[48:51], v1 offset:10240
v_exp_f32 v16, v16
v_mfma_f32_16x16x32_bf16 v[40:43], a[32:35], a[16:19], v[12:15]
ds_read_b128 a[52:55], v1 offset:26624
v_cvt_pk_bf16_f32 v63, v46, v47
v_mfma_f32_16x16x32_bf16 v[64:67], a[36:39], v[56:59], v[64:67]
s_mov_b32 m0, s37
s_nop 0
buffer_load_dwordx4 v5, s[4:7], s35 offen offset:0 sc1 lds
v_exp_f32 v17, v17
v_mfma_f32_16x16x32_bf16 v[96:99], a[36:39], v[60:63], v[96:99]
s_waitcnt lgkmcnt(2)
v_add_f32 v4, v4, v46
v_add_f32 v4, v4, v47
v_mfma_f32_16x16x32_bf16 v[32:35], a[40:43], a[4:7], v[32:35]
ds_read_b128 a[56:59], v1 offset:11264
v_exp_f32 v18, v18
v_mfma_f32_16x16x32_bf16 v[40:43], a[40:43], a[20:23], v[40:43]
ds_read_b128 a[60:63], v1 offset:27648
v_cvt_pk_bf16_f32 v48, v16, v17
v_mfma_f32_16x16x32_bf16 v[68:71], a[44:47], v[56:59], v[68:71]
buffer_load_dwordx4 v5, s[4:7], s35 offen offset:1024 sc1 lds
v_exp_f32 v19, v19
v_mfma_f32_16x16x32_bf16 v[100:103], a[44:47], v[60:63], v[100:103]
s_waitcnt lgkmcnt(2)
v_add_f32 v3, v3, v16
v_add_f32 v3, v3, v17
v_mfma_f32_16x16x32_bf16 v[32:35], a[48:51], a[8:11], v[32:35]
ds_read_b128 a[32:35], v1 offset:12288
v_exp_f32 v20, v20
v_mfma_f32_16x16x32_bf16 v[40:43], a[48:51], a[24:27], v[40:43]
ds_read_b128 a[36:39], v1 offset:28672
v_cvt_pk_bf16_f32 v49, v18, v19
v_mfma_f32_16x16x32_bf16 v[72:75], a[52:55], v[56:59], v[72:75]
buffer_load_dwordx4 v5, s[4:7], s35 offen offset:2048 sc1 lds
v_exp_f32 v21, v21
v_mfma_f32_16x16x32_bf16 v[104:107], a[52:55], v[60:63], v[104:107]
s_waitcnt lgkmcnt(2)
v_add_f32 v3, v3, v18
v_add_f32 v3, v3, v19
v_mfma_f32_16x16x32_bf16 v[32:35], a[56:59], a[12:15], v[32:35]
ds_read_b128 a[40:43], v1 offset:13312
v_exp_f32 v22, v22
v_mfma_f32_16x16x32_bf16 v[40:43], a[56:59], a[28:31], v[40:43]
ds_read_b128 a[44:47], v1 offset:29696
v_cvt_pk_bf16_f32 v50, v20, v21
v_mfma_f32_16x16x32_bf16 v[76:79], a[60:63], v[56:59], v[76:79]
buffer_load_dwordx4 v5, s[4:7], s35 offen offset:3072 sc1 lds
v_exp_f32 v23, v23
v_mfma_f32_16x16x32_bf16 v[108:111], a[60:63], v[60:63], v[108:111]
s_waitcnt lgkmcnt(2)
v_add_f32 v3, v3, v20
v_add_f32 v3, v3, v21
v_mfma_f32_16x16x32_bf16 v[36:39], a[32:35], a[0:3], v[8:11]
ds_read_b128 a[48:51], v1 offset:14336
v_exp_f32 v24, v24
v_mfma_f32_16x16x32_bf16 v[44:47], a[32:35], a[16:19], v[12:15]
ds_read_b128 a[52:55], v1 offset:30720
v_cvt_pk_bf16_f32 v51, v22, v23
v_mfma_f32_16x16x32_bf16 v[80:83], a[36:39], v[56:59], v[80:83]
s_add_u32 s41, s41, 32768
s_add_u32 m0, s37, 16384
s_nop 0
buffer_load_dwordx4 v5, s[4:7], s36 offen offset:0 sc1 lds
v_exp_f32 v25, v25
v_mfma_f32_16x16x32_bf16 v[112:115], a[36:39], v[60:63], v[112:115]
s_waitcnt lgkmcnt(2)
v_add_f32 v3, v3, v22
v_add_f32 v3, v3, v23
v_mfma_f32_16x16x32_bf16 v[36:39], a[40:43], a[4:7], v[36:39]
ds_read_b128 a[56:59], v1 offset:15360
v_exp_f32 v26, v26
v_mfma_f32_16x16x32_bf16 v[44:47], a[40:43], a[20:23], v[44:47]
ds_read_b128 a[60:63], v1 offset:31744
v_cvt_pk_bf16_f32 v52, v24, v25
v_mfma_f32_16x16x32_bf16 v[84:87], a[44:47], v[56:59], v[84:87]
s_cmp_eq_u32 s41, 0x28000
s_cselect_b32 s41, 0, s41
buffer_load_dwordx4 v5, s[4:7], s36 offen offset:1024 sc1 lds
v_exp_f32 v27, v27
v_mfma_f32_16x16x32_bf16 v[116:119], a[44:47], v[60:63], v[116:119]
s_waitcnt lgkmcnt(2)
v_add_f32 v4, v4, v24
v_add_f32 v4, v4, v25
v_add_u32 v1, s41, v5
v_mfma_f32_16x16x32_bf16 v[36:39], a[48:51], a[8:11], v[36:39]
ds_read_b128 a[32:35], v1 offset:0
v_exp_f32 v28, v28
v_mfma_f32_16x16x32_bf16 v[44:47], a[48:51], a[24:27], v[44:47]
ds_read_b128 a[36:39], v1 offset:16384
v_cvt_pk_bf16_f32 v53, v26, v27
v_mfma_f32_16x16x32_bf16 v[88:91], a[52:55], v[56:59], v[88:91]
buffer_load_dwordx4 v5, s[4:7], s36 offen offset:2048 sc1 lds
v_exp_f32 v29, v29
v_mfma_f32_16x16x32_bf16 v[120:123], a[52:55], v[60:63], v[120:123]
s_waitcnt lgkmcnt(2)
v_add_f32 v4, v4, v26
v_add_f32 v4, v4, v27
v_mfma_f32_16x16x32_bf16 v[36:39], a[56:59], a[12:15], v[36:39]
ds_read_b128 a[40:43], v1 offset:1024
v_exp_f32 v30, v30
v_mfma_f32_16x16x32_bf16 v[44:47], a[56:59], a[28:31], v[44:47]
ds_read_b128 a[44:47], v1 offset:17408
v_cvt_pk_bf16_f32 v54, v28, v29
v_mfma_f32_16x16x32_bf16 v[92:95], a[60:63], v[56:59], v[92:95]
buffer_load_dwordx4 v5, s[4:7], s36 offen offset:3072 sc1 lds
v_exp_f32 v31, v31
v_mfma_f32_16x16x32_bf16 v[124:127], a[60:63], v[60:63], v[124:127]
s_waitcnt lgkmcnt(2)
v_add_f32 v4, v4, v28
v_add_f32 v4, v4, v29
v_mfma_f32_16x16x32_bf16 v[16:19], a[32:35], a[0:3], v[8:11]
ds_read_b128 a[48:51], v1 offset:2048
v_exp_f32 v32, v32
v_mfma_f32_16x16x32_bf16 v[24:27], a[32:35], a[16:19], v[12:15]
ds_read_b128 a[52:55], v1 offset:18432
v_cvt_pk_bf16_f32 v55, v30, v31
v_mfma_f32_16x16x32_bf16 v[64:67], a[36:39], v[48:51], v[64:67]
v_exp_f32 v33, v33
v_mfma_f32_16x16x32_bf16 v[96:99], a[36:39], v[52:55], v[96:99]
s_waitcnt lgkmcnt(2)
v_add_f32 v4, v4, v30
v_add_f32 v4, v4, v31
v_mfma_f32_16x16x32_bf16 v[16:19], a[40:43], a[4:7], v[16:19]
ds_read_b128 a[56:59], v1 offset:3072
v_exp_f32 v34, v34
v_mfma_f32_16x16x32_bf16 v[24:27], a[40:43], a[20:23], v[24:27]
ds_read_b128 a[60:63], v1 offset:19456
v_cvt_pk_bf16_f32 v56, v32, v33
v_mfma_f32_16x16x32_bf16 v[68:71], a[44:47], v[48:51], v[68:71]
v_exp_f32 v35, v35
v_mfma_f32_16x16x32_bf16 v[100:103], a[44:47], v[52:55], v[100:103]
s_waitcnt lgkmcnt(2)
v_add_f32 v3, v3, v32
v_add_f32 v3, v3, v33
v_mfma_f32_16x16x32_bf16 v[16:19], a[48:51], a[8:11], v[16:19]
ds_read_b128 a[32:35], v1 offset:4096
v_exp_f32 v36, v36
v_mfma_f32_16x16x32_bf16 v[24:27], a[48:51], a[24:27], v[24:27]
ds_read_b128 a[36:39], v1 offset:20480
v_cvt_pk_bf16_f32 v57, v34, v35
v_mfma_f32_16x16x32_bf16 v[72:75], a[52:55], v[48:51], v[72:75]
v_exp_f32 v37, v37
v_mfma_f32_16x16x32_bf16 v[104:107], a[52:55], v[52:55], v[104:107]
s_waitcnt lgkmcnt(2)
v_add_f32 v3, v3, v34
v_add_f32 v3, v3, v35
v_mfma_f32_16x16x32_bf16 v[16:19], a[56:59], a[12:15], v[16:19]
ds_read_b128 a[40:43], v1 offset:5120
v_exp_f32 v38, v38
v_mfma_f32_16x16x32_bf16 v[24:27], a[56:59], a[28:31], v[24:27]
ds_read_b128 a[44:47], v1 offset:21504
v_cvt_pk_bf16_f32 v58, v36, v37
v_mfma_f32_16x16x32_bf16 v[76:79], a[60:63], v[48:51], v[76:79]
v_exp_f32 v39, v39
v_mfma_f32_16x16x32_bf16 v[108:111], a[60:63], v[52:55], v[108:111]
s_waitcnt lgkmcnt(2)
v_add_f32 v3, v3, v36
v_add_f32 v3, v3, v37
v_mfma_f32_16x16x32_bf16 v[20:23], a[32:35], a[0:3], v[8:11]
ds_read_b128 a[48:51], v1 offset:6144
v_exp_f32 v40, v40
v_mfma_f32_16x16x32_bf16 v[28:31], a[32:35], a[16:19], v[12:15]
ds_read_b128 a[52:55], v1 offset:22528
v_cvt_pk_bf16_f32 v59, v38, v39
v_mfma_f32_16x16x32_bf16 v[80:83], a[36:39], v[48:51], v[80:83]
v_exp_f32 v41, v41
v_mfma_f32_16x16x32_bf16 v[112:115], a[36:39], v[52:55], v[112:115]
s_waitcnt lgkmcnt(2)
v_add_f32 v3, v3, v38
v_add_f32 v3, v3, v39
v_mfma_f32_16x16x32_bf16 v[20:23], a[40:43], a[4:7], v[20:23]
ds_read_b128 a[56:59], v1 offset:7168
v_exp_f32 v42, v42
v_mfma_f32_16x16x32_bf16 v[28:31], a[40:43], a[20:23], v[28:31]
ds_read_b128 a[60:63], v1 offset:23552
v_cvt_pk_bf16_f32 v60, v40, v41
v_mfma_f32_16x16x32_bf16 v[84:87], a[44:47], v[48:51], v[84:87]
v_exp_f32 v43, v43
v_mfma_f32_16x16x32_bf16 v[116:119], a[44:47], v[52:55], v[116:119]
s_waitcnt lgkmcnt(2)
v_add_f32 v4, v4, v40
v_add_f32 v4, v4, v41
v_mfma_f32_16x16x32_bf16 v[20:23], a[48:51], a[8:11], v[20:23]
ds_read_b128 a[32:35], v1 offset:8192
v_exp_f32 v44, v44
v_mfma_f32_16x16x32_bf16 v[28:31], a[48:51], a[24:27], v[28:31]
ds_read_b128 a[36:39], v1 offset:24576
v_cvt_pk_bf16_f32 v61, v42, v43
v_mfma_f32_16x16x32_bf16 v[88:91], a[52:55], v[48:51], v[88:91]
v_exp_f32 v45, v45
v_mfma_f32_16x16x32_bf16 v[120:123], a[52:55], v[52:55], v[120:123]
s_waitcnt lgkmcnt(2)
v_add_f32 v4, v4, v42
v_add_f32 v4, v4, v43
v_mfma_f32_16x16x32_bf16 v[20:23], a[56:59], a[12:15], v[20:23]
ds_read_b128 a[40:43], v1 offset:9216
v_exp_f32 v46, v46
v_mfma_f32_16x16x32_bf16 v[28:31], a[56:59], a[28:31], v[28:31]
ds_read_b128 a[44:47], v1 offset:25600
v_cvt_pk_bf16_f32 v62, v44, v45
v_mfma_f32_16x16x32_bf16 v[92:95], a[60:63], v[48:51], v[92:95]
v_exp_f32 v47, v47
v_mfma_f32_16x16x32_bf16 v[124:127], a[60:63], v[52:55], v[124:127]
s_waitcnt lgkmcnt(2)
v_add_f32 v4, v4, v44
v_add_f32 v4, v4, v45
v_mfma_f32_16x16x32_bf16 v[32:35], a[32:35], a[0:3], v[8:11]
ds_read_b128 a[48:51], v1 offset:10240
v_exp_f32 v16, v16
v_mfma_f32_16x16x32_bf16 v[40:43], a[32:35], a[16:19], v[12:15]
ds_read_b128 a[52:55], v1 offset:26624
v_cvt_pk_bf16_f32 v63, v46, v47
v_mfma_f32_16x16x32_bf16 v[64:67], a[36:39], v[56:59], v[64:67]
v_exp_f32 v17, v17
v_mfma_f32_16x16x32_bf16 v[96:99], a[36:39], v[60:63], v[96:99]
s_waitcnt lgkmcnt(2)
v_add_f32 v4, v4, v46
v_add_f32 v4, v4, v47
v_mfma_f32_16x16x32_bf16 v[32:35], a[40:43], a[4:7], v[32:35]
ds_read_b128 a[56:59], v1 offset:11264
v_exp_f32 v18, v18
v_mfma_f32_16x16x32_bf16 v[40:43], a[40:43], a[20:23], v[40:43]
ds_read_b128 a[60:63], v1 offset:27648
v_cvt_pk_bf16_f32 v48, v16, v17
v_mfma_f32_16x16x32_bf16 v[68:71], a[44:47], v[56:59], v[68:71]
v_exp_f32 v19, v19
v_mfma_f32_16x16x32_bf16 v[100:103], a[44:47], v[60:63], v[100:103]
s_waitcnt lgkmcnt(2)
v_add_f32 v3, v3, v16
v_add_f32 v3, v3, v17
v_mfma_f32_16x16x32_bf16 v[32:35], a[48:51], a[8:11], v[32:35]
ds_read_b128 a[32:35], v1 offset:12288
v_exp_f32 v20, v20
v_mfma_f32_16x16x32_bf16 v[40:43], a[48:51], a[24:27], v[40:43]
ds_read_b128 a[36:39], v1 offset:28672
v_cvt_pk_bf16_f32 v49, v18, v19
v_mfma_f32_16x16x32_bf16 v[72:75], a[52:55], v[56:59], v[72:75]
s_sub_u32 s29, s29, 1
v_exp_f32 v21, v21
v_mfma_f32_16x16x32_bf16 v[104:107], a[52:55], v[60:63], v[104:107]
s_waitcnt lgkmcnt(2)
v_add_f32 v3, v3, v18
v_add_f32 v3, v3, v19
v_mfma_f32_16x16x32_bf16 v[32:35], a[56:59], a[12:15], v[32:35]
ds_read_b128 a[40:43], v1 offset:13312
v_exp_f32 v22, v22
v_mfma_f32_16x16x32_bf16 v[40:43], a[56:59], a[28:31], v[40:43]
ds_read_b128 a[44:47], v1 offset:29696
v_cvt_pk_bf16_f32 v50, v20, v21
v_mfma_f32_16x16x32_bf16 v[76:79], a[60:63], v[56:59], v[76:79]
v_exp_f32 v23, v23
v_mfma_f32_16x16x32_bf16 v[108:111], a[60:63], v[60:63], v[108:111]
s_waitcnt lgkmcnt(2)
v_add_f32 v3, v3, v20
v_add_f32 v3, v3, v21
v_mfma_f32_16x16x32_bf16 v[36:39], a[32:35], a[0:3], v[8:11]
ds_read_b128 a[48:51], v1 offset:14336
v_exp_f32 v24, v24
v_mfma_f32_16x16x32_bf16 v[44:47], a[32:35], a[16:19], v[12:15]
ds_read_b128 a[52:55], v1 offset:30720
v_cvt_pk_bf16_f32 v51, v22, v23
v_mfma_f32_16x16x32_bf16 v[80:83], a[36:39], v[56:59], v[80:83]
s_add_u32 s41, s41, 32768
v_exp_f32 v25, v25
v_mfma_f32_16x16x32_bf16 v[112:115], a[36:39], v[60:63], v[112:115]
s_waitcnt lgkmcnt(2)
v_add_f32 v3, v3, v22
v_add_f32 v3, v3, v23
v_mfma_f32_16x16x32_bf16 v[36:39], a[40:43], a[4:7], v[36:39]
ds_read_b128 a[56:59], v1 offset:15360
v_exp_f32 v26, v26
v_mfma_f32_16x16x32_bf16 v[44:47], a[40:43], a[20:23], v[44:47]
ds_read_b128 a[60:63], v1 offset:31744
v_cvt_pk_bf16_f32 v52, v24, v25
v_mfma_f32_16x16x32_bf16 v[84:87], a[44:47], v[56:59], v[84:87]
s_cmp_eq_u32 s41, 0x28000
s_cselect_b32 s41, 0, s41
v_exp_f32 v27, v27
v_mfma_f32_16x16x32_bf16 v[116:119], a[44:47], v[60:63], v[116:119]
s_waitcnt lgkmcnt(2)
v_add_f32 v4, v4, v24
v_add_f32 v4, v4, v25
v_add_u32 v1, s41, v5
v_mfma_f32_16x16x32_bf16 v[36:39], a[48:51], a[8:11], v[36:39]
ds_read_b128 a[32:35], v1 offset:0
v_exp_f32 v28, v28
v_mfma_f32_16x16x32_bf16 v[44:47], a[48:51], a[24:27], v[44:47]
ds_read_b128 a[36:39], v1 offset:16384
v_cvt_pk_bf16_f32 v53, v26, v27
v_mfma_f32_16x16x32_bf16 v[88:91], a[52:55], v[56:59], v[88:91]
v_exp_f32 v29, v29
v_mfma_f32_16x16x32_bf16 v[120:123], a[52:55], v[60:63], v[120:123]
s_waitcnt lgkmcnt(2)
v_add_f32 v4, v4, v26
v_add_f32 v4, v4, v27
v_mfma_f32_16x16x32_bf16 v[36:39], a[56:59], a[12:15], v[36:39]
ds_read_b128 a[40:43], v1 offset:1024
v_exp_f32 v30, v30
v_mfma_f32_16x16x32_bf16 v[44:47], a[56:59], a[28:31], v[44:47]
ds_read_b128 a[44:47], v1 offset:17408
v_cvt_pk_bf16_f32 v54, v28, v29
v_mfma_f32_16x16x32_bf16 v[92:95], a[60:63], v[56:59], v[92:95]
v_exp_f32 v31, v31
v_mfma_f32_16x16x32_bf16 v[124:127], a[60:63], v[60:63], v[124:127]
s_waitcnt lgkmcnt(2)
v_add_f32 v4, v4, v28
v_add_f32 v4, v4, v29
s_cmp_lg_u32 s29, 0
s_cbranch_scc1 L_Aloop_1021
L_Adrain_1020:
s_add_u32 s28, s28, 2
s_waitcnt vmcnt(0)
s_barrier
s_add_u32 s38, s28, 3
s_lshl_b32 s35, s38, 14
s_sub_u32 s36, s35, 16384
s_sub_u32 s39, s38, s26
s_sub_u32 s39, s39, 1
s_bitcmp1_b32 s39, 0
s_cselect_b32 s40, s32, s33
s_and_b32 s39, s39, 2
s_lshl_b32 s39, s39, 13
s_add_u32 s40, s40, s39
s_cmp_le_u32 s38, s26
s_cselect_b32 s35, s35, s40
s_cselect_b32 s36, s36, s40
s_add_u32 s35, s35, s30
s_add_u32 s36, s36, s31
s_add_u32 s37, s53, s34
s_add_u32 s53, s53, 32768
s_cmp_eq_u32 s53, 0x28000
s_cselect_b32 s53, 0, s53
ds_read_b128 a[48:51], v1 offset:2048
v_exp_f32 v32, v32
ds_read_b128 a[52:55], v1 offset:18432
v_cvt_pk_bf16_f32 v55, v30, v31
v_mfma_f32_16x16x32_bf16 v[64:67], a[36:39], v[48:51], v[64:67]
s_mov_b32 m0, s37
s_nop 0
buffer_load_dwordx4 v5, s[4:7], s35 offen offset:0 sc1 lds
v_exp_f32 v33, v33
v_mfma_f32_16x16x32_bf16 v[96:99], a[36:39], v[52:55], v[96:99]
s_waitcnt lgkmcnt(2)
v_add_f32 v4, v4, v30
v_add_f32 v4, v4, v31
ds_read_b128 a[56:59], v1 offset:3072
v_exp_f32 v34, v34
ds_read_b128 a[60:63], v1 offset:19456
v_cvt_pk_bf16_f32 v56, v32, v33
v_mfma_f32_16x16x32_bf16 v[68:71], a[44:47], v[48:51], v[68:71]
buffer_load_dwordx4 v5, s[4:7], s35 offen offset:1024 sc1 lds
v_exp_f32 v35, v35
v_mfma_f32_16x16x32_bf16 v[100:103], a[44:47], v[52:55], v[100:103]
s_waitcnt lgkmcnt(2)
v_add_f32 v3, v3, v32
v_add_f32 v3, v3, v33
ds_read_b128 a[32:35], v1 offset:4096
v_exp_f32 v36, v36
ds_read_b128 a[36:39], v1 offset:20480
v_cvt_pk_bf16_f32 v57, v34, v35
v_mfma_f32_16x16x32_bf16 v[72:75], a[52:55], v[48:51], v[72:75]
buffer_load_dwordx4 v5, s[4:7], s35 offen offset:2048 sc1 lds
v_exp_f32 v37, v37
v_mfma_f32_16x16x32_bf16 v[104:107], a[52:55], v[52:55], v[104:107]
s_waitcnt lgkmcnt(2)
v_add_f32 v3, v3, v34
v_add_f32 v3, v3, v35
ds_read_b128 a[40:43], v1 offset:5120
v_exp_f32 v38, v38
ds_read_b128 a[44:47], v1 offset:21504
v_cvt_pk_bf16_f32 v58, v36, v37
v_mfma_f32_16x16x32_bf16 v[76:79], a[60:63], v[48:51], v[76:79]
buffer_load_dwordx4 v5, s[4:7], s35 offen offset:3072 sc1 lds
v_exp_f32 v39, v39
v_mfma_f32_16x16x32_bf16 v[108:111], a[60:63], v[52:55], v[108:111]
s_waitcnt lgkmcnt(2)
v_add_f32 v3, v3, v36
v_add_f32 v3, v3, v37
ds_read_b128 a[48:51], v1 offset:6144
v_exp_f32 v40, v40
ds_read_b128 a[52:55], v1 offset:22528
v_cvt_pk_bf16_f32 v59, v38, v39
v_mfma_f32_16x16x32_bf16 v[80:83], a[36:39], v[48:51], v[80:83]
s_add_u32 m0, s37, 16384
s_nop 0
buffer_load_dwordx4 v5, s[4:7], s36 offen offset:0 sc1 lds
v_exp_f32 v41, v41
v_mfma_f32_16x16x32_bf16 v[112:115], a[36:39], v[52:55], v[112:115]
s_waitcnt lgkmcnt(2)
v_add_f32 v3, v3, v38
v_add_f32 v3, v3, v39
ds_read_b128 a[56:59], v1 offset:7168
v_exp_f32 v42, v42
ds_read_b128 a[60:63], v1 offset:23552
v_cvt_pk_bf16_f32 v60, v40, v41
v_mfma_f32_16x16x32_bf16 v[84:87], a[44:47], v[48:51], v[84:87]
buffer_load_dwordx4 v5, s[4:7], s36 offen offset:1024 sc1 lds
v_exp_f32 v43, v43
v_mfma_f32_16x16x32_bf16 v[116:119], a[44:47], v[52:55], v[116:119]
s_waitcnt lgkmcnt(2)
v_add_f32 v4, v4, v40
v_add_f32 v4, v4, v41
ds_read_b128 a[32:35], v1 offset:8192
v_exp_f32 v44, v44
ds_read_b128 a[36:39], v1 offset:24576
v_cvt_pk_bf16_f32 v61, v42, v43
v_mfma_f32_16x16x32_bf16 v[88:91], a[52:55], v[48:51], v[88:91]
buffer_load_dwordx4 v5, s[4:7], s36 offen offset:2048 sc1 lds
v_exp_f32 v45, v45
v_mfma_f32_16x16x32_bf16 v[120:123], a[52:55], v[52:55], v[120:123]
s_waitcnt lgkmcnt(2)
v_add_f32 v4, v4, v42
v_add_f32 v4, v4, v43
ds_read_b128 a[40:43], v1 offset:9216
v_exp_f32 v46, v46
ds_read_b128 a[44:47], v1 offset:25600
v_cvt_pk_bf16_f32 v62, v44, v45
v_mfma_f32_16x16x32_bf16 v[92:95], a[60:63], v[48:51], v[92:95]
buffer_load_dwordx4 v5, s[4:7], s36 offen offset:3072 sc1 lds
v_exp_f32 v47, v47
v_mfma_f32_16x16x32_bf16 v[124:127], a[60:63], v[52:55], v[124:127]
s_waitcnt lgkmcnt(2)
v_add_f32 v4, v4, v44
v_add_f32 v4, v4, v45
s_add_u32 s38, s28, 4
s_lshl_b32 s35, s38, 14
s_sub_u32 s36, s35, 16384
s_sub_u32 s39, s38, s26
s_sub_u32 s39, s39, 1
s_bitcmp1_b32 s39, 0
s_cselect_b32 s40, s32, s33
s_and_b32 s39, s39, 2
s_lshl_b32 s39, s39, 13
s_add_u32 s40, s40, s39
s_cmp_le_u32 s38, s26
s_cselect_b32 s35, s35, s40
s_cselect_b32 s36, s36, s40
s_add_u32 s35, s35, s30
s_add_u32 s36, s36, s31
s_add_u32 s37, s53, s34
s_add_u32 s53, s53, 32768
s_cmp_eq_u32 s53, 0x28000
s_cselect_b32 s53, 0, s53
ds_read_b128 a[48:51], v1 offset:10240
ds_read_b128 a[52:55], v1 offset:26624
v_cvt_pk_bf16_f32 v63, v46, v47
v_mfma_f32_16x16x32_bf16 v[64:67], a[36:39], v[56:59], v[64:67]
s_mov_b32 m0, s37
s_nop 0
buffer_load_dwordx4 v5, s[4:7], s35 offen offset:0 sc1 lds
v_mfma_f32_16x16x32_bf16 v[96:99], a[36:39], v[60:63], v[96:99]
s_waitcnt lgkmcnt(2)
v_add_f32 v4, v4, v46
v_add_f32 v4, v4, v47
ds_read_b128 a[56:59], v1 offset:11264
ds_read_b128 a[60:63], v1 offset:27648
v_mfma_f32_16x16x32_bf16 v[68:71], a[44:47], v[56:59], v[68:71]
buffer_load_dwordx4 v5, s[4:7], s35 offen offset:1024 sc1 lds
v_mfma_f32_16x16x32_bf16 v[100:103], a[44:47], v[60:63], v[100:103]
s_waitcnt lgkmcnt(2)
ds_read_b128 a[32:35], v1 offset:12288
ds_read_b128 a[36:39], v1 offset:28672
v_mfma_f32_16x16x32_bf16 v[72:75], a[52:55], v[56:59], v[72:75]
buffer_load_dwordx4 v5, s[4:7], s35 offen offset:2048 sc1 lds
v_mfma_f32_16x16x32_bf16 v[104:107], a[52:55], v[60:63], v[104:107]
s_waitcnt lgkmcnt(2)
ds_read_b128 a[40:43], v1 offset:13312
ds_read_b128 a[44:47], v1 offset:29696
v_mfma_f32_16x16x32_bf16 v[76:79], a[60:63], v[56:59], v[76:79]
buffer_load_dwordx4 v5, s[4:7], s35 offen offset:3072 sc1 lds
v_mfma_f32_16x16x32_bf16 v[108:111], a[60:63], v[60:63], v[108:111]
s_waitcnt lgkmcnt(2)
ds_read_b128 a[48:51], v1 offset:14336
ds_read_b128 a[52:55], v1 offset:30720
v_mfma_f32_16x16x32_bf16 v[80:83], a[36:39], v[56:59], v[80:83]
s_add_u32 m0, s37, 16384
s_nop 0
buffer_load_dwordx4 v5, s[4:7], s36 offen offset:0 sc1 lds
v_mfma_f32_16x16x32_bf16 v[112:115], a[36:39], v[60:63], v[112:115]
s_waitcnt lgkmcnt(2)
ds_read_b128 a[56:59], v1 offset:15360
ds_read_b128 a[60:63], v1 offset:31744
v_mfma_f32_16x16x32_bf16 v[84:87], a[44:47], v[56:59], v[84:87]
buffer_load_dwordx4 v5, s[4:7], s36 offen offset:1024 sc1 lds
v_mfma_f32_16x16x32_bf16 v[116:119], a[44:47], v[60:63], v[116:119]
s_waitcnt lgkmcnt(2)
v_mfma_f32_16x16x32_bf16 v[88:91], a[52:55], v[56:59], v[88:91]
buffer_load_dwordx4 v5, s[4:7], s36 offen offset:2048 sc1 lds
v_mfma_f32_16x16x32_bf16 v[120:123], a[52:55], v[60:63], v[120:123]
s_waitcnt lgkmcnt(0)
v_mfma_f32_16x16x32_bf16 v[92:95], a[60:63], v[56:59], v[92:95]
buffer_load_dwordx4 v5, s[4:7], s36 offen offset:3072 sc1 lds
v_mfma_f32_16x16x32_bf16 v[124:127], a[60:63], v[60:63], v[124:127]
s_waitcnt lgkmcnt(0)
s_branch L_Aidlechk_1018
L_Azero_1022:
v_mov_b32 v64, 0
v_mov_b32 v65, 0
v_mov_b32 v66, 0
v_mov_b32 v67, 0
v_mov_b32 v68, 0
v_mov_b32 v69, 0
v_mov_b32 v70, 0
v_mov_b32 v71, 0
v_mov_b32 v72, 0
v_mov_b32 v73, 0
v_mov_b32 v74, 0
v_mov_b32 v75, 0
v_mov_b32 v76, 0
v_mov_b32 v77, 0
v_mov_b32 v78, 0
v_mov_b32 v79, 0
v_mov_b32 v80, 0
v_mov_b32 v81, 0
v_mov_b32 v82, 0
v_mov_b32 v83, 0
v_mov_b32 v84, 0
v_mov_b32 v85, 0
v_mov_b32 v86, 0
v_mov_b32 v87, 0
v_mov_b32 v88, 0
v_mov_b32 v89, 0
v_mov_b32 v90, 0
v_mov_b32 v91, 0
v_mov_b32 v92, 0
v_mov_b32 v93, 0
v_mov_b32 v94, 0
v_mov_b32 v95, 0
v_mov_b32 v96, 0
v_mov_b32 v97, 0
v_mov_b32 v98, 0
v_mov_b32 v99, 0
v_mov_b32 v100, 0
v_mov_b32 v101, 0
v_mov_b32 v102, 0
v_mov_b32 v103, 0
v_mov_b32 v104, 0
v_mov_b32 v105, 0
v_mov_b32 v106, 0
v_mov_b32 v107, 0
v_mov_b32 v108, 0
v_mov_b32 v109, 0
v_mov_b32 v110, 0
v_mov_b32 v111, 0
v_mov_b32 v112, 0
v_mov_b32 v113, 0
v_mov_b32 v114, 0
v_mov_b32 v115, 0
v_mov_b32 v116, 0
v_mov_b32 v117, 0
v_mov_b32 v118, 0
v_mov_b32 v119, 0
v_mov_b32 v120, 0
v_mov_b32 v121, 0
v_mov_b32 v122, 0
v_mov_b32 v123, 0
v_mov_b32 v124, 0
v_mov_b32 v125, 0
v_mov_b32 v126, 0
v_mov_b32 v127, 0
s_add_u32 s38, s28, 3
s_lshl_b32 s35, s38, 14
s_sub_u32 s36, s35, 16384
s_sub_u32 s39, s38, s26
s_sub_u32 s39, s39, 1
s_bitcmp1_b32 s39, 0
s_cselect_b32 s40, s32, s33
s_and_b32 s39, s39, 2
s_lshl_b32 s39, s39, 13
s_add_u32 s40, s40, s39
s_cmp_le_u32 s38, s26
s_cselect_b32 s35, s35, s40
s_cselect_b32 s36, s36, s40
s_add_u32 s35, s35, s30
s_add_u32 s36, s36, s31
s_add_u32 s37, s53, s34
s_add_u32 s53, s53, 32768
s_cmp_eq_u32 s53, 0x28000
s_cselect_b32 s53, 0, s53
ds_read_b128 a[32:35], v1 offset:0
ds_read_b128 a[36:39], v1 offset:16384
ds_read_b128 a[40:43], v1 offset:1024
ds_read_b128 a[44:47], v1 offset:17408
s_waitcnt lgkmcnt(2)
v_mfma_f32_16x16x32_bf16 v[16:19], a[32:35], a[0:3], 0
ds_read_b128 a[48:51], v1 offset:2048
v_mfma_f32_16x16x32_bf16 v[24:27], a[32:35], a[16:19], 0
ds_read_b128 a[52:55], v1 offset:18432
s_mov_b32 m0, s37
s_nop 0
buffer_load_dwordx4 v5, s[4:7], s35 offen offset:0 sc1 lds
s_waitcnt lgkmcnt(2)
v_mfma_f32_16x16x32_bf16 v[16:19], a[40:43], a[4:7], v[16:19]
ds_read_b128 a[56:59], v1 offset:3072
v_mfma_f32_16x16x32_bf16 v[24:27], a[40:43], a[20:23], v[24:27]
ds_read_b128 a[60:63], v1 offset:19456
buffer_load_dwordx4 v5, s[4:7], s35 offen offset:1024 sc1 lds
s_waitcnt lgkmcnt(2)
v_mfma_f32_16x16x32_bf16 v[16:19], a[48:51], a[8:11], v[16:19]
ds_read_b128 a[32:35], v1 offset:4096
v_mfma_f32_16x16x32_bf16 v[24:27], a[48:51], a[24:27], v[24:27]
ds_read_b128 a[36:39], v1 offset:20480
buffer_load_dwordx4 v5, s[4:7], s35 offen offset:2048 sc1 lds
s_waitcnt lgkmcnt(2)
v_mfma_f32_16x16x32_bf16 v[16:19], a[56:59], a[12:15], v[16:19]
ds_read_b128 a[40:43], v1 offset:5120
v_mfma_f32_16x16x32_bf16 v[24:27], a[56:59], a[28:31], v[24:27]
ds_read_b128 a[44:47], v1 offset:21504
buffer_load_dwordx4 v5, s[4:7], s35 offen offset:3072 sc1 lds
s_waitcnt lgkmcnt(2)
v_mfma_f32_16x16x32_bf16 v[20:23], a[32:35], a[0:3], 0
ds_read_b128 a[48:51], v1 offset:6144
v_mfma_f32_16x16x32_bf16 v[28:31], a[32:35], a[16:19], 0
ds_read_b128 a[52:55], v1 offset:22528
s_add_u32 m0, s37, 16384
s_nop 0
buffer_load_dwordx4 v5, s[4:7], s36 offen offset:0 sc1 lds
s_waitcnt lgkmcnt(2)
v_mfma_f32_16x16x32_bf16 v[20:23], a[40:43], a[4:7], v[20:23]
ds_read_b128 a[56:59], v1 offset:7168
v_mfma_f32_16x16x32_bf16 v[28:31], a[40:43], a[20:23], v[28:31]
ds_read_b128 a[60:63], v1 offset:23552
buffer_load_dwordx4 v5, s[4:7], s36 offen offset:1024 sc1 lds
s_waitcnt lgkmcnt(2)
v_mfma_f32_16x16x32_bf16 v[20:23], a[48:51], a[8:11], v[20:23]
ds_read_b128 a[32:35], v1 offset:8192
v_mfma_f32_16x16x32_bf16 v[28:31], a[48:51], a[24:27], v[28:31]
ds_read_b128 a[36:39], v1 offset:24576
buffer_load_dwordx4 v5, s[4:7], s36 offen offset:2048 sc1 lds
s_waitcnt lgkmcnt(2)
v_mfma_f32_16x16x32_bf16 v[20:23], a[56:59], a[12:15], v[20:23]
ds_read_b128 a[40:43], v1 offset:9216
v_mfma_f32_16x16x32_bf16 v[28:31], a[56:59], a[28:31], v[28:31]
ds_read_b128 a[44:47], v1 offset:25600
buffer_load_dwordx4 v5, s[4:7], s36 offen offset:3072 sc1 lds
s_waitcnt lgkmcnt(2)
s_nop 7
s_cmp_lg_u32 s42, 0
s_cbranch_scc1 L_nomax_1024
v_max3_f32 v6, v16, v17, v18
v_max3_f32 v6, v6, v19, v20
v_max3_f32 v6, v6, v21, v22
v_max_f32 v6, v6, v23
v_mov_b32 v7, v6
s_nop 1
v_permlane16_swap_b32 v6, v7
v_max_f32 v6, v6, v7
v_mov_b32 v7, v6
s_nop 1
v_permlane32_swap_b32 v6, v7
v_max_f32 v6, v6, v7
v_sub_f32 v8, 0, v6
v_sub_f32 v9, 0, v6
v_sub_f32 v10, 0, v6
v_sub_f32 v11, 0, v6
v_max3_f32 v6, v24, v25, v26
v_max3_f32 v6, v6, v27, v28
v_max3_f32 v6, v6, v29, v30
v_max_f32 v6, v6, v31
v_mov_b32 v7, v6
s_nop 1
v_permlane16_swap_b32 v6, v7
v_max_f32 v6, v6, v7
v_mov_b32 v7, v6
s_nop 1
v_permlane32_swap_b32 v6, v7
v_max_f32 v6, v6, v7
v_sub_f32 v12, 0, v6
v_sub_f32 v13, 0, v6
v_sub_f32 v14, 0, v6
v_sub_f32 v15, 0, v6
L_nomax_1024:
v_add_f32 v16, v16, v8
v_add_f32 v17, v17, v8
v_add_f32 v18, v18, v8
v_add_f32 v19, v19, v8
v_add_f32 v20, v20, v8
v_add_f32 v21, v21, v8
v_add_f32 v22, v22, v8
v_add_f32 v23, v23, v8
v_add_f32 v24, v24, v12
v_add_f32 v25, v25, v12
v_add_f32 v26, v26, v12
v_add_f32 v27, v27, v12
v_add_f32 v28, v28, v12
v_add_f32 v29, v29, v12
v_add_f32 v30, v30, v12
v_add_f32 v31, v31, v12
s_nop 1
s_add_u32 s38, s28, 4
s_lshl_b32 s35, s38, 14
s_sub_u32 s36, s35, 16384
s_sub_u32 s39, s38, s26
s_sub_u32 s39, s39, 1
s_bitcmp1_b32 s39, 0
s_cselect_b32 s40, s32, s33
s_and_b32 s39, s39, 2
s_lshl_b32 s39, s39, 13
s_add_u32 s40, s40, s39
s_cmp_le_u32 s38, s26
s_cselect_b32 s35, s35, s40
s_cselect_b32 s36, s36, s40
s_add_u32 s35, s35, s30
s_add_u32 s36, s36, s31
s_add_u32 s37, s53, s34
s_add_u32 s53, s53, 32768
s_cmp_eq_u32 s53, 0x28000
s_cselect_b32 s53, 0, s53
s_mov_b32 m0, s37
s_nop 0
buffer_load_dwordx4 v5, s[4:7], s35 offen offset:0 sc1 lds
buffer_load_dwordx4 v5, s[4:7], s35 offen offset:1024 sc1 lds
buffer_load_dwordx4 v5, s[4:7], s35 offen offset:2048 sc1 lds
buffer_load_dwordx4 v5, s[4:7], s35 offen offset:3072 sc1 lds
s_add_u32 m0, s37, 16384
s_nop 0
buffer_load_dwordx4 v5, s[4:7], s36 offen offset:0 sc1 lds
buffer_load_dwordx4 v5, s[4:7], s36 offen offset:1024 sc1 lds
buffer_load_dwordx4 v5, s[4:7], s36 offen offset:2048 sc1 lds
buffer_load_dwordx4 v5, s[4:7], s36 offen offset:3072 sc1 lds
L_Aidlechk_1018:
s_waitcnt lgkmcnt(0)
s_cmp_ge_u32 s28, s26
s_cbranch_scc1 L_d5_1025
L_Aidle_1019:
s_add_u32 s28, s28, 2
s_waitcnt vmcnt(0)
s_barrier
s_add_u32 s38, s28, 3
s_lshl_b32 s35, s38, 14
s_sub_u32 s36, s35, 16384
s_sub_u32 s39, s38, s26
s_sub_u32 s39, s39, 1
s_bitcmp1_b32 s39, 0
s_cselect_b32 s40, s32, s33
s_and_b32 s39, s39, 2
s_lshl_b32 s39, s39, 13
s_add_u32 s40, s40, s39
s_cmp_le_u32 s38, s26
s_cselect_b32 s35, s35, s40
s_cselect_b32 s36, s36, s40
s_add_u32 s35, s35, s30
s_add_u32 s36, s36, s31
s_add_u32 s37, s53, s34
s_add_u32 s53, s53, 32768
s_cmp_eq_u32 s53, 0x28000
s_cselect_b32 s53, 0, s53
s_mov_b32 m0, s37
s_nop 0
buffer_load_dwordx4 v5, s[4:7], s35 offen offset:0 sc1 lds
buffer_load_dwordx4 v5, s[4:7], s35 offen offset:1024 sc1 lds
buffer_load_dwordx4 v5, s[4:7], s35 offen offset:2048 sc1 lds
buffer_load_dwordx4 v5, s[4:7], s35 offen offset:3072 sc1 lds
s_add_u32 m0, s37, 16384
s_nop 0
buffer_load_dwordx4 v5, s[4:7], s36 offen offset:0 sc1 lds
buffer_load_dwordx4 v5, s[4:7], s36 offen offset:1024 sc1 lds
buffer_load_dwordx4 v5, s[4:7], s36 offen offset:2048 sc1 lds
buffer_load_dwordx4 v5, s[4:7], s36 offen offset:3072 sc1 lds
s_add_u32 s38, s28, 4
s_lshl_b32 s35, s38, 14
s_sub_u32 s36, s35, 16384
s_sub_u32 s39, s38, s26
s_sub_u32 s39, s39, 1
s_bitcmp1_b32 s39, 0
s_cselect_b32 s40, s32, s33
s_and_b32 s39, s39, 2
s_lshl_b32 s39, s39, 13
s_add_u32 s40, s40, s39
s_cmp_le_u32 s38, s26
s_cselect_b32 s35, s35, s40
s_cselect_b32 s36, s36, s40
s_add_u32 s35, s35, s30
s_add_u32 s36, s36, s31
s_add_u32 s37, s53, s34
s_add_u32 s53, s53, 32768
s_cmp_eq_u32 s53, 0x28000
s_cselect_b32 s53, 0, s53
s_mov_b32 m0, s37
s_nop 0
buffer_load_dwordx4 v5, s[4:7], s35 offen offset:0 sc1 lds
buffer_load_dwordx4 v5, s[4:7], s35 offen offset:1024 sc1 lds
buffer_load_dwordx4 v5, s[4:7], s35 offen offset:2048 sc1 lds
buffer_load_dwordx4 v5, s[4:7], s35 offen offset:3072 sc1 lds
s_add_u32 m0, s37, 16384
s_nop 0
buffer_load_dwordx4 v5, s[4:7], s36 offen offset:0 sc1 lds
buffer_load_dwordx4 v5, s[4:7], s36 offen offset:1024 sc1 lds
buffer_load_dwordx4 v5, s[4:7], s36 offen offset:2048 sc1 lds
buffer_load_dwordx4 v5, s[4:7], s36 offen offset:3072 sc1 lds
s_cmp_lt_u32 s28, s26
s_cbranch_scc1 L_Aidle_1019
L_d5_1025:
L_diag_1014:
s_barrier
s_add_u32 s38, s26, s23
s_add_u32 s38, s38, 1
s_mul_i32 s39, s38, 0xcccd
s_lshr_b32 s39, s39, 18
s_mul_i32 s39, s39, 5
s_sub_u32 s39, s38, s39
s_lshl_b32 s39, s39, 15
s_add_u32 s38, s38, 2
s_mul_i32 s40, s38, 0xcccd
s_lshr_b32 s40, s40, 18
s_mul_i32 s40, s40, 5
s_sub_u32 s40, s38, s40
s_lshl_b32 s40, s40, 15
v_add_u32 v1, s39, v5
v_add_u32 v2, s40, v5
s_mul_i32 s52, s26, 0xcccd
s_lshr_b32 s52, s52, 18
s_mul_i32 s52, s52, 5
s_sub_u32 s52, s26, s52
s_lshl_b32 s52, s52, 15
v_mov_b32 v6, s52
v_mov_b32 v7, 0
ds_write_b32 v6, v7
s_waitcnt lgkmcnt(0)
s_cmp_eq_u32 s24, 0
s_cbranch_scc1 L_m0_1026
ds_read_b128 a[32:35], v1 offset:0
ds_read_b128 a[36:39], v1 offset:1024
ds_read_b128 a[40:43], v1 offset:2048
ds_read_b128 a[44:47], v1 offset:3072
ds_read_b128 a[48:51], v1 offset:4096
ds_read_b128 a[52:55], v1 offset:5120
ds_read_b128 a[56:59], v1 offset:6144
ds_read_b128 a[60:63], v1 offset:7168
ds_read_b128 a[64:67], v1 offset:16384
ds_read_b128 a[68:71], v1 offset:17408
ds_read_b128 a[72:75], v1 offset:18432
ds_read_b128 a[76:79], v1 offset:19456
ds_read_b128 a[80:83], v1 offset:20480
ds_read_b128 a[84:87], v1 offset:21504
ds_read_b128 a[88:91], v1 offset:22528
s_waitcnt lgkmcnt(7)
v_mfma_f32_16x16x32_bf16 v[16:19], a[32:35], a[0:3], v[8:11]
v_mfma_f32_16x16x32_bf16 v[24:27], a[32:35], a[16:19], v[12:15]
v_mfma_f32_16x16x32_bf16 v[16:19], a[36:39], a[4:7], v[16:19]
v_mfma_f32_16x16x32_bf16 v[24:27], a[36:39], a[20:23], v[24:27]
v_mfma_f32_16x16x32_bf16 v[16:19], a[40:43], a[8:11], v[16:19]
v_mfma_f32_16x16x32_bf16 v[24:27], a[40:43], a[24:27], v[24:27]
v_mfma_f32_16x16x32_bf16 v[16:19], a[44:47], a[12:15], v[16:19]
v_mfma_f32_16x16x32_bf16 v[24:27], a[44:47], a[28:31], v[24:27]
v_mfma_f32_16x16x32_bf16 v[20:23], a[48:51], a[0:3], v[8:11]
v_mfma_f32_16x16x32_bf16 v[28:31], a[48:51], a[16:19], v[12:15]
v_mfma_f32_16x16x32_bf16 v[20:23], a[52:55], a[4:7], v[20:23]
v_mfma_f32_16x16x32_bf16 v[28:31], a[52:55], a[20:23], v[28:31]
v_mfma_f32_16x16x32_bf16 v[20:23], a[56:59], a[8:11], v[20:23]
v_mfma_f32_16x16x32_bf16 v[28:31], a[56:59], a[24:27], v[28:31]
v_mfma_f32_16x16x32_bf16 v[20:23], a[60:63], a[12:15], v[20:23]
v_mfma_f32_16x16x32_bf16 v[28:31], a[60:63], a[28:31], v[28:31]
ds_read_b128 a[92:95], v1 offset:23552
s_nop 7
v_exp_f32 v16, v16
v_exp_f32 v17, v17
v_exp_f32 v18, v18
v_exp_f32 v19, v19
v_exp_f32 v20, v20
v_exp_f32 v21, v21
v_exp_f32 v22, v22
v_exp_f32 v23, v23
v_exp_f32 v24, v24
v_exp_f32 v25, v25
v_exp_f32 v26, v26
v_exp_f32 v27, v27
v_exp_f32 v28, v28
v_exp_f32 v29, v29
v_exp_f32 v30, v30
v_exp_f32 v31, v31
s_nop 0
v_add_f32 v3, v3, v16
v_add_f32 v3, v3, v17
v_add_f32 v3, v3, v18
v_add_f32 v3, v3, v19
v_add_f32 v3, v3, v20
v_add_f32 v3, v3, v21
v_add_f32 v3, v3, v22
v_add_f32 v3, v3, v23
v_add_f32 v4, v4, v24
v_add_f32 v4, v4, v25
v_add_f32 v4, v4, v26
v_add_f32 v4, v4, v27
v_add_f32 v4, v4, v28
v_add_f32 v4, v4, v29
v_add_f32 v4, v4, v30
v_add_f32 v4, v4, v31
v_cvt_pk_bf16_f32 v48, v16, v17
v_cvt_pk_bf16_f32 v49, v18, v19
v_cvt_pk_bf16_f32 v50, v20, v21
v_cvt_pk_bf16_f32 v51, v22, v23
v_cvt_pk_bf16_f32 v52, v24, v25
v_cvt_pk_bf16_f32 v53, v26, v27
v_cvt_pk_bf16_f32 v54, v28, v29
v_cvt_pk_bf16_f32 v55, v30, v31
s_waitcnt lgkmcnt(0)
s_nop 0
v_mfma_f32_16x16x32_bf16 v[64:67], a[64:67], v[48:51], v[64:67]
v_mfma_f32_16x16x32_bf16 v[96:99], a[64:67], v[52:55], v[96:99]
v_mfma_f32_16x16x32_bf16 v[68:71], a[68:71], v[48:51], v[68:71]
v_mfma_f32_16x16x32_bf16 v[100:103], a[68:71], v[52:55], v[100:103]
v_mfma_f32_16x16x32_bf16 v[72:75], a[72:75], v[48:51], v[72:75]
v_mfma_f32_16x16x32_bf16 v[104:107], a[72:75], v[52:55], v[104:107]
v_mfma_f32_16x16x32_bf16 v[76:79], a[76:79], v[48:51], v[76:79]
v_mfma_f32_16x16x32_bf16 v[108:111], a[76:79], v[52:55], v[108:111]
v_mfma_f32_16x16x32_bf16 v[80:83], a[80:83], v[48:51], v[80:83]
v_mfma_f32_16x16x32_bf16 v[112:115], a[80:83], v[52:55], v[112:115]
v_mfma_f32_16x16x32_bf16 v[84:87], a[84:87], v[48:51], v[84:87]
v_mfma_f32_16x16x32_bf16 v[116:119], a[84:87], v[52:55], v[116:119]
v_mfma_f32_16x16x32_bf16 v[88:91], a[88:91], v[48:51], v[88:91]
v_mfma_f32_16x16x32_bf16 v[120:123], a[88:91], v[52:55], v[120:123]
v_mfma_f32_16x16x32_bf16 v[92:95], a[92:95], v[48:51], v[92:95]
v_mfma_f32_16x16x32_bf16 v[124:127], a[92:95], v[52:55], v[124:127]
s_branch L_b1_1027
L_m0_1026:
ds_read_b128 a[32:35], v1 offset:0
ds_read_b128 a[36:39], v1 offset:1024
ds_read_b128 a[40:43], v1 offset:2048
ds_read_b128 a[44:47], v1 offset:3072
ds_read_b128 a[48:51], v1 offset:4096
ds_read_b128 a[52:55], v1 offset:5120
ds_read_b128 a[56:59], v1 offset:6144
ds_read_b128 a[60:63], v1 offset:7168
ds_read_b128 a[64:67], v1 offset:16384
ds_read_b128 a[68:71], v1 offset:17408
ds_read_b128 a[72:75], v1 offset:18432
ds_read_b128 a[76:79], v1 offset:19456
ds_read_b128 a[80:83], v1 offset:20480
ds_read_b128 a[84:87], v1 offset:21504
ds_read_b128 a[88:91], v1 offset:22528
s_waitcnt lgkmcnt(7)
v_mfma_f32_16x16x32_bf16 v[16:19], a[32:35], a[0:3], v[8:11]
v_mfma_f32_16x16x32_bf16 v[24:27], a[32:35], a[16:19], v[12:15]
v_mfma_f32_16x16x32_bf16 v[16:19], a[36:39], a[4:7], v[16:19]
v_mfma_f32_16x16x32_bf16 v[24:27], a[36:39], a[20:23], v[24:27]
v_mfma_f32_16x16x32_bf16 v[16:19], a[40:43], a[8:11], v[16:19]
v_mfma_f32_16x16x32_bf16 v[24:27], a[40:43], a[24:27], v[24:27]
v_mfma_f32_16x16x32_bf16 v[16:19], a[44:47], a[12:15], v[16:19]
v_mfma_f32_16x16x32_bf16 v[24:27], a[44:47], a[28:31], v[24:27]
v_mfma_f32_16x16x32_bf16 v[28:31], a[48:51], a[16:19], v[12:15]
v_mfma_f32_16x16x32_bf16 v[28:31], a[52:55], a[20:23], v[28:31]
v_mfma_f32_16x16x32_bf16 v[28:31], a[56:59], a[24:27], v[28:31]
v_mfma_f32_16x16x32_bf16 v[28:31], a[60:63], a[28:31], v[28:31]
ds_read_b128 a[92:95], v1 offset:23552
s_nop 7
v_exp_f32 v16, v16
v_exp_f32 v17, v17
v_exp_f32 v18, v18
v_exp_f32 v19, v19
v_exp_f32 v24, v24
v_exp_f32 v25, v25
v_exp_f32 v26, v26
v_exp_f32 v27, v27
v_exp_f32 v28, v28
v_exp_f32 v29, v29
v_exp_f32 v30, v30
v_exp_f32 v31, v31
s_nop 0
v_cndmask_b32 v16, 0, v16, s[44:45]
v_add_f32 v3, v3, v16
v_cndmask_b32 v17, 0, v17, s[46:47]
v_add_f32 v3, v3, v17
v_cndmask_b32 v18, 0, v18, s[48:49]
v_add_f32 v3, v3, v18
v_cndmask_b32 v19, 0, v19, s[50:51]
v_add_f32 v3, v3, v19
v_add_f32 v4, v4, v24
v_add_f32 v4, v4, v25
v_add_f32 v4, v4, v26
v_add_f32 v4, v4, v27
v_cndmask_b32 v28, 0, v28, s[44:45]
v_add_f32 v4, v4, v28
v_cndmask_b32 v29, 0, v29, s[46:47]
v_add_f32 v4, v4, v29
v_cndmask_b32 v30, 0, v30, s[48:49]
v_add_f32 v4, v4, v30
v_cndmask_b32 v31, 0, v31, s[50:51]
v_add_f32 v4, v4, v31
v_cvt_pk_bf16_f32 v48, v16, v17
v_cvt_pk_bf16_f32 v49, v18, v19
v_mov_b32 v50, 0
v_mov_b32 v51, 0
v_cvt_pk_bf16_f32 v52, v24, v25
v_cvt_pk_bf16_f32 v53, v26, v27
v_cvt_pk_bf16_f32 v54, v28, v29
v_cvt_pk_bf16_f32 v55, v30, v31
s_waitcnt lgkmcnt(0)
s_nop 0
v_mfma_f32_16x16x32_bf16 v[64:67], a[64:67], v[48:51], v[64:67]
v_mfma_f32_16x16x32_bf16 v[96:99], a[64:67], v[52:55], v[96:99]
v_mfma_f32_16x16x32_bf16 v[68:71], a[68:71], v[48:51], v[68:71]
v_mfma_f32_16x16x32_bf16 v[100:103], a[68:71], v[52:55], v[100:103]
v_mfma_f32_16x16x32_bf16 v[72:75], a[72:75], v[48:51], v[72:75]
v_mfma_f32_16x16x32_bf16 v[104:107], a[72:75], v[52:55], v[104:107]
v_mfma_f32_16x16x32_bf16 v[76:79], a[76:79], v[48:51], v[76:79]
v_mfma_f32_16x16x32_bf16 v[108:111], a[76:79], v[52:55], v[108:111]
v_mfma_f32_16x16x32_bf16 v[80:83], a[80:83], v[48:51], v[80:83]
v_mfma_f32_16x16x32_bf16 v[112:115], a[80:83], v[52:55], v[112:115]
v_mfma_f32_16x16x32_bf16 v[84:87], a[84:87], v[48:51], v[84:87]
v_mfma_f32_16x16x32_bf16 v[116:119], a[84:87], v[52:55], v[116:119]
v_mfma_f32_16x16x32_bf16 v[88:91], a[88:91], v[48:51], v[88:91]
v_mfma_f32_16x16x32_bf16 v[120:123], a[88:91], v[52:55], v[120:123]
v_mfma_f32_16x16x32_bf16 v[92:95], a[92:95], v[48:51], v[92:95]
v_mfma_f32_16x16x32_bf16 v[124:127], a[92:95], v[52:55], v[124:127]
L_b1_1027:
s_waitcnt vmcnt(0)
s_barrier
s_cmp_eq_u32 s24, 0
s_cbranch_scc1 L_fin_1028
s_mov_b32 s29, 1
v_add_u32 v1, 8192, v1
L_dl_1029:
s_cmp_eq_u32 s29, s24
s_cbranch_scc1 L_dlast_1030
ds_read_b128 a[32:35], v1 offset:0
ds_read_b128 a[36:39], v1 offset:1024
ds_read_b128 a[40:43], v1 offset:2048
ds_read_b128 a[44:47], v1 offset:3072
ds_read_b128 a[48:51], v1 offset:4096
ds_read_b128 a[52:55], v1 offset:5120
ds_read_b128 a[56:59], v1 offset:6144
ds_read_b128 a[60:63], v1 offset:7168
ds_read_b128 a[64:67], v1 offset:16384
ds_read_b128 a[68:71], v1 offset:17408
ds_read_b128 a[72:75], v1 offset:18432
ds_read_b128 a[76:79], v1 offset:19456
ds_read_b128 a[80:83], v1 offset:20480
ds_read_b128 a[84:87], v1 offset:21504
ds_read_b128 a[88:91], v1 offset:22528
s_waitcnt lgkmcnt(7)
v_mfma_f32_16x16x32_bf16 v[16:19], a[32:35], a[0:3], v[8:11]
v_mfma_f32_16x16x32_bf16 v[24:27], a[32:35], a[16:19], v[12:15]
v_mfma_f32_16x16x32_bf16 v[16:19], a[36:39], a[4:7], v[16:19]
v_mfma_f32_16x16x32_bf16 v[24:27], a[36:39], a[20:23], v[24:27]
v_mfma_f32_16x16x32_bf16 v[16:19], a[40:43], a[8:11], v[16:19]
v_mfma_f32_16x16x32_bf16 v[24:27], a[40:43], a[24:27], v[24:27]
v_mfma_f32_16x16x32_bf16 v[16:19], a[44:47], a[12:15], v[16:19]
v_mfma_f32_16x16x32_bf16 v[24:27], a[44:47], a[28:31], v[24:27]
v_mfma_f32_16x16x32_bf16 v[20:23], a[48:51], a[0:3], v[8:11]
v_mfma_f32_16x16x32_bf16 v[28:31], a[48:51], a[16:19], v[12:15]
v_mfma_f32_16x16x32_bf16 v[20:23], a[52:55], a[4:7], v[20:23]
v_mfma_f32_16x16x32_bf16 v[28:31], a[52:55], a[20:23], v[28:31]
v_mfma_f32_16x16x32_bf16 v[20:23], a[56:59], a[8:11], v[20:23]
v_mfma_f32_16x16x32_bf16 v[28:31], a[56:59], a[24:27], v[28:31]
v_mfma_f32_16x16x32_bf16 v[20:23], a[60:63], a[12:15], v[20:23]
v_mfma_f32_16x16x32_bf16 v[28:31], a[60:63], a[28:31], v[28:31]
ds_read_b128 a[92:95], v1 offset:23552
s_nop 7
v_exp_f32 v16, v16
v_exp_f32 v17, v17
v_exp_f32 v18, v18
v_exp_f32 v19, v19
v_exp_f32 v20, v20
v_exp_f32 v21, v21
v_exp_f32 v22, v22
v_exp_f32 v23, v23
v_exp_f32 v24, v24
v_exp_f32 v25, v25
v_exp_f32 v26, v26
v_exp_f32 v27, v27
v_exp_f32 v28, v28
v_exp_f32 v29, v29
v_exp_f32 v30, v30
v_exp_f32 v31, v31
s_nop 0
v_add_f32 v3, v3, v16
v_add_f32 v3, v3, v17
v_add_f32 v3, v3, v18
v_add_f32 v3, v3, v19
v_add_f32 v3, v3, v20
v_add_f32 v3, v3, v21
v_add_f32 v3, v3, v22
v_add_f32 v3, v3, v23
v_add_f32 v4, v4, v24
v_add_f32 v4, v4, v25
v_add_f32 v4, v4, v26
v_add_f32 v4, v4, v27
v_add_f32 v4, v4, v28
v_add_f32 v4, v4, v29
v_add_f32 v4, v4, v30
v_add_f32 v4, v4, v31
v_cvt_pk_bf16_f32 v48, v16, v17
v_cvt_pk_bf16_f32 v49, v18, v19
v_cvt_pk_bf16_f32 v50, v20, v21
v_cvt_pk_bf16_f32 v51, v22, v23
v_cvt_pk_bf16_f32 v52, v24, v25
v_cvt_pk_bf16_f32 v53, v26, v27
v_cvt_pk_bf16_f32 v54, v28, v29
v_cvt_pk_bf16_f32 v55, v30, v31
s_waitcnt lgkmcnt(0)
s_nop 0
v_mfma_f32_16x16x32_bf16 v[64:67], a[64:67], v[48:51], v[64:67]
v_mfma_f32_16x16x32_bf16 v[96:99], a[64:67], v[52:55], v[96:99]
v_mfma_f32_16x16x32_bf16 v[68:71], a[68:71], v[48:51], v[68:71]
v_mfma_f32_16x16x32_bf16 v[100:103], a[68:71], v[52:55], v[100:103]
v_mfma_f32_16x16x32_bf16 v[72:75], a[72:75], v[48:51], v[72:75]
v_mfma_f32_16x16x32_bf16 v[104:107], a[72:75], v[52:55], v[104:107]
v_mfma_f32_16x16x32_bf16 v[76:79], a[76:79], v[48:51], v[76:79]
v_mfma_f32_16x16x32_bf16 v[108:111], a[76:79], v[52:55], v[108:111]
v_mfma_f32_16x16x32_bf16 v[80:83], a[80:83], v[48:51], v[80:83]
v_mfma_f32_16x16x32_bf16 v[112:115], a[80:83], v[52:55], v[112:115]
v_mfma_f32_16x16x32_bf16 v[84:87], a[84:87], v[48:51], v[84:87]
v_mfma_f32_16x16x32_bf16 v[116:119], a[84:87], v[52:55], v[116:119]
v_mfma_f32_16x16x32_bf16 v[88:91], a[88:91], v[48:51], v[88:91]
v_mfma_f32_16x16x32_bf16 v[120:123], a[88:91], v[52:55], v[120:123]
v_mfma_f32_16x16x32_bf16 v[92:95], a[92:95], v[48:51], v[92:95]
v_mfma_f32_16x16x32_bf16 v[124:127], a[92:95], v[52:55], v[124:127]
s_add_u32 s29, s29, 1
v_mov_b32 v1, v2
v_add_u32 v2, 8192, v2
s_branch L_dl_1029
L_dlast_1030:
ds_read_b128 a[32:35], v1 offset:0
ds_read_b128 a[36:39], v1 offset:1024
ds_read_b128 a[40:43], v1 offset:2048
ds_read_b128 a[44:47], v1 offset:3072
ds_read_b128 a[48:51], v1 offset:4096
ds_read_b128 a[52:55], v1 offset:5120
ds_read_b128 a[56:59], v1 offset:6144
ds_read_b128 a[60:63], v1 offset:7168
ds_read_b128 a[64:67], v1 offset:16384
ds_read_b128 a[68:71], v1 offset:17408
ds_read_b128 a[72:75], v1 offset:18432
ds_read_b128 a[76:79], v1 offset:19456
ds_read_b128 a[80:83], v1 offset:20480
ds_read_b128 a[84:87], v1 offset:21504
ds_read_b128 a[88:91], v1 offset:22528
s_waitcnt lgkmcnt(7)
v_mfma_f32_16x16x32_bf16 v[16:19], a[32:35], a[0:3], v[8:11]
v_mfma_f32_16x16x32_bf16 v[24:27], a[32:35], a[16:19], v[12:15]
v_mfma_f32_16x16x32_bf16 v[16:19], a[36:39], a[4:7], v[16:19]
v_mfma_f32_16x16x32_bf16 v[24:27], a[36:39], a[20:23], v[24:27]
v_mfma_f32_16x16x32_bf16 v[16:19], a[40:43], a[8:11], v[16:19]
v_mfma_f32_16x16x32_bf16 v[24:27], a[40:43], a[24:27], v[24:27]
v_mfma_f32_16x16x32_bf16 v[16:19], a[44:47], a[12:15], v[16:19]
v_mfma_f32_16x16x32_bf16 v[24:27], a[44:47], a[28:31], v[24:27]
v_mfma_f32_16x16x32_bf16 v[28:31], a[48:51], a[16:19], v[12:15]
v_mfma_f32_16x16x32_bf16 v[28:31], a[52:55], a[20:23], v[28:31]
v_mfma_f32_16x16x32_bf16 v[28:31], a[56:59], a[24:27], v[28:31]
v_mfma_f32_16x16x32_bf16 v[28:31], a[60:63], a[28:31], v[28:31]
ds_read_b128 a[92:95], v1 offset:23552
s_nop 7
v_exp_f32 v16, v16
v_exp_f32 v17, v17
v_exp_f32 v18, v18
v_exp_f32 v19, v19
v_exp_f32 v24, v24
v_exp_f32 v25, v25
v_exp_f32 v26, v26
v_exp_f32 v27, v27
v_exp_f32 v28, v28
v_exp_f32 v29, v29
v_exp_f32 v30, v30
v_exp_f32 v31, v31
s_nop 0
v_cndmask_b32 v16, 0, v16, s[44:45]
v_add_f32 v3, v3, v16
v_cndmask_b32 v17, 0, v17, s[46:47]
v_add_f32 v3, v3, v17
v_cndmask_b32 v18, 0, v18, s[48:49]
v_add_f32 v3, v3, v18
v_cndmask_b32 v19, 0, v19, s[50:51]
v_add_f32 v3, v3, v19
v_add_f32 v4, v4, v24
v_add_f32 v4, v4, v25
v_add_f32 v4, v4, v26
v_add_f32 v4, v4, v27
v_cndmask_b32 v28, 0, v28, s[44:45]
v_add_f32 v4, v4, v28
v_cndmask_b32 v29, 0, v29, s[46:47]
v_add_f32 v4, v4, v29
v_cndmask_b32 v30, 0, v30, s[48:49]
v_add_f32 v4, v4, v30
v_cndmask_b32 v31, 0, v31, s[50:51]
v_add_f32 v4, v4, v31
v_cvt_pk_bf16_f32 v48, v16, v17
v_cvt_pk_bf16_f32 v49, v18, v19
v_mov_b32 v50, 0
v_mov_b32 v51, 0
v_cvt_pk_bf16_f32 v52, v24, v25
v_cvt_pk_bf16_f32 v53, v26, v27
v_cvt_pk_bf16_f32 v54, v28, v29
v_cvt_pk_bf16_f32 v55, v30, v31
s_waitcnt lgkmcnt(0)
s_nop 0
v_mfma_f32_16x16x32_bf16 v[64:67], a[64:67], v[48:51], v[64:67]
v_mfma_f32_16x16x32_bf16 v[96:99], a[64:67], v[52:55], v[96:99]
v_mfma_f32_16x16x32_bf16 v[68:71], a[68:71], v[48:51], v[68:71]
v_mfma_f32_16x16x32_bf16 v[100:103], a[68:71], v[52:55], v[100:103]
v_mfma_f32_16x16x32_bf16 v[72:75], a[72:75], v[48:51], v[72:75]
v_mfma_f32_16x16x32_bf16 v[104:107], a[72:75], v[52:55], v[104:107]
v_mfma_f32_16x16x32_bf16 v[76:79], a[76:79], v[48:51], v[76:79]
v_mfma_f32_16x16x32_bf16 v[108:111], a[76:79], v[52:55], v[108:111]
v_mfma_f32_16x16x32_bf16 v[80:83], a[80:83], v[48:51], v[80:83]
v_mfma_f32_16x16x32_bf16 v[112:115], a[80:83], v[52:55], v[112:115]
v_mfma_f32_16x16x32_bf16 v[84:87], a[84:87], v[48:51], v[84:87]
v_mfma_f32_16x16x32_bf16 v[116:119], a[84:87], v[52:55], v[116:119]
v_mfma_f32_16x16x32_bf16 v[88:91], a[88:91], v[48:51], v[88:91]
v_mfma_f32_16x16x32_bf16 v[120:123], a[88:91], v[52:55], v[120:123]
v_mfma_f32_16x16x32_bf16 v[92:95], a[92:95], v[48:51], v[92:95]
v_mfma_f32_16x16x32_bf16 v[124:127], a[92:95], v[52:55], v[124:127]
L_fin_1028:
s_setprio 0
v_mov_b32 v6, v3
s_nop 1
v_permlane16_swap_b32 v3, v6
v_add_f32 v3, v3, v6
v_mov_b32 v6, v3
s_nop 1
v_permlane32_swap_b32 v3, v6
v_add_f32 v3, v3, v6
v_mov_b32 v6, v4
s_nop 1
v_permlane16_swap_b32 v4, v6
v_add_f32 v4, v4, v6
v_mov_b32 v6, v4
s_nop 1
v_permlane32_swap_b32 v4, v6
v_add_f32 v4, v4, v6
s_cmp_lg_u32 s42, 0
s_cbranch_scc1 L_pass_1033
s_mov_b32 s38, 0x21800000
s_mov_b32 s39, 0x5d800000
v_cmp_le_f32 vcc, s38, v3
v_cmp_le_f32 s[56:57], s38, v4
s_nop 1
s_and_b64 s[56:57], s[56:57], vcc
v_cmp_ge_f32 vcc, s39, v3
s_nop 1
s_and_b64 s[56:57], s[56:57], vcc
v_cmp_ge_f32 vcc, s39, v4
s_nop 1
s_and_b64 s[56:57], s[56:57], vcc
s_cmp_eq_u64 s[56:57], exec
s_cbranch_scc1 L_pass_1033
v_mov_b32 v6, s52
v_mov_b32 v7, 1
ds_write_b32 v6, v7
L_pass_1033:
v_rcp_f32 v3, v3
v_rcp_f32 v4, v4
s_nop 7
s_lshl_b32 s38, s25, 17
s_lshl_b32 s39, s21, 12
s_add_u32 s38, s38, s39
s_add_u32 s38, s38, 0x4200000
v_mul_f32 v64, v64, v3
v_mul_f32 v65, v65, v3
v_mul_f32 v66, v66, v3
v_mul_f32 v67, v67, v3
v_mul_f32 v68, v68, v3
v_mul_f32 v69, v69, v3
v_mul_f32 v70, v70, v3
v_mul_f32 v71, v71, v3
v_cvt_pk_bf16_f32 v64, v64, v65
v_cvt_pk_bf16_f32 v65, v66, v67
v_cvt_pk_bf16_f32 v66, v68, v69
v_cvt_pk_bf16_f32 v67, v70, v71
buffer_store_dwordx4 v[64:67], v5, s[4:7], s38 offen offset:0 sc1
v_mul_f32 v72, v72, v3
v_mul_f32 v73, v73, v3
v_mul_f32 v74, v74, v3
v_mul_f32 v75, v75, v3
v_mul_f32 v76, v76, v3
v_mul_f32 v77, v77, v3
v_mul_f32 v78, v78, v3
v_mul_f32 v79, v79, v3
v_cvt_pk_bf16_f32 v72, v72, v73
v_cvt_pk_bf16_f32 v73, v74, v75
v_cvt_pk_bf16_f32 v74, v76, v77
v_cvt_pk_bf16_f32 v75, v78, v79
buffer_store_dwordx4 v[72:75], v5, s[4:7], s38 offen offset:1024 sc1
v_mul_f32 v80, v80, v3
v_mul_f32 v81, v81, v3
v_mul_f32 v82, v82, v3
v_mul_f32 v83, v83, v3
v_mul_f32 v84, v84, v3
v_mul_f32 v85, v85, v3
v_mul_f32 v86, v86, v3
v_mul_f32 v87, v87, v3
v_cvt_pk_bf16_f32 v80, v80, v81
v_cvt_pk_bf16_f32 v81, v82, v83
v_cvt_pk_bf16_f32 v82, v84, v85
v_cvt_pk_bf16_f32 v83, v86, v87
buffer_store_dwordx4 v[80:83], v5, s[4:7], s38 offen offset:2048 sc1
v_mul_f32 v88, v88, v3
v_mul_f32 v89, v89, v3
v_mul_f32 v90, v90, v3
v_mul_f32 v91, v91, v3
v_mul_f32 v92, v92, v3
v_mul_f32 v93, v93, v3
v_mul_f32 v94, v94, v3
v_mul_f32 v95, v95, v3
v_cvt_pk_bf16_f32 v88, v88, v89
v_cvt_pk_bf16_f32 v89, v90, v91
v_cvt_pk_bf16_f32 v90, v92, v93
v_cvt_pk_bf16_f32 v91, v94, v95
buffer_store_dwordx4 v[88:91], v5, s[4:7], s38 offen offset:3072 sc1
s_add_u32 s38, s38, 0x20000
v_mul_f32 v96, v96, v4
v_mul_f32 v97, v97, v4
v_mul_f32 v98, v98, v4
v_mul_f32 v99, v99, v4
v_mul_f32 v100, v100, v4
v_mul_f32 v101, v101, v4
v_mul_f32 v102, v102, v4
v_mul_f32 v103, v103, v4
v_cvt_pk_bf16_f32 v96, v96, v97
v_cvt_pk_bf16_f32 v97, v98, v99
v_cvt_pk_bf16_f32 v98, v100, v101
v_cvt_pk_bf16_f32 v99, v102, v103
buffer_store_dwordx4 v[96:99], v5, s[4:7], s38 offen offset:0 sc1
v_mul_f32 v104, v104, v4
v_mul_f32 v105, v105, v4
v_mul_f32 v106, v106, v4
v_mul_f32 v107, v107, v4
v_mul_f32 v108, v108, v4
v_mul_f32 v109, v109, v4
v_mul_f32 v110, v110, v4
v_mul_f32 v111, v111, v4
v_cvt_pk_bf16_f32 v104, v104, v105
v_cvt_pk_bf16_f32 v105, v106, v107
v_cvt_pk_bf16_f32 v106, v108, v109
v_cvt_pk_bf16_f32 v107, v110, v111
buffer_store_dwordx4 v[104:107], v5, s[4:7], s38 offen offset:1024 sc1
v_mul_f32 v112, v112, v4
v_mul_f32 v113, v113, v4
v_mul_f32 v114, v114, v4
v_mul_f32 v115, v115, v4
v_mul_f32 v116, v116, v4
v_mul_f32 v117, v117, v4
v_mul_f32 v118, v118, v4
v_mul_f32 v119, v119, v4
v_cvt_pk_bf16_f32 v112, v112, v113
v_cvt_pk_bf16_f32 v113, v114, v115
v_cvt_pk_bf16_f32 v114, v116, v117
v_cvt_pk_bf16_f32 v115, v118, v119
buffer_store_dwordx4 v[112:115], v5, s[4:7], s38 offen offset:2048 sc1
v_mul_f32 v120, v120, v4
v_mul_f32 v121, v121, v4
v_mul_f32 v122, v122, v4
v_mul_f32 v123, v123, v4
v_mul_f32 v124, v124, v4
v_mul_f32 v125, v125, v4
v_mul_f32 v126, v126, v4
v_mul_f32 v127, v127, v4
v_cvt_pk_bf16_f32 v120, v120, v121
v_cvt_pk_bf16_f32 v121, v122, v123
v_cvt_pk_bf16_f32 v122, v124, v125
v_cvt_pk_bf16_f32 v123, v126, v127
buffer_store_dwordx4 v[120:123], v5, s[4:7], s38 offen offset:3072 sc1
s_waitcnt lgkmcnt(0)
s_barrier
v_mov_b32 v6, s52
ds_read_b32 v7, v6
s_waitcnt lgkmcnt(0)
s_nop 0
v_readfirstlane_b32 s38, v7
s_nop 3
s_cmp_lg_u32 s42, 0
s_cselect_b32 s38, 0, s38
s_cmp_lg_u32 s38, 0
s_cbranch_scc1 L_fallback_1031
s_branch L_attend_1034
L_fallback_1031:
s_waitcnt vmcnt(0)
s_mov_b32 s42, 1
v_mov_b32 v6, 0xff800000
v_mov_b32 v7, 0xff800000
v_mov_b32 v3, 0xff800000
s_cmp_eq_u32 s23, 0
s_cselect_b32 s40, s26, s27
s_lshl_b32 s40, s40, 1
s_add_u32 s29, s40, s24
s_mov_b32 s28, 0
L_fb_1035:
s_barrier
s_cmp_eq_u32 s23, 0
s_cbranch_scc1 L_fbnod_1037
s_lshl_b32 s35, s28, 14
s_add_u32 s35, s35, s30
s_mov_b32 m0, s34
s_nop 0
buffer_load_dwordx4 v5, s[4:7], s35 offen offset:0 sc1 lds
buffer_load_dwordx4 v5, s[4:7], s35 offen offset:1024 sc1 lds
buffer_load_dwordx4 v5, s[4:7], s35 offen offset:2048 sc1 lds
buffer_load_dwordx4 v5, s[4:7], s35 offen offset:3072 sc1 lds
s_waitcnt vmcnt(0)
L_fbnod_1037:
s_barrier
s_lshl_b32 s38, s28, 1
s_add_u32 s38, s38, 0
v_add_u32 v1, 0, v5
s_cmp_gt_u32 s38, s29
s_cbranch_scc1 L_fx_1040
s_cmp_eq_u32 s38, s29
s_cbranch_scc1 L_fm_1039
ds_read_b128 a[32:35], v1 offset:0
ds_read_b128 a[36:39], v1 offset:1024
ds_read_b128 a[40:43], v1 offset:2048
ds_read_b128 a[44:47], v1 offset:3072
ds_read_b128 a[48:51], v1 offset:4096
ds_read_b128 a[52:55], v1 offset:5120
ds_read_b128 a[56:59], v1 offset:6144
ds_read_b128 a[60:63], v1 offset:7168
s_waitcnt lgkmcnt(0)
v_mfma_f32_16x16x32_bf16 v[16:19], a[32:35], a[0:3], 0
v_mfma_f32_16x16x32_bf16 v[24:27], a[32:35], a[16:19], 0
v_mfma_f32_16x16x32_bf16 v[16:19], a[36:39], a[4:7], v[16:19]
v_mfma_f32_16x16x32_bf16 v[24:27], a[36:39], a[20:23], v[24:27]
v_mfma_f32_16x16x32_bf16 v[16:19], a[40:43], a[8:11], v[16:19]
v_mfma_f32_16x16x32_bf16 v[24:27], a[40:43], a[24:27], v[24:27]
v_mfma_f32_16x16x32_bf16 v[16:19], a[44:47], a[12:15], v[16:19]
v_mfma_f32_16x16x32_bf16 v[24:27], a[44:47], a[28:31], v[24:27]
v_mfma_f32_16x16x32_bf16 v[20:23], a[48:51], a[0:3], 0
v_mfma_f32_16x16x32_bf16 v[28:31], a[48:51], a[16:19], 0
v_mfma_f32_16x16x32_bf16 v[20:23], a[52:55], a[4:7], v[20:23]
v_mfma_f32_16x16x32_bf16 v[28:31], a[52:55], a[20:23], v[28:31]
v_mfma_f32_16x16x32_bf16 v[20:23], a[56:59], a[8:11], v[20:23]
v_mfma_f32_16x16x32_bf16 v[28:31], a[56:59], a[24:27], v[28:31]
v_mfma_f32_16x16x32_bf16 v[20:23], a[60:63], a[12:15], v[20:23]
v_mfma_f32_16x16x32_bf16 v[28:31], a[60:63], a[28:31], v[28:31]
s_nop 7
v_max_f32 v6, v6, v16
v_max_f32 v6, v6, v17
v_max_f32 v6, v6, v18
v_max_f32 v6, v6, v19
v_max_f32 v6, v6, v20
v_max_f32 v6, v6, v21
v_max_f32 v6, v6, v22
v_max_f32 v6, v6, v23
v_max_f32 v7, v7, v24
v_max_f32 v7, v7, v25
v_max_f32 v7, v7, v26
v_max_f32 v7, v7, v27
v_max_f32 v7, v7, v28
v_max_f32 v7, v7, v29
v_max_f32 v7, v7, v30
v_max_f32 v7, v7, v31
s_branch L_fx_1040
L_fm_1039:
ds_read_b128 a[32:35], v1 offset:0
ds_read_b128 a[36:39], v1 offset:1024
ds_read_b128 a[40:43], v1 offset:2048
ds_read_b128 a[44:47], v1 offset:3072
ds_read_b128 a[48:51], v1 offset:4096
ds_read_b128 a[52:55], v1 offset:5120
ds_read_b128 a[56:59], v1 offset:6144
ds_read_b128 a[60:63], v1 offset:7168
s_waitcnt lgkmcnt(0)
v_mfma_f32_16x16x32_bf16 v[16:19], a[32:35], a[0:3], 0
v_mfma_f32_16x16x32_bf16 v[24:27], a[32:35], a[16:19], 0
v_mfma_f32_16x16x32_bf16 v[16:19], a[36:39], a[4:7], v[16:19]
v_mfma_f32_16x16x32_bf16 v[24:27], a[36:39], a[20:23], v[24:27]
v_mfma_f32_16x16x32_bf16 v[16:19], a[40:43], a[8:11], v[16:19]
v_mfma_f32_16x16x32_bf16 v[24:27], a[40:43], a[24:27], v[24:27]
v_mfma_f32_16x16x32_bf16 v[16:19], a[44:47], a[12:15], v[16:19]
v_mfma_f32_16x16x32_bf16 v[24:27], a[44:47], a[28:31], v[24:27]
v_mfma_f32_16x16x32_bf16 v[28:31], a[48:51], a[16:19], 0
v_mfma_f32_16x16x32_bf16 v[28:31], a[52:55], a[20:23], v[28:31]
v_mfma_f32_16x16x32_bf16 v[28:31], a[56:59], a[24:27], v[28:31]
v_mfma_f32_16x16x32_bf16 v[28:31], a[60:63], a[28:31], v[28:31]
s_nop 7
v_cndmask_b32 v16, v3, v16, s[44:45]
v_max_f32 v6, v6, v16
v_cndmask_b32 v17, v3, v17, s[46:47]
v_max_f32 v6, v6, v17
v_cndmask_b32 v18, v3, v18, s[48:49]
v_max_f32 v6, v6, v18
v_cndmask_b32 v19, v3, v19, s[50:51]
v_max_f32 v6, v6, v19
v_max_f32 v7, v7, v24
v_max_f32 v7, v7, v25
v_max_f32 v7, v7, v26
v_max_f32 v7, v7, v27
v_cndmask_b32 v28, v3, v28, s[44:45]
v_max_f32 v7, v7, v28
v_cndmask_b32 v29, v3, v29, s[46:47]
v_max_f32 v7, v7, v29
v_cndmask_b32 v30, v3, v30, s[48:49]
v_max_f32 v7, v7, v30
v_cndmask_b32 v31, v3, v31, s[50:51]
v_max_f32 v7, v7, v31
L_fx_1040:
s_lshl_b32 s38, s28, 1
s_add_u32 s38, s38, 1
v_add_u32 v1, 8192, v5
s_cmp_gt_u32 s38, s29
s_cbranch_scc1 L_fx_1043
s_cmp_eq_u32 s38, s29
s_cbranch_scc1 L_fm_1042
ds_read_b128 a[32:35], v1 offset:0
ds_read_b128 a[36:39], v1 offset:1024
ds_read_b128 a[40:43], v1 offset:2048
ds_read_b128 a[44:47], v1 offset:3072
ds_read_b128 a[48:51], v1 offset:4096
ds_read_b128 a[52:55], v1 offset:5120
ds_read_b128 a[56:59], v1 offset:6144
ds_read_b128 a[60:63], v1 offset:7168
s_waitcnt lgkmcnt(0)
v_mfma_f32_16x16x32_bf16 v[16:19], a[32:35], a[0:3], 0
v_mfma_f32_16x16x32_bf16 v[24:27], a[32:35], a[16:19], 0
v_mfma_f32_16x16x32_bf16 v[16:19], a[36:39], a[4:7], v[16:19]
v_mfma_f32_16x16x32_bf16 v[24:27], a[36:39], a[20:23], v[24:27]
v_mfma_f32_16x16x32_bf16 v[16:19], a[40:43], a[8:11], v[16:19]
v_mfma_f32_16x16x32_bf16 v[24:27], a[40:43], a[24:27], v[24:27]
v_mfma_f32_16x16x32_bf16 v[16:19], a[44:47], a[12:15], v[16:19]
v_mfma_f32_16x16x32_bf16 v[24:27], a[44:47], a[28:31], v[24:27]
v_mfma_f32_16x16x32_bf16 v[20:23], a[48:51], a[0:3], 0
v_mfma_f32_16x16x32_bf16 v[28:31], a[48:51], a[16:19], 0
v_mfma_f32_16x16x32_bf16 v[20:23], a[52:55], a[4:7], v[20:23]
v_mfma_f32_16x16x32_bf16 v[28:31], a[52:55], a[20:23], v[28:31]
v_mfma_f32_16x16x32_bf16 v[20:23], a[56:59], a[8:11], v[20:23]
v_mfma_f32_16x16x32_bf16 v[28:31], a[56:59], a[24:27], v[28:31]
v_mfma_f32_16x16x32_bf16 v[20:23], a[60:63], a[12:15], v[20:23]
v_mfma_f32_16x16x32_bf16 v[28:31], a[60:63], a[28:31], v[28:31]
s_nop 7
v_max_f32 v6, v6, v16
v_max_f32 v6, v6, v17
v_max_f32 v6, v6, v18
v_max_f32 v6, v6, v19
v_max_f32 v6, v6, v20
v_max_f32 v6, v6, v21
v_max_f32 v6, v6, v22
v_max_f32 v6, v6, v23
v_max_f32 v7, v7, v24
v_max_f32 v7, v7, v25
v_max_f32 v7, v7, v26
v_max_f32 v7, v7, v27
v_max_f32 v7, v7, v28
v_max_f32 v7, v7, v29
v_max_f32 v7, v7, v30
v_max_f32 v7, v7, v31
s_branch L_fx_1043
L_fm_1042:
ds_read_b128 a[32:35], v1 offset:0
ds_read_b128 a[36:39], v1 offset:1024
ds_read_b128 a[40:43], v1 offset:2048
ds_read_b128 a[44:47], v1 offset:3072
ds_read_b128 a[48:51], v1 offset:4096
ds_read_b128 a[52:55], v1 offset:5120
ds_read_b128 a[56:59], v1 offset:6144
ds_read_b128 a[60:63], v1 offset:7168
s_waitcnt lgkmcnt(0)
v_mfma_f32_16x16x32_bf16 v[16:19], a[32:35], a[0:3], 0
v_mfma_f32_16x16x32_bf16 v[24:27], a[32:35], a[16:19], 0
v_mfma_f32_16x16x32_bf16 v[16:19], a[36:39], a[4:7], v[16:19]
v_mfma_f32_16x16x32_bf16 v[24:27], a[36:39], a[20:23], v[24:27]
v_mfma_f32_16x16x32_bf16 v[16:19], a[40:43], a[8:11], v[16:19]
v_mfma_f32_16x16x32_bf16 v[24:27], a[40:43], a[24:27], v[24:27]
v_mfma_f32_16x16x32_bf16 v[16:19], a[44:47], a[12:15], v[16:19]
v_mfma_f32_16x16x32_bf16 v[24:27], a[44:47], a[28:31], v[24:27]
v_mfma_f32_16x16x32_bf16 v[28:31], a[48:51], a[16:19], 0
v_mfma_f32_16x16x32_bf16 v[28:31], a[52:55], a[20:23], v[28:31]
v_mfma_f32_16x16x32_bf16 v[28:31], a[56:59], a[24:27], v[28:31]
v_mfma_f32_16x16x32_bf16 v[28:31], a[60:63], a[28:31], v[28:31]
s_nop 7
v_cndmask_b32 v16, v3, v16, s[44:45]
v_max_f32 v6, v6, v16
v_cndmask_b32 v17, v3, v17, s[46:47]
v_max_f32 v6, v6, v17
v_cndmask_b32 v18, v3, v18, s[48:49]
v_max_f32 v6, v6, v18
v_cndmask_b32 v19, v3, v19, s[50:51]
v_max_f32 v6, v6, v19
v_max_f32 v7, v7, v24
v_max_f32 v7, v7, v25
v_max_f32 v7, v7, v26
v_max_f32 v7, v7, v27
v_cndmask_b32 v28, v3, v28, s[44:45]
v_max_f32 v7, v7, v28
v_cndmask_b32 v29, v3, v29, s[46:47]
v_max_f32 v7, v7, v29
v_cndmask_b32 v30, v3, v30, s[48:49]
v_max_f32 v7, v7, v30
v_cndmask_b32 v31, v3, v31, s[50:51]
v_max_f32 v7, v7, v31
L_fx_1043:
s_add_u32 s28, s28, 1
s_add_u32 s38, s26, 2
s_cmp_lt_u32 s28, s38
s_cbranch_scc1 L_fb_1035
v_mov_b32 v4, v6
s_nop 1
v_permlane16_swap_b32 v6, v4
v_max_f32 v6, v6, v4
v_mov_b32 v4, v6
s_nop 1
v_permlane32_swap_b32 v6, v4
v_max_f32 v6, v6, v4
v_sub_f32 v8, 0, v6
v_sub_f32 v9, 0, v6
v_sub_f32 v10, 0, v6
v_sub_f32 v11, 0, v6
v_mov_b32 v4, v7
s_nop 1
v_permlane16_swap_b32 v7, v4
v_max_f32 v7, v7, v4
v_mov_b32 v4, v7
s_nop 1
v_permlane32_swap_b32 v7, v4
v_max_f32 v7, v7, v4
v_sub_f32 v12, 0, v7
v_sub_f32 v13, 0, v7
v_sub_f32 v14, 0, v7
v_sub_f32 v15, 0, v7
s_barrier
s_add_u32 s35, s30, 0
s_add_u32 s36, s31, 0
s_cmp_eq_u32 s23, 0
s_cselect_b32 s35, s35, s36
s_lshl_b32 s38, s23, 14
s_add_u32 s38, s38, s34
s_add_u32 m0, s38, 0
s_nop 0
buffer_load_dwordx4 v5, s[4:7], s35 offen offset:0 sc1 lds
buffer_load_dwordx4 v5, s[4:7], s35 offen offset:1024 sc1 lds
buffer_load_dwordx4 v5, s[4:7], s35 offen offset:2048 sc1 lds
buffer_load_dwordx4 v5, s[4:7], s35 offen offset:3072 sc1 lds
s_add_u32 s35, s30, 16384
s_add_u32 s36, s31, 0
s_cmp_eq_u32 s23, 0
s_cselect_b32 s35, s35, s36
s_lshl_b32 s38, s23, 14
s_add_u32 s38, s38, s34
s_add_u32 m0, s38, 32768
s_nop 0
buffer_load_dwordx4 v5, s[4:7], s35 offen offset:0 sc1 lds
buffer_load_dwordx4 v5, s[4:7], s35 offen offset:1024 sc1 lds
buffer_load_dwordx4 v5, s[4:7], s35 offen offset:2048 sc1 lds
buffer_load_dwordx4 v5, s[4:7], s35 offen offset:3072 sc1 lds
s_add_u32 s35, s30, 32768
s_add_u32 s36, s31, 16384
s_cmp_eq_u32 s23, 0
s_cselect_b32 s35, s35, s36
s_lshl_b32 s38, s23, 14
s_add_u32 s38, s38, s34
s_add_u32 m0, s38, 65536
s_nop 0
buffer_load_dwordx4 v5, s[4:7], s35 offen offset:0 sc1 lds
buffer_load_dwordx4 v5, s[4:7], s35 offen offset:1024 sc1 lds
buffer_load_dwordx4 v5, s[4:7], s35 offen offset:2048 sc1 lds
buffer_load_dwordx4 v5, s[4:7], s35 offen offset:3072 sc1 lds
s_branch L_att_start_1011
L_attend_1034:
v_mbcnt_lo_u32_b32 v0, -1, 0
v_mbcnt_hi_u32_b32 v0, -1, v0
v_lshlrev_b32 v5, 4, v0
s_and_b32 s23, s2, 7
s_lshl_b32 s23, s23, 2
s_bfe_u32 s30, s2, 0x20003
s_add_u32 s23, s23, s30
s_lshr_b32 s24, s2, 5
s_and_b32 s28, s20, 3
s_lshr_b32 s29, s20, 2
s_bfe_u32 s36, s2, 0x20001
s_and_b32 s37, s2, 1
s_lshl_b32 s37, s37, 3
s_bfe_u32 s30, s2, 0x30003
s_add_u32 s37, s37, s30
s_lshr_b32 s38, s2, 6
s_and_b32 s39, s20, 3
s_lshr_b32 s40, s20, 2
s_load_dwordx2 s[12:13], s[0:1], 40
s_load_dwordx2 s[16:17], s[0:1], 0
v_lshrrev_b32 v14, 4, v0
v_lshlrev_b32 v3, 10, v14
v_bfe_u32 v15, v0, 1, 3
v_xor_b32 v15, v15, v14
v_and_b32 v10, 1, v0
v_lshlrev_b32 v10, 4, v10
v_add_u32 v3, v3, v10
v_xor_b32 v11, 4, v15
v_lshl_add_u32 v4, v11, 5, v3
v_lshl_add_u32 v3, v15, 5, v3
v_add_u32 v4, 3072, v4
v_lshrrev_b32 v14, 4, v0
v_bfe_u32 v15, v0, 2, 2
v_lshl_add_u32 v14, v14, 2, v15
v_lshlrev_b32 v6, 8, v14
v_and_b32 v14, 7, v14
v_lshl_add_u32 v6, v14, 5, v6
v_and_b32 v15, 3, v0
v_lshl_add_u32 v6, v15, 3, v6
s_lshl_b32 s30, s40, 7
v_xor_b32 v6, s30, v6
v_add_u32 v6, 16384, v6
v_xor_b32 v7, 32, v6
v_xor_b32 v8, 64, v6
v_xor_b32 v9, 96, v6
s_lshl_b32 s30, s39, 12
v_add_u32 v10, s30, v5
s_lshl_b32 s41, s37, 3
s_add_u32 s41, s41, s20
s_lshl_b32 s41, s41, 17
s_lshl_b32 s30, s36, 15
s_add_u32 s41, s41, s30
s_add_u32 s41, s41, 0x4200000
s_lshl_b32 s42, s36, 20
s_lshl_b32 s30, s20, 13
s_add_u32 s42, s42, s30
s_lshl_b32 s30, s38, 8
s_add_u32 s42, s42, s30
s_lshl_b32 s43, s20, 11
s_waitcnt lgkmcnt(0)
s_mov_b32 s14, 0x400000
s_mov_b32 s15, 0x20000
s_mov_b32 s18, 0x200000
s_mov_b32 s19, 0x20000
s_waitcnt vmcnt(0)
s_barrier
s_lshl_b32 s32, s22, 2
s_lshr_b32 s31, s21, 3
s_add_u32 s32, s32, s31
s_lshl_b32 s30, s32, 7
s_add_u32 s30, s30, 0x22800
s_cmp_eq_u32 s20, 0
s_cselect_b32 s31, s30, s86
v_mov_b32 v1, 1
s_mov_b64 exec, 1
buffer_atomic_add v1, off, s[4:7], s31 sc1
s_mov_b64 exec, -1
s_sub_u32 s31, 15, s37
s_min_u32 s30, s37, s31
s_lshl_b32 s30, s30, 2
s_add_u32 s30, s30, s36
s_lshl_b32 s32, s30, 7
s_add_u32 s32, s32, 0x22800
s_mov_b32 s45, 128
s_add_u32 m0, s43, 16384
s_add_u32 s30, s42, 0
buffer_load_dwordx4 v3, s[12:15], s30 offen lds
buffer_load_dwordx4 v4, s[12:15], s30 offen offset:1024 lds
s_add_u32 m0, s43, 49152
s_add_u32 s30, s42, 65536
buffer_load_dwordx4 v3, s[12:15], s30 offen lds
buffer_load_dwordx4 v4, s[12:15], s30 offen offset:1024 lds
s_add_u32 m0, s43, 81920
s_add_u32 s30, s42, 131072
buffer_load_dwordx4 v3, s[12:15], s30 offen lds
buffer_load_dwordx4 v4, s[12:15], s30 offen offset:1024 lds
s_add_u32 m0, s43, 114688
s_add_u32 s30, s42, 196608
buffer_load_dwordx4 v3, s[12:15], s30 offen lds
buffer_load_dwordx4 v4, s[12:15], s30 offen offset:1024 lds
s_cmp_lg_u32 s20, 0
s_cbranch_scc1 L_sok_1044
s_mov_b32 s31, 0x40000
L_sloop_1045:
buffer_load_dword v1, off, s[8:11], s45 sc1
s_waitcnt vmcnt(0)
v_readfirstlane_b32 s30, v1
s_nop 3
s_cmp_ge_u32 s30, 256
s_cbranch_scc1 L_sok_1044
s_sleep 16
s_sub_u32 s31, s31, 1
s_cmp_lg_u32 s31, 0
s_cbranch_scc1 L_sloop_1045
L_sok_1044:
s_cmp_lg_u32 s20, 0
s_cbranch_scc1 L_sok_1046
s_mov_b32 s31, 0x40000
L_sloop_1047:
buffer_load_dword v1, off, s[4:7], s32 sc1
s_waitcnt vmcnt(0)
v_readfirstlane_b32 s30, v1
s_nop 3
s_cmp_ge_u32 s30, 8
s_cbranch_scc1 L_sok_1046
s_sleep 16
s_sub_u32 s31, s31, 1
s_cmp_lg_u32 s31, 0
s_cbranch_scc1 L_sloop_1047
L_sok_1046:
s_barrier
s_add_u32 m0, s43, 0
s_add_u32 s30, s41, 0
buffer_load_dwordx4 v5, s[4:7], s30 offen sc1 lds
buffer_load_dwordx4 v5, s[4:7], s30 offen offset:1024 sc1 lds
s_add_u32 m0, s43, 32768
s_add_u32 s30, s41, 2048
buffer_load_dwordx4 v5, s[4:7], s30 offen sc1 lds
buffer_load_dwordx4 v5, s[4:7], s30 offen offset:1024 sc1 lds
s_add_u32 m0, s43, 65536
s_add_u32 s30, s41, 4096
buffer_load_dwordx4 v5, s[4:7], s30 offen sc1 lds
buffer_load_dwordx4 v5, s[4:7], s30 offen offset:1024 sc1 lds
s_add_u32 m0, s43, 98304
s_add_u32 s30, s41, 6144
buffer_load_dwordx4 v5, s[4:7], s30 offen sc1 lds
buffer_load_dwordx4 v5, s[4:7], s30 offen offset:1024 sc1 lds
s_lshl_b32 s44, s38, 2
s_add_u32 s44, s44, s36
v_and_b32 v12, 7, v0
v_bfe_u32 v13, v0, 3, 2
v_lshrrev_b32 v14, 5, v0
s_lshr_b32 s30, s44, 1
s_lshl_b32 s31, s37, 3
s_add_u32 s35, s30, s31
s_and_b32 s32, s44, 1
s_lshl_b32 s30, s35, 4
s_lshl_b32 s31, s32, 3
s_add_u32 s30, s30, s31
v_add_u32 v15, s30, v12
s_lshl_b32 s30, s20, 1
v_add_u32 v11, s30, v14
v_lshlrev_b32 v11, 5, v11
v_lshl_add_u32 v11, v13, 2, v11
v_lshlrev_b32 v15, 10, v15
v_lshl_add_u32 v15, v11, 1, v15
v_lshlrev_b32 v11, 2, v11
s_lshl_b32 s31, s32, 7
v_lshlrev_b32 v12, 4, v12
v_lshl_add_u32 v12, v13, 8, v12
v_add_u32 v12, s31, v12
v_lshl_add_u32 v13, v14, 11, v12
v_lshl_add_u32 v12, v14, 10, v12
buffer_load_dwordx2 v[120:121], v15, s[16:19], 0 offen
buffer_load_dwordx2 v[122:123], v15, s[16:19], 0 offen offset:32
s_mov_b32 s30, 0x1000
buffer_load_dwordx4 v[96:99], v11, s[4:7], s30 offen offset:0 sc1
buffer_load_dwordx4 v[100:103], v11, s[4:7], s30 offen offset:64 sc1
buffer_load_dwordx4 v[104:107], v11, s[4:7], s30 offen offset:2048 sc1
buffer_load_dwordx4 v[108:111], v11, s[4:7], s30 offen offset:2112 sc1
s_mov_b32 s30, 0x2000
buffer_load_dwordx4 v[112:115], v11, s[4:7], s30 offen offset:0 sc1
s_mov_b32 s30, 0x2000
buffer_load_dwordx4 v[116:119], v11, s[4:7], s30 offen offset:64 sc1
s_waitcnt vmcnt(14)
s_barrier
ds_read_b128 v[32:35], v10 offset:0
ds_read_b128 v[36:39], v10 offset:2048
ds_read_b64_tr_b16 v[16:17], v6 offset:0
ds_read_b64_tr_b16 v[18:19], v6 offset:4096
ds_read_b64_tr_b16 v[20:21], v7 offset:0
ds_read_b64_tr_b16 v[22:23], v7 offset:4096
ds_read_b64_tr_b16 v[24:25], v8 offset:0
ds_read_b64_tr_b16 v[26:27], v8 offset:4096
ds_read_b64_tr_b16 v[28:29], v9 offset:0
ds_read_b64_tr_b16 v[30:31], v9 offset:4096
s_waitcnt lgkmcnt(6)
v_mfma_f32_16x16x32_bf16 v[64:67], v[16:19], v[32:35], 0
ds_read_b128 v[56:59], v10 offset:1024
v_mfma_f32_16x16x32_bf16 v[68:71], v[16:19], v[36:39], 0
ds_read_b128 v[60:63], v10 offset:3072
s_waitcnt lgkmcnt(6)
v_mfma_f32_16x16x32_bf16 v[72:75], v[20:23], v[32:35], 0
ds_read_b64_tr_b16 v[40:41], v6 offset:8192
v_mfma_f32_16x16x32_bf16 v[76:79], v[20:23], v[36:39], 0
ds_read_b64_tr_b16 v[42:43], v6 offset:12288
s_waitcnt lgkmcnt(6)
v_mfma_f32_16x16x32_bf16 v[80:83], v[24:27], v[32:35], 0
ds_read_b64_tr_b16 v[44:45], v7 offset:8192
v_mfma_f32_16x16x32_bf16 v[84:87], v[24:27], v[36:39], 0
ds_read_b64_tr_b16 v[46:47], v7 offset:12288
s_waitcnt lgkmcnt(6)
v_mfma_f32_16x16x32_bf16 v[88:91], v[28:31], v[32:35], 0
ds_read_b64_tr_b16 v[48:49], v8 offset:8192
ds_read_b64_tr_b16 v[50:51], v8 offset:12288
v_mfma_f32_16x16x32_bf16 v[92:95], v[28:31], v[36:39], 0
ds_read_b64_tr_b16 v[52:53], v9 offset:8192
ds_read_b64_tr_b16 v[54:55], v9 offset:12288
s_waitcnt vmcnt(12)
s_barrier
v_add_u32 v6, 0x8000, v6
v_add_u32 v7, 0x8000, v7
v_add_u32 v8, 0x8000, v8
v_add_u32 v9, 0x8000, v9
v_add_u32 v10, 0x8000, v10
s_waitcnt lgkmcnt(6)
v_mfma_f32_16x16x32_bf16 v[64:67], v[40:43], v[56:59], v[64:67]
ds_read_b128 v[32:35], v10 offset:0
v_mfma_f32_16x16x32_bf16 v[68:71], v[40:43], v[60:63], v[68:71]
ds_read_b128 v[36:39], v10 offset:2048
s_waitcnt lgkmcnt(6)
v_mfma_f32_16x16x32_bf16 v[72:75], v[44:47], v[56:59], v[72:75]
ds_read_b64_tr_b16 v[16:17], v6 offset:0
v_mfma_f32_16x16x32_bf16 v[76:79], v[44:47], v[60:63], v[76:79]
ds_read_b64_tr_b16 v[18:19], v6 offset:4096
s_add_u32 m0, s43, 147456
s_add_u32 s30, s42, 262144
buffer_load_dwordx4 v3, s[12:15], s30 offen lds
buffer_load_dwordx4 v4, s[12:15], s30 offen offset:1024 lds
s_waitcnt lgkmcnt(6)
v_mfma_f32_16x16x32_bf16 v[80:83], v[48:51], v[56:59], v[80:83]
ds_read_b64_tr_b16 v[20:21], v7 offset:0
v_mfma_f32_16x16x32_bf16 v[84:87], v[48:51], v[60:63], v[84:87]
ds_read_b64_tr_b16 v[22:23], v7 offset:4096
s_add_u32 m0, s43, 131072
s_add_u32 s30, s41, 8192
buffer_load_dwordx4 v5, s[4:7], s30 offen sc1 lds
buffer_load_dwordx4 v5, s[4:7], s30 offen offset:1024 sc1 lds
s_waitcnt lgkmcnt(6)
v_mfma_f32_16x16x32_bf16 v[88:91], v[52:55], v[56:59], v[88:91]
ds_read_b64_tr_b16 v[24:25], v8 offset:0
ds_read_b64_tr_b16 v[26:27], v8 offset:4096
v_mfma_f32_16x16x32_bf16 v[92:95], v[52:55], v[60:63], v[92:95]
ds_read_b64_tr_b16 v[28:29], v9 offset:0
ds_read_b64_tr_b16 v[30:31], v9 offset:4096
s_waitcnt lgkmcnt(6)
v_mfma_f32_16x16x32_bf16 v[64:67], v[16:19], v[32:35], v[64:67]
ds_read_b128 v[56:59], v10 offset:1024
v_mfma_f32_16x16x32_bf16 v[68:71], v[16:19], v[36:39], v[68:71]
ds_read_b128 v[60:63], v10 offset:3072
s_waitcnt lgkmcnt(6)
v_mfma_f32_16x16x32_bf16 v[72:75], v[20:23], v[32:35], v[72:75]
ds_read_b64_tr_b16 v[40:41], v6 offset:8192
v_mfma_f32_16x16x32_bf16 v[76:79], v[20:23], v[36:39], v[76:79]
ds_read_b64_tr_b16 v[42:43], v6 offset:12288
s_waitcnt lgkmcnt(6)
v_mfma_f32_16x16x32_bf16 v[80:83], v[24:27], v[32:35], v[80:83]
ds_read_b64_tr_b16 v[44:45], v7 offset:8192
v_mfma_f32_16x16x32_bf16 v[84:87], v[24:27], v[36:39], v[84:87]
ds_read_b64_tr_b16 v[46:47], v7 offset:12288
s_waitcnt lgkmcnt(6)
v_mfma_f32_16x16x32_bf16 v[88:91], v[28:31], v[32:35], v[88:91]
ds_read_b64_tr_b16 v[48:49], v8 offset:8192
ds_read_b64_tr_b16 v[50:51], v8 offset:12288
v_mfma_f32_16x16x32_bf16 v[92:95], v[28:31], v[36:39], v[92:95]
ds_read_b64_tr_b16 v[52:53], v9 offset:8192
ds_read_b64_tr_b16 v[54:55], v9 offset:12288
s_waitcnt vmcnt(14)
s_barrier
v_add_u32 v6, 0x8000, v6
v_add_u32 v7, 0x8000, v7
v_add_u32 v8, 0x8000, v8
v_add_u32 v9, 0x8000, v9
v_add_u32 v10, 0x8000, v10
s_waitcnt lgkmcnt(6)
v_mfma_f32_16x16x32_bf16 v[64:67], v[40:43], v[56:59], v[64:67]
ds_read_b128 v[32:35], v10 offset:0
v_mfma_f32_16x16x32_bf16 v[68:71], v[40:43], v[60:63], v[68:71]
ds_read_b128 v[36:39], v10 offset:2048
s_waitcnt lgkmcnt(6)
v_mfma_f32_16x16x32_bf16 v[72:75], v[44:47], v[56:59], v[72:75]
ds_read_b64_tr_b16 v[16:17], v6 offset:0
v_mfma_f32_16x16x32_bf16 v[76:79], v[44:47], v[60:63], v[76:79]
ds_read_b64_tr_b16 v[18:19], v6 offset:4096
s_add_u32 m0, s43, 16384
s_add_u32 s30, s42, 327680
buffer_load_dwordx4 v3, s[12:15], s30 offen lds
buffer_load_dwordx4 v4, s[12:15], s30 offen offset:1024 lds
s_waitcnt lgkmcnt(6)
v_mfma_f32_16x16x32_bf16 v[80:83], v[48:51], v[56:59], v[80:83]
ds_read_b64_tr_b16 v[20:21], v7 offset:0
v_mfma_f32_16x16x32_bf16 v[84:87], v[48:51], v[60:63], v[84:87]
ds_read_b64_tr_b16 v[22:23], v7 offset:4096
s_add_u32 m0, s43, 0
s_add_u32 s30, s41, 10240
buffer_load_dwordx4 v5, s[4:7], s30 offen sc1 lds
buffer_load_dwordx4 v5, s[4:7], s30 offen offset:1024 sc1 lds
s_waitcnt lgkmcnt(6)
v_mfma_f32_16x16x32_bf16 v[88:91], v[52:55], v[56:59], v[88:91]
ds_read_b64_tr_b16 v[24:25], v8 offset:0
ds_read_b64_tr_b16 v[26:27], v8 offset:4096
v_mfma_f32_16x16x32_bf16 v[92:95], v[52:55], v[60:63], v[92:95]
ds_read_b64_tr_b16 v[28:29], v9 offset:0
ds_read_b64_tr_b16 v[30:31], v9 offset:4096
s_waitcnt lgkmcnt(6)
v_mfma_f32_16x16x32_bf16 v[64:67], v[16:19], v[32:35], v[64:67]
ds_read_b128 v[56:59], v10 offset:1024
v_mfma_f32_16x16x32_bf16 v[68:71], v[16:19], v[36:39], v[68:71]
ds_read_b128 v[60:63], v10 offset:3072
s_waitcnt lgkmcnt(6)
v_mfma_f32_16x16x32_bf16 v[72:75], v[20:23], v[32:35], v[72:75]
ds_read_b64_tr_b16 v[40:41], v6 offset:8192
v_mfma_f32_16x16x32_bf16 v[76:79], v[20:23], v[36:39], v[76:79]
ds_read_b64_tr_b16 v[42:43], v6 offset:12288
s_waitcnt lgkmcnt(6)
v_mfma_f32_16x16x32_bf16 v[80:83], v[24:27], v[32:35], v[80:83]
ds_read_b64_tr_b16 v[44:45], v7 offset:8192
v_mfma_f32_16x16x32_bf16 v[84:87], v[24:27], v[36:39], v[84:87]
ds_read_b64_tr_b16 v[46:47], v7 offset:12288
s_waitcnt lgkmcnt(6)
v_mfma_f32_16x16x32_bf16 v[88:91], v[28:31], v[32:35], v[88:91]
ds_read_b64_tr_b16 v[48:49], v8 offset:8192
ds_read_b64_tr_b16 v[50:51], v8 offset:12288
v_mfma_f32_16x16x32_bf16 v[92:95], v[28:31], v[36:39], v[92:95]
ds_read_b64_tr_b16 v[52:53], v9 offset:8192
ds_read_b64_tr_b16 v[54:55], v9 offset:12288
s_waitcnt vmcnt(16)
s_barrier
v_add_u32 v6, 0x8000, v6
v_add_u32 v7, 0x8000, v7
v_add_u32 v8, 0x8000, v8
v_add_u32 v9, 0x8000, v9
v_add_u32 v10, 0x8000, v10
s_waitcnt lgkmcnt(6)
v_mfma_f32_16x16x32_bf16 v[64:67], v[40:43], v[56:59], v[64:67]
ds_read_b128 v[32:35], v10 offset:0
v_mfma_f32_16x16x32_bf16 v[68:71], v[40:43], v[60:63], v[68:71]
ds_read_b128 v[36:39], v10 offset:2048
s_waitcnt lgkmcnt(6)
v_mfma_f32_16x16x32_bf16 v[72:75], v[44:47], v[56:59], v[72:75]
ds_read_b64_tr_b16 v[16:17], v6 offset:0
v_mfma_f32_16x16x32_bf16 v[76:79], v[44:47], v[60:63], v[76:79]
ds_read_b64_tr_b16 v[18:19], v6 offset:4096
s_add_u32 m0, s43, 49152
s_add_u32 s30, s42, 393216
buffer_load_dwordx4 v3, s[12:15], s30 offen lds
buffer_load_dwordx4 v4, s[12:15], s30 offen offset:1024 lds
s_waitcnt lgkmcnt(6)
v_mfma_f32_16x16x32_bf16 v[80:83], v[48:51], v[56:59], v[80:83]
ds_read_b64_tr_b16 v[20:21], v7 offset:0
v_mfma_f32_16x16x32_bf16 v[84:87], v[48:51], v[60:63], v[84:87]
ds_read_b64_tr_b16 v[22:23], v7 offset:4096
s_add_u32 m0, s43, 32768
s_add_u32 s30, s41, 12288
buffer_load_dwordx4 v5, s[4:7], s30 offen sc1 lds
buffer_load_dwordx4 v5, s[4:7], s30 offen offset:1024 sc1 lds
s_waitcnt lgkmcnt(6)
v_mfma_f32_16x16x32_bf16 v[88:91], v[52:55], v[56:59], v[88:91]
ds_read_b64_tr_b16 v[24:25], v8 offset:0
ds_read_b64_tr_b16 v[26:27], v8 offset:4096
v_mfma_f32_16x16x32_bf16 v[92:95], v[52:55], v[60:63], v[92:95]
ds_read_b64_tr_b16 v[28:29], v9 offset:0
ds_read_b64_tr_b16 v[30:31], v9 offset:4096
s_waitcnt lgkmcnt(6)
v_mfma_f32_16x16x32_bf16 v[64:67], v[16:19], v[32:35], v[64:67]
ds_read_b128 v[56:59], v10 offset:1024
v_mfma_f32_16x16x32_bf16 v[68:71], v[16:19], v[36:39], v[68:71]
ds_read_b128 v[60:63], v10 offset:3072
s_waitcnt lgkmcnt(6)
v_mfma_f32_16x16x32_bf16 v[72:75], v[20:23], v[32:35], v[72:75]
ds_read_b64_tr_b16 v[40:41], v6 offset:8192
v_mfma_f32_16x16x32_bf16 v[76:79], v[20:23], v[36:39], v[76:79]
ds_read_b64_tr_b16 v[42:43], v6 offset:12288
s_waitcnt lgkmcnt(6)
v_mfma_f32_16x16x32_bf16 v[80:83], v[24:27], v[32:35], v[80:83]
ds_read_b64_tr_b16 v[44:45], v7 offset:8192
v_mfma_f32_16x16x32_bf16 v[84:87], v[24:27], v[36:39], v[84:87]
ds_read_b64_tr_b16 v[46:47], v7 offset:12288
s_waitcnt lgkmcnt(6)
v_mfma_f32_16x16x32_bf16 v[88:91], v[28:31], v[32:35], v[88:91]
ds_read_b64_tr_b16 v[48:49], v8 offset:8192
ds_read_b64_tr_b16 v[50:51], v8 offset:12288
v_mfma_f32_16x16x32_bf16 v[92:95], v[28:31], v[36:39], v[92:95]
ds_read_b64_tr_b16 v[52:53], v9 offset:8192
ds_read_b64_tr_b16 v[54:55], v9 offset:12288
s_waitcnt vmcnt(8)
s_barrier
v_add_u32 v6, 0x8000, v6
v_add_u32 v7, 0x8000, v7
v_add_u32 v8, 0x8000, v8
v_add_u32 v9, 0x8000, v9
v_add_u32 v10, 0x8000, v10
s_waitcnt lgkmcnt(6)
v_mfma_f32_16x16x32_bf16 v[64:67], v[40:43], v[56:59], v[64:67]
ds_read_b128 v[32:35], v10 offset:0
v_mfma_f32_16x16x32_bf16 v[68:71], v[40:43], v[60:63], v[68:71]
ds_read_b128 v[36:39], v10 offset:2048
s_waitcnt lgkmcnt(6)
v_mfma_f32_16x16x32_bf16 v[72:75], v[44:47], v[56:59], v[72:75]
ds_read_b64_tr_b16 v[16:17], v6 offset:0
v_mfma_f32_16x16x32_bf16 v[76:79], v[44:47], v[60:63], v[76:79]
ds_read_b64_tr_b16 v[18:19], v6 offset:4096
s_add_u32 m0, s43, 81920
s_add_u32 s30, s42, 458752
buffer_load_dwordx4 v3, s[12:15], s30 offen lds
buffer_load_dwordx4 v4, s[12:15], s30 offen offset:1024 lds
s_waitcnt lgkmcnt(6)
v_mfma_f32_16x16x32_bf16 v[80:83], v[48:51], v[56:59], v[80:83]
ds_read_b64_tr_b16 v[20:21], v7 offset:0
v_mfma_f32_16x16x32_bf16 v[84:87], v[48:51], v[60:63], v[84:87]
ds_read_b64_tr_b16 v[22:23], v7 offset:4096
s_add_u32 m0, s43, 65536
s_add_u32 s30, s41, 14336
buffer_load_dwordx4 v5, s[4:7], s30 offen sc1 lds
buffer_load_dwordx4 v5, s[4:7], s30 offen offset:1024 sc1 lds
s_waitcnt lgkmcnt(6)
v_mfma_f32_16x16x32_bf16 v[88:91], v[52:55], v[56:59], v[88:91]
ds_read_b64_tr_b16 v[24:25], v8 offset:0
ds_read_b64_tr_b16 v[26:27], v8 offset:4096
v_mfma_f32_16x16x32_bf16 v[92:95], v[52:55], v[60:63], v[92:95]
ds_read_b64_tr_b16 v[28:29], v9 offset:0
ds_read_b64_tr_b16 v[30:31], v9 offset:4096
s_waitcnt lgkmcnt(6)
v_mfma_f32_16x16x32_bf16 v[64:67], v[16:19], v[32:35], v[64:67]
ds_read_b128 v[56:59], v10 offset:1024
v_mfma_f32_16x16x32_bf16 v[68:71], v[16:19], v[36:39], v[68:71]
ds_read_b128 v[60:63], v10 offset:3072
s_waitcnt lgkmcnt(6)
v_mfma_f32_16x16x32_bf16 v[72:75], v[20:23], v[32:35], v[72:75]
ds_read_b64_tr_b16 v[40:41], v6 offset:8192
v_mfma_f32_16x16x32_bf16 v[76:79], v[20:23], v[36:39], v[76:79]
ds_read_b64_tr_b16 v[42:43], v6 offset:12288
s_waitcnt lgkmcnt(6)
v_mfma_f32_16x16x32_bf16 v[80:83], v[24:27], v[32:35], v[80:83]
ds_read_b64_tr_b16 v[44:45], v7 offset:8192
v_mfma_f32_16x16x32_bf16 v[84:87], v[24:27], v[36:39], v[84:87]
ds_read_b64_tr_b16 v[46:47], v7 offset:12288
s_waitcnt lgkmcnt(6)
v_mfma_f32_16x16x32_bf16 v[88:91], v[28:31], v[32:35], v[88:91]
ds_read_b64_tr_b16 v[48:49], v8 offset:8192
ds_read_b64_tr_b16 v[50:51], v8 offset:12288
v_mfma_f32_16x16x32_bf16 v[92:95], v[28:31], v[36:39], v[92:95]
ds_read_b64_tr_b16 v[52:53], v9 offset:8192
ds_read_b64_tr_b16 v[54:55], v9 offset:12288
s_waitcnt vmcnt(8)
s_barrier
v_add_u32 v6, 0xfffe0000, v6
v_add_u32 v7, 0xfffe0000, v7
v_add_u32 v8, 0xfffe0000, v8
v_add_u32 v9, 0xfffe0000, v9
v_add_u32 v10, 0xfffe0000, v10
s_waitcnt lgkmcnt(6)
v_mfma_f32_16x16x32_bf16 v[64:67], v[40:43], v[56:59], v[64:67]
ds_read_b128 v[32:35], v10 offset:0
v_mfma_f32_16x16x32_bf16 v[68:71], v[40:43], v[60:63], v[68:71]
ds_read_b128 v[36:39], v10 offset:2048
s_waitcnt lgkmcnt(6)
v_mfma_f32_16x16x32_bf16 v[72:75], v[44:47], v[56:59], v[72:75]
ds_read_b64_tr_b16 v[16:17], v6 offset:0
v_mfma_f32_16x16x32_bf16 v[76:79], v[44:47], v[60:63], v[76:79]
ds_read_b64_tr_b16 v[18:19], v6 offset:4096
s_add_u32 m0, s43, 114688
s_add_u32 s30, s42, 524288
buffer_load_dwordx4 v3, s[12:15], s30 offen lds
buffer_load_dwordx4 v4, s[12:15], s30 offen offset:1024 lds
s_waitcnt lgkmcnt(6)
v_mfma_f32_16x16x32_bf16 v[80:83], v[48:51], v[56:59], v[80:83]
ds_read_b64_tr_b16 v[20:21], v7 offset:0
v_mfma_f32_16x16x32_bf16 v[84:87], v[48:51], v[60:63], v[84:87]
ds_read_b64_tr_b16 v[22:23], v7 offset:4096
s_add_u32 m0, s43, 98304
s_add_u32 s30, s41, 16384
buffer_load_dwordx4 v5, s[4:7], s30 offen sc1 lds
buffer_load_dwordx4 v5, s[4:7], s30 offen offset:1024 sc1 lds
s_waitcnt lgkmcnt(6)
v_mfma_f32_16x16x32_bf16 v[88:91], v[52:55], v[56:59], v[88:91]
ds_read_b64_tr_b16 v[24:25], v8 offset:0
ds_read_b64_tr_b16 v[26:27], v8 offset:4096
v_mfma_f32_16x16x32_bf16 v[92:95], v[52:55], v[60:63], v[92:95]
ds_read_b64_tr_b16 v[28:29], v9 offset:0
ds_read_b64_tr_b16 v[30:31], v9 offset:4096
s_waitcnt lgkmcnt(6)
v_mfma_f32_16x16x32_bf16 v[64:67], v[16:19], v[32:35], v[64:67]
ds_read_b128 v[56:59], v10 offset:1024
v_mfma_f32_16x16x32_bf16 v[68:71], v[16:19], v[36:39], v[68:71]
ds_read_b128 v[60:63], v10 offset:3072
s_waitcnt lgkmcnt(6)
v_mfma_f32_16x16x32_bf16 v[72:75], v[20:23], v[32:35], v[72:75]
ds_read_b64_tr_b16 v[40:41], v6 offset:8192
v_mfma_f32_16x16x32_bf16 v[76:79], v[20:23], v[36:39], v[76:79]
ds_read_b64_tr_b16 v[42:43], v6 offset:12288
s_waitcnt lgkmcnt(6)
v_mfma_f32_16x16x32_bf16 v[80:83], v[24:27], v[32:35], v[80:83]
ds_read_b64_tr_b16 v[44:45], v7 offset:8192
v_mfma_f32_16x16x32_bf16 v[84:87], v[24:27], v[36:39], v[84:87]
ds_read_b64_tr_b16 v[46:47], v7 offset:12288
s_waitcnt lgkmcnt(6)
v_mfma_f32_16x16x32_bf16 v[88:91], v[28:31], v[32:35], v[88:91]
ds_read_b64_tr_b16 v[48:49], v8 offset:8192
ds_read_b64_tr_b16 v[50:51], v8 offset:12288
v_mfma_f32_16x16x32_bf16 v[92:95], v[28:31], v[36:39], v[92:95]
ds_read_b64_tr_b16 v[52:53], v9 offset:8192
ds_read_b64_tr_b16 v[54:55], v9 offset:12288
s_waitcnt vmcnt(8)
s_barrier
v_add_u32 v6, 0x8000, v6
v_add_u32 v7, 0x8000, v7
v_add_u32 v8, 0x8000, v8
v_add_u32 v9, 0x8000, v9
v_add_u32 v10, 0x8000, v10
s_waitcnt lgkmcnt(6)
v_mfma_f32_16x16x32_bf16 v[64:67], v[40:43], v[56:59], v[64:67]
ds_read_b128 v[32:35], v10 offset:0
v_mfma_f32_16x16x32_bf16 v[68:71], v[40:43], v[60:63], v[68:71]
ds_read_b128 v[36:39], v10 offset:2048
s_waitcnt lgkmcnt(6)
v_mfma_f32_16x16x32_bf16 v[72:75], v[44:47], v[56:59], v[72:75]
ds_read_b64_tr_b16 v[16:17], v6 offset:0
v_mfma_f32_16x16x32_bf16 v[76:79], v[44:47], v[60:63], v[76:79]
ds_read_b64_tr_b16 v[18:19], v6 offset:4096
s_add_u32 m0, s43, 147456
s_add_u32 s30, s42, 589824
buffer_load_dwordx4 v3, s[12:15], s30 offen lds
buffer_load_dwordx4 v4, s[12:15], s30 offen offset:1024 lds
s_waitcnt lgkmcnt(6)
v_mfma_f32_16x16x32_bf16 v[80:83], v[48:51], v[56:59], v[80:83]
ds_read_b64_tr_b16 v[20:21], v7 offset:0
v_mfma_f32_16x16x32_bf16 v[84:87], v[48:51], v[60:63], v[84:87]
ds_read_b64_tr_b16 v[22:23], v7 offset:4096
s_add_u32 m0, s43, 131072
s_add_u32 s30, s41, 18432
buffer_load_dwordx4 v5, s[4:7], s30 offen sc1 lds
buffer_load_dwordx4 v5, s[4:7], s30 offen offset:1024 sc1 lds
s_waitcnt lgkmcnt(6)
v_mfma_f32_16x16x32_bf16 v[88:91], v[52:55], v[56:59], v[88:91]
ds_read_b64_tr_b16 v[24:25], v8 offset:0
ds_read_b64_tr_b16 v[26:27], v8 offset:4096
v_mfma_f32_16x16x32_bf16 v[92:95], v[52:55], v[60:63], v[92:95]
ds_read_b64_tr_b16 v[28:29], v9 offset:0
ds_read_b64_tr_b16 v[30:31], v9 offset:4096
s_waitcnt lgkmcnt(6)
v_mfma_f32_16x16x32_bf16 v[64:67], v[16:19], v[32:35], v[64:67]
ds_read_b128 v[56:59], v10 offset:1024
v_mfma_f32_16x16x32_bf16 v[68:71], v[16:19], v[36:39], v[68:71]
ds_read_b128 v[60:63], v10 offset:3072
s_waitcnt lgkmcnt(6)
v_mfma_f32_16x16x32_bf16 v[72:75], v[20:23], v[32:35], v[72:75]
ds_read_b64_tr_b16 v[40:41], v6 offset:8192
v_mfma_f32_16x16x32_bf16 v[76:79], v[20:23], v[36:39], v[76:79]
ds_read_b64_tr_b16 v[42:43], v6 offset:12288
s_waitcnt lgkmcnt(6)
v_mfma_f32_16x16x32_bf16 v[80:83], v[24:27], v[32:35], v[80:83]
ds_read_b64_tr_b16 v[44:45], v7 offset:8192
v_mfma_f32_16x16x32_bf16 v[84:87], v[24:27], v[36:39], v[84:87]
ds_read_b64_tr_b16 v[46:47], v7 offset:12288
s_waitcnt lgkmcnt(6)
v_mfma_f32_16x16x32_bf16 v[88:91], v[28:31], v[32:35], v[88:91]
ds_read_b64_tr_b16 v[48:49], v8 offset:8192
ds_read_b64_tr_b16 v[50:51], v8 offset:12288
v_mfma_f32_16x16x32_bf16 v[92:95], v[28:31], v[36:39], v[92:95]
ds_read_b64_tr_b16 v[52:53], v9 offset:8192
ds_read_b64_tr_b16 v[54:55], v9 offset:12288
s_waitcnt vmcnt(8)
s_barrier
v_add_u32 v6, 0x8000, v6
v_add_u32 v7, 0x8000, v7
v_add_u32 v8, 0x8000, v8
v_add_u32 v9, 0x8000, v9
v_add_u32 v10, 0x8000, v10
s_waitcnt lgkmcnt(6)
v_mfma_f32_16x16x32_bf16 v[64:67], v[40:43], v[56:59], v[64:67]
ds_read_b128 v[32:35], v10 offset:0
v_mfma_f32_16x16x32_bf16 v[68:71], v[40:43], v[60:63], v[68:71]
ds_read_b128 v[36:39], v10 offset:2048
s_waitcnt lgkmcnt(6)
v_mfma_f32_16x16x32_bf16 v[72:75], v[44:47], v[56:59], v[72:75]
ds_read_b64_tr_b16 v[16:17], v6 offset:0
v_mfma_f32_16x16x32_bf16 v[76:79], v[44:47], v[60:63], v[76:79]
ds_read_b64_tr_b16 v[18:19], v6 offset:4096
s_add_u32 m0, s43, 16384
s_add_u32 s30, s42, 655360
buffer_load_dwordx4 v3, s[12:15], s30 offen lds
buffer_load_dwordx4 v4, s[12:15], s30 offen offset:1024 lds
s_waitcnt lgkmcnt(6)
v_mfma_f32_16x16x32_bf16 v[80:83], v[48:51], v[56:59], v[80:83]
ds_read_b64_tr_b16 v[20:21], v7 offset:0
v_mfma_f32_16x16x32_bf16 v[84:87], v[48:51], v[60:63], v[84:87]
ds_read_b64_tr_b16 v[22:23], v7 offset:4096
s_add_u32 m0, s43, 0
s_add_u32 s30, s41, 20480
buffer_load_dwordx4 v5, s[4:7], s30 offen sc1 lds
buffer_load_dwordx4 v5, s[4:7], s30 offen offset:1024 sc1 lds
s_waitcnt lgkmcnt(6)
v_mfma_f32_16x16x32_bf16 v[88:91], v[52:55], v[56:59], v[88:91]
ds_read_b64_tr_b16 v[24:25], v8 offset:0
ds_read_b64_tr_b16 v[26:27], v8 offset:4096
v_mfma_f32_16x16x32_bf16 v[92:95], v[52:55], v[60:63], v[92:95]
ds_read_b64_tr_b16 v[28:29], v9 offset:0
ds_read_b64_tr_b16 v[30:31], v9 offset:4096
s_waitcnt lgkmcnt(6)
v_mfma_f32_16x16x32_bf16 v[64:67], v[16:19], v[32:35], v[64:67]
ds_read_b128 v[56:59], v10 offset:1024
v_mfma_f32_16x16x32_bf16 v[68:71], v[16:19], v[36:39], v[68:71]
ds_read_b128 v[60:63], v10 offset:3072
s_waitcnt lgkmcnt(6)
v_mfma_f32_16x16x32_bf16 v[72:75], v[20:23], v[32:35], v[72:75]
ds_read_b64_tr_b16 v[40:41], v6 offset:8192
v_mfma_f32_16x16x32_bf16 v[76:79], v[20:23], v[36:39], v[76:79]
ds_read_b64_tr_b16 v[42:43], v6 offset:12288
s_waitcnt lgkmcnt(6)
v_mfma_f32_16x16x32_bf16 v[80:83], v[24:27], v[32:35], v[80:83]
ds_read_b64_tr_b16 v[44:45], v7 offset:8192
v_mfma_f32_16x16x32_bf16 v[84:87], v[24:27], v[36:39], v[84:87]
ds_read_b64_tr_b16 v[46:47], v7 offset:12288
s_waitcnt lgkmcnt(6)
v_mfma_f32_16x16x32_bf16 v[88:91], v[28:31], v[32:35], v[88:91]
ds_read_b64_tr_b16 v[48:49], v8 offset:8192
ds_read_b64_tr_b16 v[50:51], v8 offset:12288
v_mfma_f32_16x16x32_bf16 v[92:95], v[28:31], v[36:39], v[92:95]
ds_read_b64_tr_b16 v[52:53], v9 offset:8192
ds_read_b64_tr_b16 v[54:55], v9 offset:12288
s_waitcnt vmcnt(8)
s_barrier
v_add_u32 v6, 0x8000, v6
v_add_u32 v7, 0x8000, v7
v_add_u32 v8, 0x8000, v8
v_add_u32 v9, 0x8000, v9
v_add_u32 v10, 0x8000, v10
s_waitcnt lgkmcnt(6)
v_mfma_f32_16x16x32_bf16 v[64:67], v[40:43], v[56:59], v[64:67]
ds_read_b128 v[32:35], v10 offset:0
v_mfma_f32_16x16x32_bf16 v[68:71], v[40:43], v[60:63], v[68:71]
ds_read_b128 v[36:39], v10 offset:2048
s_waitcnt lgkmcnt(6)
v_mfma_f32_16x16x32_bf16 v[72:75], v[44:47], v[56:59], v[72:75]
ds_read_b64_tr_b16 v[16:17], v6 offset:0
v_mfma_f32_16x16x32_bf16 v[76:79], v[44:47], v[60:63], v[76:79]
ds_read_b64_tr_b16 v[18:19], v6 offset:4096
s_add_u32 m0, s43, 49152
s_add_u32 s30, s42, 720896
buffer_load_dwordx4 v3, s[12:15], s30 offen lds
buffer_load_dwordx4 v4, s[12:15], s30 offen offset:1024 lds
s_waitcnt lgkmcnt(6)
v_mfma_f32_16x16x32_bf16 v[80:83], v[48:51], v[56:59], v[80:83]
ds_read_b64_tr_b16 v[20:21], v7 offset:0
v_mfma_f32_16x16x32_bf16 v[84:87], v[48:51], v[60:63], v[84:87]
ds_read_b64_tr_b16 v[22:23], v7 offset:4096
s_add_u32 m0, s43, 32768
s_add_u32 s30, s41, 22528
buffer_load_dwordx4 v5, s[4:7], s30 offen sc1 lds
buffer_load_dwordx4 v5, s[4:7], s30 offen offset:1024 sc1 lds
s_waitcnt lgkmcnt(6)
v_mfma_f32_16x16x32_bf16 v[88:91], v[52:55], v[56:59], v[88:91]
ds_read_b64_tr_b16 v[24:25], v8 offset:0
ds_read_b64_tr_b16 v[26:27], v8 offset:4096
v_mfma_f32_16x16x32_bf16 v[92:95], v[52:55], v[60:63], v[92:95]
ds_read_b64_tr_b16 v[28:29], v9 offset:0
ds_read_b64_tr_b16 v[30:31], v9 offset:4096
s_waitcnt lgkmcnt(6)
v_mfma_f32_16x16x32_bf16 v[64:67], v[16:19], v[32:35], v[64:67]
ds_read_b128 v[56:59], v10 offset:1024
v_mfma_f32_16x16x32_bf16 v[68:71], v[16:19], v[36:39], v[68:71]
ds_read_b128 v[60:63], v10 offset:3072
s_waitcnt lgkmcnt(6)
v_mfma_f32_16x16x32_bf16 v[72:75], v[20:23], v[32:35], v[72:75]
ds_read_b64_tr_b16 v[40:41], v6 offset:8192
v_mfma_f32_16x16x32_bf16 v[76:79], v[20:23], v[36:39], v[76:79]
ds_read_b64_tr_b16 v[42:43], v6 offset:12288
s_waitcnt lgkmcnt(6)
v_mfma_f32_16x16x32_bf16 v[80:83], v[24:27], v[32:35], v[80:83]
ds_read_b64_tr_b16 v[44:45], v7 offset:8192
v_mfma_f32_16x16x32_bf16 v[84:87], v[24:27], v[36:39], v[84:87]
ds_read_b64_tr_b16 v[46:47], v7 offset:12288
s_waitcnt lgkmcnt(6)
v_mfma_f32_16x16x32_bf16 v[88:91], v[28:31], v[32:35], v[88:91]
ds_read_b64_tr_b16 v[48:49], v8 offset:8192
ds_read_b64_tr_b16 v[50:51], v8 offset:12288
v_mfma_f32_16x16x32_bf16 v[92:95], v[28:31], v[36:39], v[92:95]
ds_read_b64_tr_b16 v[52:53], v9 offset:8192
ds_read_b64_tr_b16 v[54:55], v9 offset:12288
s_waitcnt vmcnt(8)
s_barrier
v_add_u32 v6, 0x8000, v6
v_add_u32 v7, 0x8000, v7
v_add_u32 v8, 0x8000, v8
v_add_u32 v9, 0x8000, v9
v_add_u32 v10, 0x8000, v10
s_waitcnt lgkmcnt(6)
v_mfma_f32_16x16x32_bf16 v[64:67], v[40:43], v[56:59], v[64:67]
ds_read_b128 v[32:35], v10 offset:0
v_mfma_f32_16x16x32_bf16 v[68:71], v[40:43], v[60:63], v[68:71]
ds_read_b128 v[36:39], v10 offset:2048
s_waitcnt lgkmcnt(6)
v_mfma_f32_16x16x32_bf16 v[72:75], v[44:47], v[56:59], v[72:75]
ds_read_b64_tr_b16 v[16:17], v6 offset:0
v_mfma_f32_16x16x32_bf16 v[76:79], v[44:47], v[60:63], v[76:79]
ds_read_b64_tr_b16 v[18:19], v6 offset:4096
s_add_u32 m0, s43, 81920
s_add_u32 s30, s42, 786432
buffer_load_dwordx4 v3, s[12:15], s30 offen lds
buffer_load_dwordx4 v4, s[12:15], s30 offen offset:1024 lds
s_waitcnt lgkmcnt(6)
v_mfma_f32_16x16x32_bf16 v[80:83], v[48:51], v[56:59], v[80:83]
ds_read_b64_tr_b16 v[20:21], v7 offset:0
v_mfma_f32_16x16x32_bf16 v[84:87], v[48:51], v[60:63], v[84:87]
ds_read_b64_tr_b16 v[22:23], v7 offset:4096
s_add_u32 m0, s43, 65536
s_add_u32 s30, s41, 24576
buffer_load_dwordx4 v5, s[4:7], s30 offen sc1 lds
buffer_load_dwordx4 v5, s[4:7], s30 offen offset:1024 sc1 lds
s_waitcnt lgkmcnt(6)
v_mfma_f32_16x16x32_bf16 v[88:91], v[52:55], v[56:59], v[88:91]
ds_read_b64_tr_b16 v[24:25], v8 offset:0
ds_read_b64_tr_b16 v[26:27], v8 offset:4096
v_mfma_f32_16x16x32_bf16 v[92:95], v[52:55], v[60:63], v[92:95]
ds_read_b64_tr_b16 v[28:29], v9 offset:0
ds_read_b64_tr_b16 v[30:31], v9 offset:4096
s_waitcnt lgkmcnt(6)
v_mfma_f32_16x16x32_bf16 v[64:67], v[16:19], v[32:35], v[64:67]
ds_read_b128 v[56:59], v10 offset:1024
v_mfma_f32_16x16x32_bf16 v[68:71], v[16:19], v[36:39], v[68:71]
ds_read_b128 v[60:63], v10 offset:3072
s_waitcnt lgkmcnt(6)
v_mfma_f32_16x16x32_bf16 v[72:75], v[20:23], v[32:35], v[72:75]
ds_read_b64_tr_b16 v[40:41], v6 offset:8192
v_mfma_f32_16x16x32_bf16 v[76:79], v[20:23], v[36:39], v[76:79]
ds_read_b64_tr_b16 v[42:43], v6 offset:12288
s_waitcnt lgkmcnt(6)
v_mfma_f32_16x16x32_bf16 v[80:83], v[24:27], v[32:35], v[80:83]
ds_read_b64_tr_b16 v[44:45], v7 offset:8192
v_mfma_f32_16x16x32_bf16 v[84:87], v[24:27], v[36:39], v[84:87]
ds_read_b64_tr_b16 v[46:47], v7 offset:12288
s_waitcnt lgkmcnt(6)
v_mfma_f32_16x16x32_bf16 v[88:91], v[28:31], v[32:35], v[88:91]
ds_read_b64_tr_b16 v[48:49], v8 offset:8192
ds_read_b64_tr_b16 v[50:51], v8 offset:12288
v_mfma_f32_16x16x32_bf16 v[92:95], v[28:31], v[36:39], v[92:95]
ds_read_b64_tr_b16 v[52:53], v9 offset:8192
ds_read_b64_tr_b16 v[54:55], v9 offset:12288
s_waitcnt vmcnt(8)
s_barrier
v_add_u32 v6, 0xfffe0000, v6
v_add_u32 v7, 0xfffe0000, v7
v_add_u32 v8, 0xfffe0000, v8
v_add_u32 v9, 0xfffe0000, v9
v_add_u32 v10, 0xfffe0000, v10
s_waitcnt lgkmcnt(6)
v_mfma_f32_16x16x32_bf16 v[64:67], v[40:43], v[56:59], v[64:67]
ds_read_b128 v[32:35], v10 offset:0
v_mfma_f32_16x16x32_bf16 v[68:71], v[40:43], v[60:63], v[68:71]
ds_read_b128 v[36:39], v10 offset:2048
s_waitcnt lgkmcnt(6)
v_mfma_f32_16x16x32_bf16 v[72:75], v[44:47], v[56:59], v[72:75]
ds_read_b64_tr_b16 v[16:17], v6 offset:0
v_mfma_f32_16x16x32_bf16 v[76:79], v[44:47], v[60:63], v[76:79]
ds_read_b64_tr_b16 v[18:19], v6 offset:4096
s_add_u32 m0, s43, 114688
s_add_u32 s30, s42, 851968
buffer_load_dwordx4 v3, s[12:15], s30 offen lds
buffer_load_dwordx4 v4, s[12:15], s30 offen offset:1024 lds
s_waitcnt lgkmcnt(6)
v_mfma_f32_16x16x32_bf16 v[80:83], v[48:51], v[56:59], v[80:83]
ds_read_b64_tr_b16 v[20:21], v7 offset:0
v_mfma_f32_16x16x32_bf16 v[84:87], v[48:51], v[60:63], v[84:87]
ds_read_b64_tr_b16 v[22:23], v7 offset:4096
s_add_u32 m0, s43, 98304
s_add_u32 s30, s41, 26624
buffer_load_dwordx4 v5, s[4:7], s30 offen sc1 lds
buffer_load_dwordx4 v5, s[4:7], s30 offen offset:1024 sc1 lds
s_waitcnt lgkmcnt(6)
v_mfma_f32_16x16x32_bf16 v[88:91], v[52:55], v[56:59], v[88:91]
ds_read_b64_tr_b16 v[24:25], v8 offset:0
ds_read_b64_tr_b16 v[26:27], v8 offset:4096
v_mfma_f32_16x16x32_bf16 v[92:95], v[52:55], v[60:63], v[92:95]
ds_read_b64_tr_b16 v[28:29], v9 offset:0
ds_read_b64_tr_b16 v[30:31], v9 offset:4096
s_waitcnt lgkmcnt(6)
v_mfma_f32_16x16x32_bf16 v[64:67], v[16:19], v[32:35], v[64:67]
ds_read_b128 v[56:59], v10 offset:1024
v_mfma_f32_16x16x32_bf16 v[68:71], v[16:19], v[36:39], v[68:71]
ds_read_b128 v[60:63], v10 offset:3072
s_waitcnt lgkmcnt(6)
v_mfma_f32_16x16x32_bf16 v[72:75], v[20:23], v[32:35], v[72:75]
ds_read_b64_tr_b16 v[40:41], v6 offset:8192
v_mfma_f32_16x16x32_bf16 v[76:79], v[20:23], v[36:39], v[76:79]
ds_read_b64_tr_b16 v[42:43], v6 offset:12288
s_waitcnt lgkmcnt(6)
v_mfma_f32_16x16x32_bf16 v[80:83], v[24:27], v[32:35], v[80:83]
ds_read_b64_tr_b16 v[44:45], v7 offset:8192
v_mfma_f32_16x16x32_bf16 v[84:87], v[24:27], v[36:39], v[84:87]
ds_read_b64_tr_b16 v[46:47], v7 offset:12288
s_waitcnt lgkmcnt(6)
v_mfma_f32_16x16x32_bf16 v[88:91], v[28:31], v[32:35], v[88:91]
ds_read_b64_tr_b16 v[48:49], v8 offset:8192
ds_read_b64_tr_b16 v[50:51], v8 offset:12288
v_mfma_f32_16x16x32_bf16 v[92:95], v[28:31], v[36:39], v[92:95]
ds_read_b64_tr_b16 v[52:53], v9 offset:8192
ds_read_b64_tr_b16 v[54:55], v9 offset:12288
s_waitcnt vmcnt(8)
s_barrier
v_add_u32 v6, 0x8000, v6
v_add_u32 v7, 0x8000, v7
v_add_u32 v8, 0x8000, v8
v_add_u32 v9, 0x8000, v9
v_add_u32 v10, 0x8000, v10
s_waitcnt lgkmcnt(6)
v_mfma_f32_16x16x32_bf16 v[64:67], v[40:43], v[56:59], v[64:67]
ds_read_b128 v[32:35], v10 offset:0
v_mfma_f32_16x16x32_bf16 v[68:71], v[40:43], v[60:63], v[68:71]
ds_read_b128 v[36:39], v10 offset:2048
s_waitcnt lgkmcnt(6)
v_mfma_f32_16x16x32_bf16 v[72:75], v[44:47], v[56:59], v[72:75]
ds_read_b64_tr_b16 v[16:17], v6 offset:0
v_mfma_f32_16x16x32_bf16 v[76:79], v[44:47], v[60:63], v[76:79]
ds_read_b64_tr_b16 v[18:19], v6 offset:4096
s_add_u32 m0, s43, 147456
s_add_u32 s30, s42, 917504
buffer_load_dwordx4 v3, s[12:15], s30 offen lds
buffer_load_dwordx4 v4, s[12:15], s30 offen offset:1024 lds
s_waitcnt lgkmcnt(6)
v_mfma_f32_16x16x32_bf16 v[80:83], v[48:51], v[56:59], v[80:83]
ds_read_b64_tr_b16 v[20:21], v7 offset:0
v_mfma_f32_16x16x32_bf16 v[84:87], v[48:51], v[60:63], v[84:87]
ds_read_b64_tr_b16 v[22:23], v7 offset:4096
s_add_u32 m0, s43, 131072
s_add_u32 s30, s41, 28672
buffer_load_dwordx4 v5, s[4:7], s30 offen sc1 lds
buffer_load_dwordx4 v5, s[4:7], s30 offen offset:1024 sc1 lds
s_waitcnt lgkmcnt(6)
v_mfma_f32_16x16x32_bf16 v[88:91], v[52:55], v[56:59], v[88:91]
ds_read_b64_tr_b16 v[24:25], v8 offset:0
ds_read_b64_tr_b16 v[26:27], v8 offset:4096
v_mfma_f32_16x16x32_bf16 v[92:95], v[52:55], v[60:63], v[92:95]
ds_read_b64_tr_b16 v[28:29], v9 offset:0
ds_read_b64_tr_b16 v[30:31], v9 offset:4096
s_waitcnt lgkmcnt(6)
v_mfma_f32_16x16x32_bf16 v[64:67], v[16:19], v[32:35], v[64:67]
ds_read_b128 v[56:59], v10 offset:1024
v_mfma_f32_16x16x32_bf16 v[68:71], v[16:19], v[36:39], v[68:71]
ds_read_b128 v[60:63], v10 offset:3072
s_waitcnt lgkmcnt(6)
v_mfma_f32_16x16x32_bf16 v[72:75], v[20:23], v[32:35], v[72:75]
ds_read_b64_tr_b16 v[40:41], v6 offset:8192
v_mfma_f32_16x16x32_bf16 v[76:79], v[20:23], v[36:39], v[76:79]
ds_read_b64_tr_b16 v[42:43], v6 offset:12288
s_waitcnt lgkmcnt(6)
v_mfma_f32_16x16x32_bf16 v[80:83], v[24:27], v[32:35], v[80:83]
ds_read_b64_tr_b16 v[44:45], v7 offset:8192
v_mfma_f32_16x16x32_bf16 v[84:87], v[24:27], v[36:39], v[84:87]
ds_read_b64_tr_b16 v[46:47], v7 offset:12288
s_waitcnt lgkmcnt(6)
v_mfma_f32_16x16x32_bf16 v[88:91], v[28:31], v[32:35], v[88:91]
ds_read_b64_tr_b16 v[48:49], v8 offset:8192
ds_read_b64_tr_b16 v[50:51], v8 offset:12288
v_mfma_f32_16x16x32_bf16 v[92:95], v[28:31], v[36:39], v[92:95]
ds_read_b64_tr_b16 v[52:53], v9 offset:8192
ds_read_b64_tr_b16 v[54:55], v9 offset:12288
s_waitcnt vmcnt(8)
s_barrier
v_add_u32 v6, 0x8000, v6
v_add_u32 v7, 0x8000, v7
v_add_u32 v8, 0x8000, v8
v_add_u32 v9, 0x8000, v9
v_add_u32 v10, 0x8000, v10
s_waitcnt lgkmcnt(6)
v_mfma_f32_16x16x32_bf16 v[64:67], v[40:43], v[56:59], v[64:67]
ds_read_b128 v[32:35], v10 offset:0
v_mfma_f32_16x16x32_bf16 v[68:71], v[40:43], v[60:63], v[68:71]
ds_read_b128 v[36:39], v10 offset:2048
s_waitcnt lgkmcnt(6)
v_mfma_f32_16x16x32_bf16 v[72:75], v[44:47], v[56:59], v[72:75]
ds_read_b64_tr_b16 v[16:17], v6 offset:0
v_mfma_f32_16x16x32_bf16 v[76:79], v[44:47], v[60:63], v[76:79]
ds_read_b64_tr_b16 v[18:19], v6 offset:4096
s_add_u32 m0, s43, 16384
s_add_u32 s30, s42, 983040
buffer_load_dwordx4 v3, s[12:15], s30 offen lds
buffer_load_dwordx4 v4, s[12:15], s30 offen offset:1024 lds
s_waitcnt lgkmcnt(6)
v_mfma_f32_16x16x32_bf16 v[80:83], v[48:51], v[56:59], v[80:83]
ds_read_b64_tr_b16 v[20:21], v7 offset:0
v_mfma_f32_16x16x32_bf16 v[84:87], v[48:51], v[60:63], v[84:87]
ds_read_b64_tr_b16 v[22:23], v7 offset:4096
s_add_u32 m0, s43, 0
s_add_u32 s30, s41, 30720
buffer_load_dwordx4 v5, s[4:7], s30 offen sc1 lds
buffer_load_dwordx4 v5, s[4:7], s30 offen offset:1024 sc1 lds
s_waitcnt lgkmcnt(6)
v_mfma_f32_16x16x32_bf16 v[88:91], v[52:55], v[56:59], v[88:91]
ds_read_b64_tr_b16 v[24:25], v8 offset:0
ds_read_b64_tr_b16 v[26:27], v8 offset:4096
v_mfma_f32_16x16x32_bf16 v[92:95], v[52:55], v[60:63], v[92:95]
ds_read_b64_tr_b16 v[28:29], v9 offset:0
ds_read_b64_tr_b16 v[30:31], v9 offset:4096
s_waitcnt lgkmcnt(6)
v_mfma_f32_16x16x32_bf16 v[64:67], v[16:19], v[32:35], v[64:67]
ds_read_b128 v[56:59], v10 offset:1024
v_mfma_f32_16x16x32_bf16 v[68:71], v[16:19], v[36:39], v[68:71]
ds_read_b128 v[60:63], v10 offset:3072
s_waitcnt lgkmcnt(6)
v_mfma_f32_16x16x32_bf16 v[72:75], v[20:23], v[32:35], v[72:75]
ds_read_b64_tr_b16 v[40:41], v6 offset:8192
v_mfma_f32_16x16x32_bf16 v[76:79], v[20:23], v[36:39], v[76:79]
ds_read_b64_tr_b16 v[42:43], v6 offset:12288
s_waitcnt lgkmcnt(6)
v_mfma_f32_16x16x32_bf16 v[80:83], v[24:27], v[32:35], v[80:83]
ds_read_b64_tr_b16 v[44:45], v7 offset:8192
v_mfma_f32_16x16x32_bf16 v[84:87], v[24:27], v[36:39], v[84:87]
ds_read_b64_tr_b16 v[46:47], v7 offset:12288
s_waitcnt lgkmcnt(6)
v_mfma_f32_16x16x32_bf16 v[88:91], v[28:31], v[32:35], v[88:91]
ds_read_b64_tr_b16 v[48:49], v8 offset:8192
ds_read_b64_tr_b16 v[50:51], v8 offset:12288
v_mfma_f32_16x16x32_bf16 v[92:95], v[28:31], v[36:39], v[92:95]
ds_read_b64_tr_b16 v[52:53], v9 offset:8192
ds_read_b64_tr_b16 v[54:55], v9 offset:12288
s_waitcnt vmcnt(8)
s_barrier
v_add_u32 v6, 0x8000, v6
v_add_u32 v7, 0x8000, v7
v_add_u32 v8, 0x8000, v8
v_add_u32 v9, 0x8000, v9
v_add_u32 v10, 0x8000, v10
s_waitcnt lgkmcnt(6)
v_mfma_f32_16x16x32_bf16 v[64:67], v[40:43], v[56:59], v[64:67]
ds_read_b128 v[32:35], v10 offset:0
v_mfma_f32_16x16x32_bf16 v[68:71], v[40:43], v[60:63], v[68:71]
ds_read_b128 v[36:39], v10 offset:2048
s_waitcnt lgkmcnt(6)
v_mfma_f32_16x16x32_bf16 v[72:75], v[44:47], v[56:59], v[72:75]
ds_read_b64_tr_b16 v[16:17], v6 offset:0
v_mfma_f32_16x16x32_bf16 v[76:79], v[44:47], v[60:63], v[76:79]
ds_read_b64_tr_b16 v[18:19], v6 offset:4096
s_waitcnt lgkmcnt(6)
v_mfma_f32_16x16x32_bf16 v[80:83], v[48:51], v[56:59], v[80:83]
ds_read_b64_tr_b16 v[20:21], v7 offset:0
v_mfma_f32_16x16x32_bf16 v[84:87], v[48:51], v[60:63], v[84:87]
ds_read_b64_tr_b16 v[22:23], v7 offset:4096
s_waitcnt lgkmcnt(6)
v_mfma_f32_16x16x32_bf16 v[88:91], v[52:55], v[56:59], v[88:91]
ds_read_b64_tr_b16 v[24:25], v8 offset:0
ds_read_b64_tr_b16 v[26:27], v8 offset:4096
v_mfma_f32_16x16x32_bf16 v[92:95], v[52:55], v[60:63], v[92:95]
ds_read_b64_tr_b16 v[28:29], v9 offset:0
ds_read_b64_tr_b16 v[30:31], v9 offset:4096
s_waitcnt lgkmcnt(6)
v_mfma_f32_16x16x32_bf16 v[64:67], v[16:19], v[32:35], v[64:67]
ds_read_b128 v[56:59], v10 offset:1024
v_mfma_f32_16x16x32_bf16 v[68:71], v[16:19], v[36:39], v[68:71]
ds_read_b128 v[60:63], v10 offset:3072
s_waitcnt lgkmcnt(6)
v_mfma_f32_16x16x32_bf16 v[72:75], v[20:23], v[32:35], v[72:75]
ds_read_b64_tr_b16 v[40:41], v6 offset:8192
v_mfma_f32_16x16x32_bf16 v[76:79], v[20:23], v[36:39], v[76:79]
ds_read_b64_tr_b16 v[42:43], v6 offset:12288
s_waitcnt lgkmcnt(6)
v_mfma_f32_16x16x32_bf16 v[80:83], v[24:27], v[32:35], v[80:83]
ds_read_b64_tr_b16 v[44:45], v7 offset:8192
v_mfma_f32_16x16x32_bf16 v[84:87], v[24:27], v[36:39], v[84:87]
ds_read_b64_tr_b16 v[46:47], v7 offset:12288
s_waitcnt lgkmcnt(6)
v_mfma_f32_16x16x32_bf16 v[88:91], v[28:31], v[32:35], v[88:91]
ds_read_b64_tr_b16 v[48:49], v8 offset:8192
ds_read_b64_tr_b16 v[50:51], v8 offset:12288
v_mfma_f32_16x16x32_bf16 v[92:95], v[28:31], v[36:39], v[92:95]
ds_read_b64_tr_b16 v[52:53], v9 offset:8192
ds_read_b64_tr_b16 v[54:55], v9 offset:12288
s_waitcnt vmcnt(4)
s_barrier
v_add_u32 v6, 0x8000, v6
v_add_u32 v7, 0x8000, v7
v_add_u32 v8, 0x8000, v8
v_add_u32 v9, 0x8000, v9
v_add_u32 v10, 0x8000, v10
s_waitcnt lgkmcnt(6)
v_mfma_f32_16x16x32_bf16 v[64:67], v[40:43], v[56:59], v[64:67]
ds_read_b128 v[32:35], v10 offset:0
v_mfma_f32_16x16x32_bf16 v[68:71], v[40:43], v[60:63], v[68:71]
ds_read_b128 v[36:39], v10 offset:2048
s_waitcnt lgkmcnt(6)
v_mfma_f32_16x16x32_bf16 v[72:75], v[44:47], v[56:59], v[72:75]
ds_read_b64_tr_b16 v[16:17], v6 offset:0
v_mfma_f32_16x16x32_bf16 v[76:79], v[44:47], v[60:63], v[76:79]
ds_read_b64_tr_b16 v[18:19], v6 offset:4096
s_waitcnt lgkmcnt(6)
v_mfma_f32_16x16x32_bf16 v[80:83], v[48:51], v[56:59], v[80:83]
ds_read_b64_tr_b16 v[20:21], v7 offset:0
v_mfma_f32_16x16x32_bf16 v[84:87], v[48:51], v[60:63], v[84:87]
ds_read_b64_tr_b16 v[22:23], v7 offset:4096
s_waitcnt lgkmcnt(6)
v_mfma_f32_16x16x32_bf16 v[88:91], v[52:55], v[56:59], v[88:91]
ds_read_b64_tr_b16 v[24:25], v8 offset:0
ds_read_b64_tr_b16 v[26:27], v8 offset:4096
v_mfma_f32_16x16x32_bf16 v[92:95], v[52:55], v[60:63], v[92:95]
ds_read_b64_tr_b16 v[28:29], v9 offset:0
ds_read_b64_tr_b16 v[30:31], v9 offset:4096
s_waitcnt lgkmcnt(6)
v_mfma_f32_16x16x32_bf16 v[64:67], v[16:19], v[32:35], v[64:67]
ds_read_b128 v[56:59], v10 offset:1024
v_mfma_f32_16x16x32_bf16 v[68:71], v[16:19], v[36:39], v[68:71]
ds_read_b128 v[60:63], v10 offset:3072
s_waitcnt lgkmcnt(6)
v_mfma_f32_16x16x32_bf16 v[72:75], v[20:23], v[32:35], v[72:75]
ds_read_b64_tr_b16 v[40:41], v6 offset:8192
v_mfma_f32_16x16x32_bf16 v[76:79], v[20:23], v[36:39], v[76:79]
ds_read_b64_tr_b16 v[42:43], v6 offset:12288
s_waitcnt lgkmcnt(6)
v_mfma_f32_16x16x32_bf16 v[80:83], v[24:27], v[32:35], v[80:83]
ds_read_b64_tr_b16 v[44:45], v7 offset:8192
v_mfma_f32_16x16x32_bf16 v[84:87], v[24:27], v[36:39], v[84:87]
ds_read_b64_tr_b16 v[46:47], v7 offset:12288
s_waitcnt lgkmcnt(6)
v_mfma_f32_16x16x32_bf16 v[88:91], v[28:31], v[32:35], v[88:91]
ds_read_b64_tr_b16 v[48:49], v8 offset:8192
ds_read_b64_tr_b16 v[50:51], v8 offset:12288
v_mfma_f32_16x16x32_bf16 v[92:95], v[28:31], v[36:39], v[92:95]
ds_read_b64_tr_b16 v[52:53], v9 offset:8192
ds_read_b64_tr_b16 v[54:55], v9 offset:12288
s_waitcnt vmcnt(0)
s_barrier
v_add_u32 v6, 0xfffe0000, v6
v_add_u32 v7, 0xfffe0000, v7
v_add_u32 v8, 0xfffe0000, v8
v_add_u32 v9, 0xfffe0000, v9
v_add_u32 v10, 0xfffe0000, v10
s_waitcnt lgkmcnt(6)
v_mfma_f32_16x16x32_bf16 v[64:67], v[40:43], v[56:59], v[64:67]
ds_read_b128 v[32:35], v10 offset:0
v_mfma_f32_16x16x32_bf16 v[68:71], v[40:43], v[60:63], v[68:71]
ds_read_b128 v[36:39], v10 offset:2048
s_waitcnt lgkmcnt(6)
v_mfma_f32_16x16x32_bf16 v[72:75], v[44:47], v[56:59], v[72:75]
ds_read_b64_tr_b16 v[16:17], v6 offset:0
v_mfma_f32_16x16x32_bf16 v[76:79], v[44:47], v[60:63], v[76:79]
ds_read_b64_tr_b16 v[18:19], v6 offset:4096
s_waitcnt lgkmcnt(6)
v_mfma_f32_16x16x32_bf16 v[80:83], v[48:51], v[56:59], v[80:83]
ds_read_b64_tr_b16 v[20:21], v7 offset:0
v_mfma_f32_16x16x32_bf16 v[84:87], v[48:51], v[60:63], v[84:87]
ds_read_b64_tr_b16 v[22:23], v7 offset:4096
s_waitcnt lgkmcnt(6)
v_mfma_f32_16x16x32_bf16 v[88:91], v[52:55], v[56:59], v[88:91]
ds_read_b64_tr_b16 v[24:25], v8 offset:0
ds_read_b64_tr_b16 v[26:27], v8 offset:4096
v_mfma_f32_16x16x32_bf16 v[92:95], v[52:55], v[60:63], v[92:95]
ds_read_b64_tr_b16 v[28:29], v9 offset:0
ds_read_b64_tr_b16 v[30:31], v9 offset:4096
s_waitcnt lgkmcnt(6)
v_mfma_f32_16x16x32_bf16 v[64:67], v[16:19], v[32:35], v[64:67]
ds_read_b128 v[56:59], v10 offset:1024
v_mfma_f32_16x16x32_bf16 v[68:71], v[16:19], v[36:39], v[68:71]
ds_read_b128 v[60:63], v10 offset:3072
s_waitcnt lgkmcnt(6)
v_mfma_f32_16x16x32_bf16 v[72:75], v[20:23], v[32:35], v[72:75]
ds_read_b64_tr_b16 v[40:41], v6 offset:8192
v_mfma_f32_16x16x32_bf16 v[76:79], v[20:23], v[36:39], v[76:79]
ds_read_b64_tr_b16 v[42:43], v6 offset:12288
s_waitcnt lgkmcnt(6)
v_mfma_f32_16x16x32_bf16 v[80:83], v[24:27], v[32:35], v[80:83]
ds_read_b64_tr_b16 v[44:45], v7 offset:8192
v_mfma_f32_16x16x32_bf16 v[84:87], v[24:27], v[36:39], v[84:87]
ds_read_b64_tr_b16 v[46:47], v7 offset:12288
s_waitcnt lgkmcnt(6)
v_mfma_f32_16x16x32_bf16 v[88:91], v[28:31], v[32:35], v[88:91]
ds_read_b64_tr_b16 v[48:49], v8 offset:8192
ds_read_b64_tr_b16 v[50:51], v8 offset:12288
v_mfma_f32_16x16x32_bf16 v[92:95], v[28:31], v[36:39], v[92:95]
ds_read_b64_tr_b16 v[52:53], v9 offset:8192
ds_read_b64_tr_b16 v[54:55], v9 offset:12288
s_waitcnt lgkmcnt(6)
v_mfma_f32_16x16x32_bf16 v[64:67], v[40:43], v[56:59], v[64:67]
v_mfma_f32_16x16x32_bf16 v[68:71], v[40:43], v[60:63], v[68:71]
s_waitcnt lgkmcnt(4)
v_mfma_f32_16x16x32_bf16 v[72:75], v[44:47], v[56:59], v[72:75]
v_mfma_f32_16x16x32_bf16 v[76:79], v[44:47], v[60:63], v[76:79]
s_waitcnt lgkmcnt(2)
v_mfma_f32_16x16x32_bf16 v[80:83], v[48:51], v[56:59], v[80:83]
v_mfma_f32_16x16x32_bf16 v[84:87], v[48:51], v[60:63], v[84:87]
s_waitcnt lgkmcnt(0)
v_mfma_f32_16x16x32_bf16 v[88:91], v[52:55], v[56:59], v[88:91]
v_mfma_f32_16x16x32_bf16 v[92:95], v[52:55], v[60:63], v[92:95]
s_nop 7
s_lshl_b32 s30, s36, 7
s_lshl_b32 s31, s37, 3
s_add_u32 s30, s30, s31
s_lshl_b32 s31, s39, 1
s_add_u32 s30, s30, s31
s_lshl_b32 s30, s30, 4
s_lshl_b32 s31, s38, 2
s_add_u32 s30, s30, s31
s_lshl_b32 s31, s40, 1
s_add_u32 s30, s30, s31
s_lshl_b32 s30, s30, 10
s_add_u32 s30, s30, 0x1200000
v_cvt_pk_bf16_f32 v16, v64, v65
v_cvt_pk_bf16_f32 v17, v66, v67
v_cvt_pk_bf16_f32 v18, v72, v73
v_cvt_pk_bf16_f32 v19, v74, v75
buffer_store_dwordx4 v[16:19], v5, s[4:7], s30 offen offset:0 sc1
v_cvt_pk_bf16_f32 v20, v80, v81
v_cvt_pk_bf16_f32 v21, v82, v83
v_cvt_pk_bf16_f32 v22, v88, v89
v_cvt_pk_bf16_f32 v23, v90, v91
buffer_store_dwordx4 v[20:23], v5, s[4:7], s30 offen offset:1024 sc1
s_add_u32 s30, s30, 16384
v_cvt_pk_bf16_f32 v24, v68, v69
v_cvt_pk_bf16_f32 v25, v70, v71
v_cvt_pk_bf16_f32 v26, v76, v77
v_cvt_pk_bf16_f32 v27, v78, v79
buffer_store_dwordx4 v[24:27], v5, s[4:7], s30 offen offset:0 sc1
v_cvt_pk_bf16_f32 v28, v84, v85
v_cvt_pk_bf16_f32 v29, v86, v87
v_cvt_pk_bf16_f32 v30, v92, v93
v_cvt_pk_bf16_f32 v31, v94, v95
buffer_store_dwordx4 v[28:31], v5, s[4:7], s30 offen offset:1024 sc1
s_waitcnt vmcnt(0)
s_barrier
s_lshl_b32 s30, s37, 7
s_add_u32 s30, s30, 0x22000
s_cmp_eq_u32 s20, 0
s_cselect_b32 s31, s30, s86
v_mov_b32 v1, 1
s_mov_b64 exec, 1
buffer_atomic_add v1, off, s[4:7], s31 sc1
s_mov_b64 exec, -1
s_lshl_b32 s31, s37, 7
s_add_u32 s31, s31, 0x22000
s_mov_b32 s41, s31
s_cmp_lg_u32 s20, 0
s_cbranch_scc1 L_sok_1048
s_mov_b32 s31, 0x40000
L_sloop_1049:
buffer_load_dword v1, off, s[4:7], s41 sc1
s_waitcnt vmcnt(0)
v_readfirstlane_b32 s30, v1
s_nop 3
s_cmp_ge_u32 s30, 16
s_cbranch_scc1 L_sok_1048
s_sleep 16
s_sub_u32 s31, s31, 1
s_cmp_lg_u32 s31, 0
s_cbranch_scc1 L_sloop_1049
L_sok_1048:
s_barrier
s_lshl_b32 s30, s35, 14
s_lshl_b32 s31, s20, 11
s_add_u32 s30, s30, s31
s_add_u32 s30, s30, 0x1200000
buffer_load_dwordx4 v[16:19], v12, s[4:7], s30 offen sc1
s_add_u32 s30, s30, 2097152
buffer_load_dwordx4 v[20:23], v12, s[4:7], s30 offen sc1
s_add_u32 s30, s30, 2097152
buffer_load_dwordx4 v[24:27], v12, s[4:7], s30 offen sc1
s_add_u32 s30, s30, 2097152
buffer_load_dwordx4 v[28:31], v12, s[4:7], s30 offen sc1
s_waitcnt vmcnt(3)
v_lshlrev_b32 v64, 16, v16
v_and_b32 v65, 0xffff0000, v16
v_lshlrev_b32 v66, 16, v17
v_and_b32 v67, 0xffff0000, v17
v_lshlrev_b32 v68, 16, v18
v_and_b32 v69, 0xffff0000, v18
v_lshlrev_b32 v70, 16, v19
v_and_b32 v71, 0xffff0000, v19
s_waitcnt vmcnt(2)
v_lshlrev_b32 v72, 16, v20
v_and_b32 v73, 0xffff0000, v20
v_add_f32 v64, v64, v72
v_add_f32 v65, v65, v73
v_lshlrev_b32 v72, 16, v21
v_and_b32 v73, 0xffff0000, v21
v_add_f32 v66, v66, v72
v_add_f32 v67, v67, v73
v_lshlrev_b32 v72, 16, v22
v_and_b32 v73, 0xffff0000, v22
v_add_f32 v68, v68, v72
v_add_f32 v69, v69, v73
v_lshlrev_b32 v72, 16, v23
v_and_b32 v73, 0xffff0000, v23
v_add_f32 v70, v70, v72
v_add_f32 v71, v71, v73
s_waitcnt vmcnt(1)
v_lshlrev_b32 v72, 16, v24
v_and_b32 v73, 0xffff0000, v24
v_add_f32 v64, v64, v72
v_add_f32 v65, v65, v73
v_lshlrev_b32 v72, 16, v25
v_and_b32 v73, 0xffff0000, v25
v_add_f32 v66, v66, v72
v_add_f32 v67, v67, v73
v_lshlrev_b32 v72, 16, v26
v_and_b32 v73, 0xffff0000, v26
v_add_f32 v68, v68, v72
v_add_f32 v69, v69, v73
v_lshlrev_b32 v72, 16, v27
v_and_b32 v73, 0xffff0000, v27
v_add_f32 v70, v70, v72
v_add_f32 v71, v71, v73
s_waitcnt vmcnt(0)
v_lshlrev_b32 v72, 16, v28
v_and_b32 v73, 0xffff0000, v28
v_add_f32 v64, v64, v72
v_add_f32 v65, v65, v73
v_lshlrev_b32 v72, 16, v29
v_and_b32 v73, 0xffff0000, v29
v_add_f32 v66, v66, v72
v_add_f32 v67, v67, v73
v_lshlrev_b32 v72, 16, v30
v_and_b32 v73, 0xffff0000, v30
v_add_f32 v68, v68, v72
v_add_f32 v69, v69, v73
v_lshlrev_b32 v72, 16, v31
v_and_b32 v73, 0xffff0000, v31
v_add_f32 v70, v70, v72
v_add_f32 v71, v71, v73
v_lshlrev_b32 v72, 16, v120
v_and_b32 v73, 0xffff0000, v120
v_lshlrev_b32 v74, 16, v121
v_and_b32 v75, 0xffff0000, v121
v_fma_f32 v64, v64, v96, v72
v_fma_f32 v65, v65, v97, v73
v_fma_f32 v66, v66, v98, v74
v_fma_f32 v67, v67, v99, v75
v_lshlrev_b32 v72, 16, v122
v_and_b32 v73, 0xffff0000, v122
v_lshlrev_b32 v74, 16, v123
v_and_b32 v75, 0xffff0000, v123
v_fma_f32 v68, v68, v100, v72
v_fma_f32 v69, v69, v101, v73
v_fma_f32 v70, v70, v102, v74
v_fma_f32 v71, v71, v103, v75
s_lshl_b32 s30, s35, 15
s_lshl_b32 s31, s20, 12
s_add_u32 s30, s30, s31
s_add_u32 s30, s30, 0x400000
buffer_store_dwordx4 v[64:67], v13, s[4:7], s30 offen sc1
buffer_store_dwordx4 v[68:71], v13, s[4:7], s30 offen offset:1024 sc1
v_add_f32 v72, v64, v65
v_add_f32 v73, v66, v67
v_add_f32 v74, v68, v69
v_add_f32 v75, v70, v71
v_add_f32 v72, v72, v73
v_add_f32 v74, v74, v75
v_add_f32 v72, v72, v74
s_nop 1
v_add_f32_dpp v72, v72, v72 row_ror:8 row_mask:0xf bank_mask:0xf
v_mov_b32 v73, v72
s_nop 1
v_permlane16_swap_b32 v72, v73
v_add_f32 v72, v72, v73
v_mov_b32 v73, v72
s_nop 1
v_permlane32_swap_b32 v72, v73
v_add_f32 v72, v72, v73
v_mul_f32 v72, 0x3c800000, v72
v_sub_f32 v74, v64, v72
v_mul_f32 v73, v74, v74
v_sub_f32 v74, v65, v72
v_fmac_f32 v73, v74, v74
v_sub_f32 v74, v66, v72
v_fmac_f32 v73, v74, v74
v_sub_f32 v74, v67, v72
v_fmac_f32 v73, v74, v74
v_sub_f32 v74, v68, v72
v_fmac_f32 v73, v74, v74
v_sub_f32 v74, v69, v72
v_fmac_f32 v73, v74, v74
v_sub_f32 v74, v70, v72
v_fmac_f32 v73, v74, v74
v_sub_f32 v74, v71, v72
v_fmac_f32 v73, v74, v74
s_nop 1
v_add_f32_dpp v73, v73, v73 row_ror:8 row_mask:0xf bank_mask:0xf
v_mov_b32 v74, v73
s_nop 1
v_permlane16_swap_b32 v73, v74
v_add_f32 v73, v73, v74
v_mov_b32 v74, v73
s_nop 1
v_permlane32_swap_b32 v73, v74
v_add_f32 v73, v73, v74
v_and_b32 v74, 7, v0
v_lshlrev_b32 v74, 6, v74
s_lshl_b32 s30, s20, 3
v_add_u32 v75, s30, v74
ds_write_b64 v75, v[72:73]
s_waitcnt lgkmcnt(0)
s_barrier
ds_read_b128 v[76:79], v74 offset:0
ds_read_b128 v[80:83], v74 offset:16
ds_read_b128 v[84:87], v74 offset:32
ds_read_b128 v[88:91], v74 offset:48
s_waitcnt lgkmcnt(0)
v_add_f32 v72, v76, v78
v_add_f32 v73, v80, v82
v_add_f32 v72, v72, v73
v_add_f32 v73, v84, v86
v_add_f32 v72, v72, v73
v_add_f32 v73, v88, v90
v_add_f32 v72, v72, v73
v_mul_f32 v72, 0x3e000000, v72
v_add_f32 v73, v77, v79
v_add_f32 v73, v73, v81
v_add_f32 v73, v73, v83
v_add_f32 v73, v73, v85
v_add_f32 v73, v73, v87
v_add_f32 v73, v73, v89
v_add_f32 v73, v73, v91
v_sub_f32 v74, v76, v72
v_mul_f32 v75, v74, v74
v_fmac_f32 v73, 0x42800000, v75
v_sub_f32 v74, v78, v72
v_mul_f32 v75, v74, v74
v_fmac_f32 v73, 0x42800000, v75
v_sub_f32 v74, v80, v72
v_mul_f32 v75, v74, v74
v_fmac_f32 v73, 0x42800000, v75
v_sub_f32 v74, v82, v72
v_mul_f32 v75, v74, v74
v_fmac_f32 v73, 0x42800000, v75
v_sub_f32 v74, v84, v72
v_mul_f32 v75, v74, v74
v_fmac_f32 v73, 0x42800000, v75
v_sub_f32 v74, v86, v72
v_mul_f32 v75, v74, v74
v_fmac_f32 v73, 0x42800000, v75
v_sub_f32 v74, v88, v72
v_mul_f32 v75, v74, v74
v_fmac_f32 v73, 0x42800000, v75
v_sub_f32 v74, v90, v72
v_mul_f32 v75, v74, v74
v_fmac_f32 v73, 0x42800000, v75
v_mov_b32 v74, 0x3727c5ac
v_fmac_f32 v74, 0x3b000000, v73
v_rsq_f32 v74, v74
s_nop 0
v_sub_f32 v64, v64, v72
v_sub_f32 v65, v65, v72
v_sub_f32 v66, v66, v72
v_sub_f32 v67, v67, v72
v_sub_f32 v68, v68, v72
v_sub_f32 v69, v69, v72
v_sub_f32 v70, v70, v72
v_sub_f32 v71, v71, v72
v_mul_f32 v64, v64, v74
v_mul_f32 v65, v65, v74
v_mul_f32 v66, v66, v74
v_mul_f32 v67, v67, v74
v_mul_f32 v68, v68, v74
v_mul_f32 v69, v69, v74
v_mul_f32 v70, v70, v74
v_mul_f32 v71, v71, v74
v_add_f32 v112, 1.0, v112
v_add_f32 v113, 1.0, v113
v_add_f32 v114, 1.0, v114
v_add_f32 v115, 1.0, v115
v_add_f32 v116, 1.0, v116
v_add_f32 v117, 1.0, v117
v_add_f32 v118, 1.0, v118
v_add_f32 v119, 1.0, v119
v_fma_f32 v64, v64, v112, v104
v_fma_f32 v65, v65, v113, v105
v_fma_f32 v66, v66, v114, v106
v_fma_f32 v67, v67, v115, v107
v_fma_f32 v68, v68, v116, v108
v_fma_f32 v69, v69, v117, v109
v_fma_f32 v70, v70, v118, v110
v_fma_f32 v71, v71, v119, v111
v_cvt_pk_bf16_f32 v72, v64, v65
v_cvt_pk_bf16_f32 v73, v66, v67
v_cvt_pk_bf16_f32 v74, v68, v69
v_cvt_pk_bf16_f32 v75, v70, v71
s_lshl_b32 s30, s35, 14
s_lshl_b32 s31, s20, 11
s_add_u32 s30, s30, s31
s_add_u32 s30, s30, 0x800000
buffer_store_dwordx4 v[72:75], v12, s[4:7], s30 offen sc1
s_lshr_b32 s44, s37, 1
s_load_dwordx2 s[12:13], s[0:1], 56
s_load_dwordx2 s[16:17], s[0:1], 64
s_and_b32 s33, s2, 1
s_lshl_b32 s33, s33, 2
s_bfe_u32 s30, s2, 0x20003
s_add_u32 s33, s33, s30
s_bfe_u32 s34, s2, 0x20001
s_mul_i32 s34, s34, 7
s_lshr_b32 s30, s2, 5
s_add_u32 s34, s34, s30
s_lshl_b32 s35, s33, 4
s_lshl_b32 s30, s20, 1
s_add_u32 s35, s35, s30
v_lshrrev_b32 v14, 3, v0
s_mov_b32 s55, 3584
v_mul_lo_u32 v3, v14, s55
v_bfe_u32 v14, v14, 1, 2
v_bfe_u32 v15, v0, 1, 2
v_xor_b32 v14, v14, v15
v_and_b32 v15, 1, v0
v_lshlrev_b32 v15, 4, v15
v_add_u32 v3, v3, v15
v_lshl_add_u32 v4, v14, 5, v3
v_lshl_add_u32 v3, v14, 5, v3
v_add_u32 v4, 27648, v4
v_lshrrev_b32 v14, 4, v0
v_bfe_u32 v15, v0, 2, 2
v_lshl_add_u32 v15, v14, 2, v15
v_lshlrev_b32 v6, 7, v15
v_bfe_u32 v14, v15, 1, 2
v_lshl_add_u32 v6, v14, 5, v6
v_and_b32 v15, 3, v0
v_lshl_add_u32 v6, v15, 3, v6
v_xor_b32 v7, 32, v6
v_xor_b32 v8, 64, v6
v_xor_b32 v9, 96, v6
s_mul_i32 s52, s20, 57344
s_lshl_b32 s30, s34, 7
s_add_u32 s52, s52, s30
s_lshl_b32 s53, s20, 11
s_waitcnt lgkmcnt(0)
s_mov_b32 s14, 0x1c0000
s_mov_b32 s15, 0x20000
s_mov_b32 s18, 0x1c0000
s_mov_b32 s19, 0x20000
s_waitcnt vmcnt(0)
s_barrier
s_lshl_b32 s30, s44, 7
s_add_u32 s30, s30, 0x21800
s_cmp_eq_u32 s20, 0
s_cselect_b32 s31, s30, s86
v_mov_b32 v1, 1
s_mov_b64 exec, 1
buffer_atomic_add v1, off, s[4:7], s31 sc1
s_mov_b64 exec, -1
s_cmp_ge_u32 s2, 224
s_cbranch_scc1 L_k5_1050
s_lshl_b32 s32, s33, 7
s_add_u32 s32, s32, 0x21800
s_add_u32 m0, s53, 0x0
s_add_u32 s30, s52, 0x0
buffer_load_dwordx4 v3, s[12:15], s30 offen lds
buffer_load_dwordx4 v4, s[12:15], s30 offen offset:1024 lds
s_add_u32 m0, s53, 0x10000
s_add_u32 s30, s52, 0x0
buffer_load_dwordx4 v3, s[16:19], s30 offen lds
buffer_load_dwordx4 v4, s[16:19], s30 offen offset:1024 lds
s_add_u32 m0, s53, 0x4000
s_add_u32 s30, s52, 0x70000
buffer_load_dwordx4 v3, s[12:15], s30 offen lds
buffer_load_dwordx4 v4, s[12:15], s30 offen offset:1024 lds
s_add_u32 m0, s53, 0x14000
s_add_u32 s30, s52, 0x70000
buffer_load_dwordx4 v3, s[16:19], s30 offen lds
buffer_load_dwordx4 v4, s[16:19], s30 offen offset:1024 lds
v_add_u32 v10, 0x10000, v6
v_add_u32 v11, 0x10000, v7
v_add_u32 v12, 0x10000, v8
v_add_u32 v13, 0x10000, v9
s_cmp_lg_u32 s20, 0
s_cbranch_scc1 L_sok_1051
s_mov_b32 s31, 0x40000
L_sloop_1052:
buffer_load_dword v1, off, s[4:7], s32 sc1
s_waitcnt vmcnt(0)
v_readfirstlane_b32 s30, v1
s_nop 3
s_cmp_ge_u32 s30, 32
s_cbranch_scc1 L_sok_1051
s_sleep 16
s_sub_u32 s31, s31, 1
s_cmp_lg_u32 s31, 0
s_cbranch_scc1 L_sloop_1052
L_sok_1051:
s_barrier
s_mul_i32 s41, s35, 57344
s_lshl_b32 s31, s34, 11
s_add_u32 s41, s41, s31
s_add_u32 s41, s41, 0xa00000
s_lshl_b32 s30, s35, 14
s_add_u32 s30, s30, 0x800000
buffer_load_dwordx4 a[0:3], v5, s[4:7], s30 offen offset:0 sc1
buffer_load_dwordx4 a[8:11], v5, s[4:7], s30 offen offset:1024 sc1
buffer_load_dwordx4 a[16:19], v5, s[4:7], s30 offen offset:2048 sc1
buffer_load_dwordx4 a[24:27], v5, s[4:7], s30 offen offset:3072 sc1
s_lshl_b32 s30, s35, 14
s_add_u32 s30, s30, 0x804000
buffer_load_dwordx4 a[4:7], v5, s[4:7], s30 offen offset:0 sc1
buffer_load_dwordx4 a[12:15], v5, s[4:7], s30 offen offset:1024 sc1
buffer_load_dwordx4 a[20:23], v5, s[4:7], s30 offen offset:2048 sc1
buffer_load_dwordx4 a[28:31], v5, s[4:7], s30 offen offset:3072 sc1
s_lshl_b32 s30, s35, 14
s_add_u32 s30, s30, 0x801000
buffer_load_dwordx4 a[32:35], v5, s[4:7], s30 offen offset:0 sc1
buffer_load_dwordx4 a[40:43], v5, s[4:7], s30 offen offset:1024 sc1
buffer_load_dwordx4 a[48:51], v5, s[4:7], s30 offen offset:2048 sc1
buffer_load_dwordx4 a[56:59], v5, s[4:7], s30 offen offset:3072 sc1
s_lshl_b32 s30, s35, 14
s_add_u32 s30, s30, 0x805000
buffer_load_dwordx4 a[36:39], v5, s[4:7], s30 offen offset:0 sc1
buffer_load_dwordx4 a[44:47], v5, s[4:7], s30 offen offset:1024 sc1
buffer_load_dwordx4 a[52:55], v5, s[4:7], s30 offen offset:2048 sc1
buffer_load_dwordx4 a[60:63], v5, s[4:7], s30 offen offset:3072 sc1
s_waitcnt vmcnt(20)
s_barrier
ds_read_b64_tr_b16 v[16:17], v6 offset:0
ds_read_b64_tr_b16 v[18:19], v6 offset:2048
ds_read_b64_tr_b16 v[20:21], v7 offset:0
ds_read_b64_tr_b16 v[22:23], v7 offset:2048
ds_read_b64_tr_b16 v[24:25], v10 offset:0
ds_read_b64_tr_b16 v[26:27], v10 offset:2048
ds_read_b64_tr_b16 v[28:29], v11 offset:0
ds_read_b64_tr_b16 v[30:31], v11 offset:2048
ds_read_b64_tr_b16 v[32:33], v6 offset:4096
ds_read_b64_tr_b16 v[34:35], v6 offset:6144
ds_read_b64_tr_b16 v[36:37], v7 offset:4096
ds_read_b64_tr_b16 v[38:39], v7 offset:6144
ds_read_b64_tr_b16 v[40:41], v10 offset:4096
ds_read_b64_tr_b16 v[42:43], v10 offset:6144
ds_read_b64_tr_b16 v[44:45], v11 offset:4096
s_waitcnt lgkmcnt(7)
ds_read_b64_tr_b16 v[46:47], v11 offset:6144
s_lshl_b32 s30, s35, 14
s_add_u32 s30, s30, 0x802000
buffer_load_dwordx4 a[64:67], v5, s[4:7], s30 offen offset:0 sc1
buffer_load_dwordx4 a[72:75], v5, s[4:7], s30 offen offset:1024 sc1
buffer_load_dwordx4 a[80:83], v5, s[4:7], s30 offen offset:2048 sc1
buffer_load_dwordx4 a[88:91], v5, s[4:7], s30 offen offset:3072 sc1
s_lshl_b32 s30, s35, 14
s_add_u32 s30, s30, 0x806000
buffer_load_dwordx4 a[68:71], v5, s[4:7], s30 offen offset:0 sc1
buffer_load_dwordx4 a[76:79], v5, s[4:7], s30 offen offset:1024 sc1
buffer_load_dwordx4 a[84:87], v5, s[4:7], s30 offen offset:2048 sc1
buffer_load_dwordx4 a[92:95], v5, s[4:7], s30 offen offset:3072 sc1
s_waitcnt vmcnt(16)
v_mfma_f32_16x16x32_bf16 v[64:67], v[16:19], a[0:3], 0
ds_read_b64_tr_b16 v[48:49], v6 offset:8192
v_mfma_f32_16x16x32_bf16 v[80:83], v[16:19], a[4:7], 0
ds_read_b64_tr_b16 v[50:51], v6 offset:10240
v_mfma_f32_16x16x32_bf16 v[68:71], v[20:23], a[0:3], 0
ds_read_b64_tr_b16 v[52:53], v7 offset:8192
v_mfma_f32_16x16x32_bf16 v[84:87], v[20:23], a[4:7], 0
ds_read_b64_tr_b16 v[54:55], v7 offset:10240
v_mfma_f32_16x16x32_bf16 v[72:75], v[24:27], a[0:3], 0
ds_read_b64_tr_b16 v[56:57], v10 offset:8192
v_mfma_f32_16x16x32_bf16 v[88:91], v[24:27], a[4:7], 0
ds_read_b64_tr_b16 v[58:59], v10 offset:10240
v_mfma_f32_16x16x32_bf16 v[76:79], v[28:31], a[0:3], 0
ds_read_b64_tr_b16 v[60:61], v11 offset:8192
v_mfma_f32_16x16x32_bf16 v[92:95], v[28:31], a[4:7], 0
s_waitcnt lgkmcnt(7)
ds_read_b64_tr_b16 v[62:63], v11 offset:10240
v_mfma_f32_16x16x32_bf16 v[64:67], v[32:35], a[8:11], v[64:67]
ds_read_b64_tr_b16 v[16:17], v6 offset:12288
v_mfma_f32_16x16x32_bf16 v[80:83], v[32:35], a[12:15], v[80:83]
ds_read_b64_tr_b16 v[18:19], v6 offset:14336
v_mfma_f32_16x16x32_bf16 v[68:71], v[36:39], a[8:11], v[68:71]
ds_read_b64_tr_b16 v[20:21], v7 offset:12288
v_mfma_f32_16x16x32_bf16 v[84:87], v[36:39], a[12:15], v[84:87]
ds_read_b64_tr_b16 v[22:23], v7 offset:14336
v_mfma_f32_16x16x32_bf16 v[72:75], v[40:43], a[8:11], v[72:75]
ds_read_b64_tr_b16 v[24:25], v10 offset:12288
v_mfma_f32_16x16x32_bf16 v[88:91], v[40:43], a[12:15], v[88:91]
ds_read_b64_tr_b16 v[26:27], v10 offset:14336
v_mfma_f32_16x16x32_bf16 v[76:79], v[44:47], a[8:11], v[76:79]
ds_read_b64_tr_b16 v[28:29], v11 offset:12288
v_mfma_f32_16x16x32_bf16 v[92:95], v[44:47], a[12:15], v[92:95]
s_waitcnt lgkmcnt(7)
ds_read_b64_tr_b16 v[30:31], v11 offset:14336
s_barrier
s_lshl_b32 s30, s35, 14
s_add_u32 s30, s30, 0x803000
buffer_load_dwordx4 a[96:99], v5, s[4:7], s30 offen offset:0 sc1
buffer_load_dwordx4 a[104:107], v5, s[4:7], s30 offen offset:1024 sc1
buffer_load_dwordx4 a[112:115], v5, s[4:7], s30 offen offset:2048 sc1
buffer_load_dwordx4 a[120:123], v5, s[4:7], s30 offen offset:3072 sc1
s_lshl_b32 s30, s35, 14
s_add_u32 s30, s30, 0x807000
buffer_load_dwordx4 a[100:103], v5, s[4:7], s30 offen offset:0 sc1
buffer_load_dwordx4 a[108:111], v5, s[4:7], s30 offen offset:1024 sc1
buffer_load_dwordx4 a[116:119], v5, s[4:7], s30 offen offset:2048 sc1
buffer_load_dwordx4 a[124:127], v5, s[4:7], s30 offen offset:3072 sc1
v_mfma_f32_16x16x32_bf16 v[64:67], v[48:51], a[16:19], v[64:67]
ds_read_b64_tr_b16 v[32:33], v6 offset:16384
v_mfma_f32_16x16x32_bf16 v[80:83], v[48:51], a[20:23], v[80:83]
ds_read_b64_tr_b16 v[34:35], v6 offset:18432
v_mfma_f32_16x16x32_bf16 v[68:71], v[52:55], a[16:19], v[68:71]
ds_read_b64_tr_b16 v[36:37], v7 offset:16384
s_add_u32 m0, s53, 0x8000
s_add_u32 s30, s52, 0xe0000
buffer_load_dwordx4 v3, s[12:15], s30 offen lds
buffer_load_dwordx4 v4, s[12:15], s30 offen offset:1024 lds
v_mfma_f32_16x16x32_bf16 v[84:87], v[52:55], a[20:23], v[84:87]
ds_read_b64_tr_b16 v[38:39], v7 offset:18432
v_mfma_f32_16x16x32_bf16 v[72:75], v[56:59], a[16:19], v[72:75]
ds_read_b64_tr_b16 v[40:41], v10 offset:16384
v_mfma_f32_16x16x32_bf16 v[88:91], v[56:59], a[20:23], v[88:91]
ds_read_b64_tr_b16 v[42:43], v10 offset:18432
v_mfma_f32_16x16x32_bf16 v[76:79], v[60:63], a[16:19], v[76:79]
ds_read_b64_tr_b16 v[44:45], v11 offset:16384
v_mfma_f32_16x16x32_bf16 v[92:95], v[60:63], a[20:23], v[92:95]
s_waitcnt lgkmcnt(7)
ds_read_b64_tr_b16 v[46:47], v11 offset:18432
v_mfma_f32_16x16x32_bf16 v[64:67], v[16:19], a[24:27], v[64:67]
ds_read_b64_tr_b16 v[48:49], v6 offset:20480
v_mfma_f32_16x16x32_bf16 v[80:83], v[16:19], a[28:31], v[80:83]
ds_read_b64_tr_b16 v[50:51], v6 offset:22528
v_mfma_f32_16x16x32_bf16 v[68:71], v[20:23], a[24:27], v[68:71]
ds_read_b64_tr_b16 v[52:53], v7 offset:20480
s_add_u32 m0, s53, 0x18000
s_add_u32 s30, s52, 0xe0000
buffer_load_dwordx4 v3, s[16:19], s30 offen lds
buffer_load_dwordx4 v4, s[16:19], s30 offen offset:1024 lds
v_mfma_f32_16x16x32_bf16 v[84:87], v[20:23], a[28:31], v[84:87]
ds_read_b64_tr_b16 v[54:55], v7 offset:22528
v_mfma_f32_16x16x32_bf16 v[72:75], v[24:27], a[24:27], v[72:75]
ds_read_b64_tr_b16 v[56:57], v10 offset:20480
v_mfma_f32_16x16x32_bf16 v[88:91], v[24:27], a[28:31], v[88:91]
ds_read_b64_tr_b16 v[58:59], v10 offset:22528
v_mfma_f32_16x16x32_bf16 v[76:79], v[28:31], a[24:27], v[76:79]
ds_read_b64_tr_b16 v[60:61], v11 offset:20480
v_mfma_f32_16x16x32_bf16 v[92:95], v[28:31], a[28:31], v[92:95]
s_waitcnt lgkmcnt(7)
ds_read_b64_tr_b16 v[62:63], v11 offset:22528
s_waitcnt vmcnt(20)
v_mfma_f32_16x16x32_bf16 v[64:67], v[32:35], a[32:35], v[64:67]
ds_read_b64_tr_b16 v[16:17], v6 offset:24576
v_mfma_f32_16x16x32_bf16 v[80:83], v[32:35], a[36:39], v[80:83]
ds_read_b64_tr_b16 v[18:19], v6 offset:26624
v_mfma_f32_16x16x32_bf16 v[68:71], v[36:39], a[32:35], v[68:71]
ds_read_b64_tr_b16 v[20:21], v7 offset:24576
v_mfma_f32_16x16x32_bf16 v[84:87], v[36:39], a[36:39], v[84:87]
ds_read_b64_tr_b16 v[22:23], v7 offset:26624
v_mfma_f32_16x16x32_bf16 v[72:75], v[40:43], a[32:35], v[72:75]
ds_read_b64_tr_b16 v[24:25], v10 offset:24576
v_mfma_f32_16x16x32_bf16 v[88:91], v[40:43], a[36:39], v[88:91]
ds_read_b64_tr_b16 v[26:27], v10 offset:26624
v_mfma_f32_16x16x32_bf16 v[76:79], v[44:47], a[32:35], v[76:79]
ds_read_b64_tr_b16 v[28:29], v11 offset:24576
v_mfma_f32_16x16x32_bf16 v[92:95], v[44:47], a[36:39], v[92:95]
s_waitcnt lgkmcnt(7)
ds_read_b64_tr_b16 v[30:31], v11 offset:26624
v_mfma_f32_16x16x32_bf16 v[64:67], v[48:51], a[40:43], v[64:67]
ds_read_b64_tr_b16 v[32:33], v6 offset:28672
v_mfma_f32_16x16x32_bf16 v[80:83], v[48:51], a[44:47], v[80:83]
ds_read_b64_tr_b16 v[34:35], v6 offset:30720
v_mfma_f32_16x16x32_bf16 v[68:71], v[52:55], a[40:43], v[68:71]
ds_read_b64_tr_b16 v[36:37], v7 offset:28672
v_mfma_f32_16x16x32_bf16 v[84:87], v[52:55], a[44:47], v[84:87]
ds_read_b64_tr_b16 v[38:39], v7 offset:30720
v_mfma_f32_16x16x32_bf16 v[72:75], v[56:59], a[40:43], v[72:75]
ds_read_b64_tr_b16 v[40:41], v10 offset:28672
v_mfma_f32_16x16x32_bf16 v[88:91], v[56:59], a[44:47], v[88:91]
ds_read_b64_tr_b16 v[42:43], v10 offset:30720
v_mfma_f32_16x16x32_bf16 v[76:79], v[60:63], a[40:43], v[76:79]
ds_read_b64_tr_b16 v[44:45], v11 offset:28672
v_mfma_f32_16x16x32_bf16 v[92:95], v[60:63], a[44:47], v[92:95]
s_waitcnt lgkmcnt(7)
ds_read_b64_tr_b16 v[46:47], v11 offset:30720
s_waitcnt vmcnt(0)
s_barrier
v_mfma_f32_16x16x32_bf16 v[64:67], v[16:19], a[48:51], v[64:67]
ds_read_b64_tr_b16 v[48:49], v6 offset:32768
v_mfma_f32_16x16x32_bf16 v[80:83], v[16:19], a[52:55], v[80:83]
ds_read_b64_tr_b16 v[50:51], v6 offset:34816
v_mfma_f32_16x16x32_bf16 v[68:71], v[20:23], a[48:51], v[68:71]
ds_read_b64_tr_b16 v[52:53], v7 offset:32768
s_add_u32 m0, s53, 0xc000
s_add_u32 s30, s52, 0x150000
buffer_load_dwordx4 v3, s[12:15], s30 offen lds
buffer_load_dwordx4 v4, s[12:15], s30 offen offset:1024 lds
v_mfma_f32_16x16x32_bf16 v[84:87], v[20:23], a[52:55], v[84:87]
ds_read_b64_tr_b16 v[54:55], v7 offset:34816
v_mfma_f32_16x16x32_bf16 v[72:75], v[24:27], a[48:51], v[72:75]
ds_read_b64_tr_b16 v[56:57], v10 offset:32768
v_mfma_f32_16x16x32_bf16 v[88:91], v[24:27], a[52:55], v[88:91]
ds_read_b64_tr_b16 v[58:59], v10 offset:34816
v_mfma_f32_16x16x32_bf16 v[76:79], v[28:31], a[48:51], v[76:79]
ds_read_b64_tr_b16 v[60:61], v11 offset:32768
v_mfma_f32_16x16x32_bf16 v[92:95], v[28:31], a[52:55], v[92:95]
s_waitcnt lgkmcnt(7)
ds_read_b64_tr_b16 v[62:63], v11 offset:34816
v_mfma_f32_16x16x32_bf16 v[64:67], v[32:35], a[56:59], v[64:67]
ds_read_b64_tr_b16 v[16:17], v6 offset:36864
v_mfma_f32_16x16x32_bf16 v[80:83], v[32:35], a[60:63], v[80:83]
ds_read_b64_tr_b16 v[18:19], v6 offset:38912
v_mfma_f32_16x16x32_bf16 v[68:71], v[36:39], a[56:59], v[68:71]
ds_read_b64_tr_b16 v[20:21], v7 offset:36864
s_add_u32 m0, s53, 0x1c000
s_add_u32 s30, s52, 0x150000
buffer_load_dwordx4 v3, s[16:19], s30 offen lds
buffer_load_dwordx4 v4, s[16:19], s30 offen offset:1024 lds
v_mfma_f32_16x16x32_bf16 v[84:87], v[36:39], a[60:63], v[84:87]
ds_read_b64_tr_b16 v[22:23], v7 offset:38912
v_mfma_f32_16x16x32_bf16 v[72:75], v[40:43], a[56:59], v[72:75]
ds_read_b64_tr_b16 v[24:25], v10 offset:36864
v_mfma_f32_16x16x32_bf16 v[88:91], v[40:43], a[60:63], v[88:91]
ds_read_b64_tr_b16 v[26:27], v10 offset:38912
v_mfma_f32_16x16x32_bf16 v[76:79], v[44:47], a[56:59], v[76:79]
ds_read_b64_tr_b16 v[28:29], v11 offset:36864
v_mfma_f32_16x16x32_bf16 v[92:95], v[44:47], a[60:63], v[92:95]
s_waitcnt lgkmcnt(7)
ds_read_b64_tr_b16 v[30:31], v11 offset:38912
v_mfma_f32_16x16x32_bf16 v[64:67], v[48:51], a[64:67], v[64:67]
ds_read_b64_tr_b16 v[32:33], v6 offset:40960
v_mfma_f32_16x16x32_bf16 v[80:83], v[48:51], a[68:71], v[80:83]
ds_read_b64_tr_b16 v[34:35], v6 offset:43008
v_mfma_f32_16x16x32_bf16 v[68:71], v[52:55], a[64:67], v[68:71]
ds_read_b64_tr_b16 v[36:37], v7 offset:40960
v_mfma_f32_16x16x32_bf16 v[84:87], v[52:55], a[68:71], v[84:87]
ds_read_b64_tr_b16 v[38:39], v7 offset:43008
v_mfma_f32_16x16x32_bf16 v[72:75], v[56:59], a[64:67], v[72:75]
ds_read_b64_tr_b16 v[40:41], v10 offset:40960
v_mfma_f32_16x16x32_bf16 v[88:91], v[56:59], a[68:71], v[88:91]
ds_read_b64_tr_b16 v[42:43], v10 offset:43008
v_mfma_f32_16x16x32_bf16 v[76:79], v[60:63], a[64:67], v[76:79]
ds_read_b64_tr_b16 v[44:45], v11 offset:40960
v_mfma_f32_16x16x32_bf16 v[92:95], v[60:63], a[68:71], v[92:95]
s_waitcnt lgkmcnt(7)
ds_read_b64_tr_b16 v[46:47], v11 offset:43008
v_mfma_f32_16x16x32_bf16 v[64:67], v[16:19], a[72:75], v[64:67]
ds_read_b64_tr_b16 v[48:49], v6 offset:45056
v_mfma_f32_16x16x32_bf16 v[80:83], v[16:19], a[76:79], v[80:83]
ds_read_b64_tr_b16 v[50:51], v6 offset:47104
v_mfma_f32_16x16x32_bf16 v[68:71], v[20:23], a[72:75], v[68:71]
ds_read_b64_tr_b16 v[52:53], v7 offset:45056
v_mfma_f32_16x16x32_bf16 v[84:87], v[20:23], a[76:79], v[84:87]
ds_read_b64_tr_b16 v[54:55], v7 offset:47104
v_mfma_f32_16x16x32_bf16 v[72:75], v[24:27], a[72:75], v[72:75]
ds_read_b64_tr_b16 v[56:57], v10 offset:45056
v_mfma_f32_16x16x32_bf16 v[88:91], v[24:27], a[76:79], v[88:91]
ds_read_b64_tr_b16 v[58:59], v10 offset:47104
v_mfma_f32_16x16x32_bf16 v[76:79], v[28:31], a[72:75], v[76:79]
ds_read_b64_tr_b16 v[60:61], v11 offset:45056
v_mfma_f32_16x16x32_bf16 v[92:95], v[28:31], a[76:79], v[92:95]
s_waitcnt lgkmcnt(7)
ds_read_b64_tr_b16 v[62:63], v11 offset:47104
s_waitcnt vmcnt(0)
s_barrier
v_mfma_f32_16x16x32_bf16 v[64:67], v[32:35], a[80:83], v[64:67]
ds_read_b64_tr_b16 v[16:17], v6 offset:49152
v_mfma_f32_16x16x32_bf16 v[80:83], v[32:35], a[84:87], v[80:83]
ds_read_b64_tr_b16 v[18:19], v6 offset:51200
v_mfma_f32_16x16x32_bf16 v[68:71], v[36:39], a[80:83], v[68:71]
ds_read_b64_tr_b16 v[20:21], v7 offset:49152
v_mfma_f32_16x16x32_bf16 v[84:87], v[36:39], a[84:87], v[84:87]
ds_read_b64_tr_b16 v[22:23], v7 offset:51200
v_mfma_f32_16x16x32_bf16 v[72:75], v[40:43], a[80:83], v[72:75]
ds_read_b64_tr_b16 v[24:25], v10 offset:49152
v_mfma_f32_16x16x32_bf16 v[88:91], v[40:43], a[84:87], v[88:91]
ds_read_b64_tr_b16 v[26:27], v10 offset:51200
v_mfma_f32_16x16x32_bf16 v[76:79], v[44:47], a[80:83], v[76:79]
ds_read_b64_tr_b16 v[28:29], v11 offset:49152
v_mfma_f32_16x16x32_bf16 v[92:95], v[44:47], a[84:87], v[92:95]
s_waitcnt lgkmcnt(7)
ds_read_b64_tr_b16 v[30:31], v11 offset:51200
v_mfma_f32_16x16x32_bf16 v[64:67], v[48:51], a[88:91], v[64:67]
ds_read_b64_tr_b16 v[32:33], v6 offset:53248
v_mfma_f32_16x16x32_bf16 v[80:83], v[48:51], a[92:95], v[80:83]
ds_read_b64_tr_b16 v[34:35], v6 offset:55296
v_mfma_f32_16x16x32_bf16 v[68:71], v[52:55], a[88:91], v[68:71]
ds_read_b64_tr_b16 v[36:37], v7 offset:53248
v_mfma_f32_16x16x32_bf16 v[84:87], v[52:55], a[92:95], v[84:87]
ds_read_b64_tr_b16 v[38:39], v7 offset:55296
v_mfma_f32_16x16x32_bf16 v[72:75], v[56:59], a[88:91], v[72:75]
ds_read_b64_tr_b16 v[40:41], v10 offset:53248
v_mfma_f32_16x16x32_bf16 v[88:91], v[56:59], a[92:95], v[88:91]
ds_read_b64_tr_b16 v[42:43], v10 offset:55296
v_mfma_f32_16x16x32_bf16 v[76:79], v[60:63], a[88:91], v[76:79]
ds_read_b64_tr_b16 v[44:45], v11 offset:53248
v_mfma_f32_16x16x32_bf16 v[92:95], v[60:63], a[92:95], v[92:95]
s_waitcnt lgkmcnt(7)
ds_read_b64_tr_b16 v[46:47], v11 offset:55296
v_mfma_f32_16x16x32_bf16 v[64:67], v[16:19], a[96:99], v[64:67]
ds_read_b64_tr_b16 v[48:49], v6 offset:57344
v_mfma_f32_16x16x32_bf16 v[80:83], v[16:19], a[100:103], v[80:83]
ds_read_b64_tr_b16 v[50:51], v6 offset:59392
v_mfma_f32_16x16x32_bf16 v[68:71], v[20:23], a[96:99], v[68:71]
ds_read_b64_tr_b16 v[52:53], v7 offset:57344
v_mfma_f32_16x16x32_bf16 v[84:87], v[20:23], a[100:103], v[84:87]
ds_read_b64_tr_b16 v[54:55], v7 offset:59392
v_mfma_f32_16x16x32_bf16 v[72:75], v[24:27], a[96:99], v[72:75]
ds_read_b64_tr_b16 v[56:57], v10 offset:57344
v_mfma_f32_16x16x32_bf16 v[88:91], v[24:27], a[100:103], v[88:91]
ds_read_b64_tr_b16 v[58:59], v10 offset:59392
v_mfma_f32_16x16x32_bf16 v[76:79], v[28:31], a[96:99], v[76:79]
ds_read_b64_tr_b16 v[60:61], v11 offset:57344
v_mfma_f32_16x16x32_bf16 v[92:95], v[28:31], a[100:103], v[92:95]
s_waitcnt lgkmcnt(7)
ds_read_b64_tr_b16 v[62:63], v11 offset:59392
v_mfma_f32_16x16x32_bf16 v[64:67], v[32:35], a[104:107], v[64:67]
ds_read_b64_tr_b16 v[16:17], v6 offset:61440
v_mfma_f32_16x16x32_bf16 v[80:83], v[32:35], a[108:111], v[80:83]
ds_read_b64_tr_b16 v[18:19], v6 offset:63488
v_mfma_f32_16x16x32_bf16 v[68:71], v[36:39], a[104:107], v[68:71]
ds_read_b64_tr_b16 v[20:21], v7 offset:61440
v_mfma_f32_16x16x32_bf16 v[84:87], v[36:39], a[108:111], v[84:87]
ds_read_b64_tr_b16 v[22:23], v7 offset:63488
v_mfma_f32_16x16x32_bf16 v[72:75], v[40:43], a[104:107], v[72:75]
ds_read_b64_tr_b16 v[24:25], v10 offset:61440
v_mfma_f32_16x16x32_bf16 v[88:91], v[40:43], a[108:111], v[88:91]
ds_read_b64_tr_b16 v[26:27], v10 offset:63488
v_mfma_f32_16x16x32_bf16 v[76:79], v[44:47], a[104:107], v[76:79]
ds_read_b64_tr_b16 v[28:29], v11 offset:61440
v_mfma_f32_16x16x32_bf16 v[92:95], v[44:47], a[108:111], v[92:95]
s_waitcnt lgkmcnt(7)
ds_read_b64_tr_b16 v[30:31], v11 offset:63488
v_mfma_f32_16x16x32_bf16 v[64:67], v[48:51], a[112:115], v[64:67]
ds_read_b64_tr_b16 v[32:33], v8 offset:0
v_mfma_f32_16x16x32_bf16 v[80:83], v[48:51], a[116:119], v[80:83]
ds_read_b64_tr_b16 v[34:35], v8 offset:2048
v_mfma_f32_16x16x32_bf16 v[68:71], v[52:55], a[112:115], v[68:71]
ds_read_b64_tr_b16 v[36:37], v9 offset:0
v_mfma_f32_16x16x32_bf16 v[84:87], v[52:55], a[116:119], v[84:87]
ds_read_b64_tr_b16 v[38:39], v9 offset:2048
v_mfma_f32_16x16x32_bf16 v[72:75], v[56:59], a[112:115], v[72:75]
ds_read_b64_tr_b16 v[40:41], v12 offset:0
v_mfma_f32_16x16x32_bf16 v[88:91], v[56:59], a[116:119], v[88:91]
ds_read_b64_tr_b16 v[42:43], v12 offset:2048
v_mfma_f32_16x16x32_bf16 v[76:79], v[60:63], a[112:115], v[76:79]
ds_read_b64_tr_b16 v[44:45], v13 offset:0
v_mfma_f32_16x16x32_bf16 v[92:95], v[60:63], a[116:119], v[92:95]
s_waitcnt lgkmcnt(7)
ds_read_b64_tr_b16 v[46:47], v13 offset:2048
v_mfma_f32_16x16x32_bf16 v[64:67], v[16:19], a[120:123], v[64:67]
ds_read_b64_tr_b16 v[48:49], v8 offset:4096
v_mfma_f32_16x16x32_bf16 v[80:83], v[16:19], a[124:127], v[80:83]
ds_read_b64_tr_b16 v[50:51], v8 offset:6144
v_mfma_f32_16x16x32_bf16 v[68:71], v[20:23], a[120:123], v[68:71]
ds_read_b64_tr_b16 v[52:53], v9 offset:4096
v_mfma_f32_16x16x32_bf16 v[84:87], v[20:23], a[124:127], v[84:87]
ds_read_b64_tr_b16 v[54:55], v9 offset:6144
v_mfma_f32_16x16x32_bf16 v[72:75], v[24:27], a[120:123], v[72:75]
ds_read_b64_tr_b16 v[56:57], v12 offset:4096
v_mfma_f32_16x16x32_bf16 v[88:91], v[24:27], a[124:127], v[88:91]
ds_read_b64_tr_b16 v[58:59], v12 offset:6144
v_mfma_f32_16x16x32_bf16 v[76:79], v[28:31], a[120:123], v[76:79]
ds_read_b64_tr_b16 v[60:61], v13 offset:4096
v_mfma_f32_16x16x32_bf16 v[92:95], v[28:31], a[124:127], v[92:95]
s_waitcnt lgkmcnt(7)
ds_read_b64_tr_b16 v[62:63], v13 offset:6144
v_mfma_f32_16x16x32_bf16 v[96:99], v[32:35], a[0:3], 0
ds_read_b64_tr_b16 v[16:17], v8 offset:8192
v_mfma_f32_16x16x32_bf16 v[112:115], v[32:35], a[4:7], 0
ds_read_b64_tr_b16 v[18:19], v8 offset:10240
v_mfma_f32_16x16x32_bf16 v[100:103], v[36:39], a[0:3], 0
ds_read_b64_tr_b16 v[20:21], v9 offset:8192
v_mfma_f32_16x16x32_bf16 v[116:119], v[36:39], a[4:7], 0
ds_read_b64_tr_b16 v[22:23], v9 offset:10240
v_mfma_f32_16x16x32_bf16 v[104:107], v[40:43], a[0:3], 0
ds_read_b64_tr_b16 v[24:25], v12 offset:8192
v_mfma_f32_16x16x32_bf16 v[120:123], v[40:43], a[4:7], 0
ds_read_b64_tr_b16 v[26:27], v12 offset:10240
v_mfma_f32_16x16x32_bf16 v[108:111], v[44:47], a[0:3], 0
ds_read_b64_tr_b16 v[28:29], v13 offset:8192
v_mfma_f32_16x16x32_bf16 v[124:127], v[44:47], a[4:7], 0
s_waitcnt lgkmcnt(7)
ds_read_b64_tr_b16 v[30:31], v13 offset:10240
s_mov_b32 s32, 0x3fb8aa3b
v_mfma_f32_16x16x32_bf16 v[96:99], v[48:51], a[8:11], v[96:99]
ds_read_b64_tr_b16 v[32:33], v8 offset:12288
v_mul_f32 v1, s32, v64
v_mul_f32 v2, s32, v65
v_mfma_f32_16x16x32_bf16 v[112:115], v[48:51], a[12:15], v[112:115]
ds_read_b64_tr_b16 v[34:35], v8 offset:14336
v_mul_f32 v14, s32, v66
v_mul_f32 v15, s32, v67
v_mfma_f32_16x16x32_bf16 v[100:103], v[52:55], a[8:11], v[100:103]
ds_read_b64_tr_b16 v[36:37], v9 offset:12288
v_exp_f32 v1, -v1
v_exp_f32 v2, -v2
v_mfma_f32_16x16x32_bf16 v[116:119], v[52:55], a[12:15], v[116:119]
ds_read_b64_tr_b16 v[38:39], v9 offset:14336
v_exp_f32 v14, -v14
v_exp_f32 v15, -v15
v_mfma_f32_16x16x32_bf16 v[104:107], v[56:59], a[8:11], v[104:107]
ds_read_b64_tr_b16 v[40:41], v12 offset:12288
v_mul_f32 v64, v64, v72
v_mul_f32 v65, v65, v73
v_mfma_f32_16x16x32_bf16 v[120:123], v[56:59], a[12:15], v[120:123]
ds_read_b64_tr_b16 v[42:43], v12 offset:14336
v_mul_f32 v66, v66, v74
v_mul_f32 v67, v67, v75
v_mfma_f32_16x16x32_bf16 v[108:111], v[60:63], a[8:11], v[108:111]
ds_read_b64_tr_b16 v[44:45], v13 offset:12288
v_add_f32 v1, 1.0, v1
v_add_f32 v2, 1.0, v2
v_mfma_f32_16x16x32_bf16 v[124:127], v[60:63], a[12:15], v[124:127]
s_waitcnt lgkmcnt(7)
ds_read_b64_tr_b16 v[46:47], v13 offset:14336
v_add_f32 v14, 1.0, v14
v_add_f32 v15, 1.0, v15
v_mfma_f32_16x16x32_bf16 v[96:99], v[16:19], a[16:19], v[96:99]
ds_read_b64_tr_b16 v[48:49], v8 offset:16384
v_rcp_f32 v1, v1
v_rcp_f32 v2, v2
v_mfma_f32_16x16x32_bf16 v[112:115], v[16:19], a[20:23], v[112:115]
ds_read_b64_tr_b16 v[50:51], v8 offset:18432
v_rcp_f32 v14, v14
v_rcp_f32 v15, v15
v_mfma_f32_16x16x32_bf16 v[100:103], v[20:23], a[16:19], v[100:103]
ds_read_b64_tr_b16 v[52:53], v9 offset:16384
s_nop 0
v_mul_f32 v64, v64, v1
v_mfma_f32_16x16x32_bf16 v[116:119], v[20:23], a[20:23], v[116:119]
ds_read_b64_tr_b16 v[54:55], v9 offset:18432
v_mul_f32 v65, v65, v2
v_mul_f32 v66, v66, v14
v_mfma_f32_16x16x32_bf16 v[104:107], v[24:27], a[16:19], v[104:107]
ds_read_b64_tr_b16 v[56:57], v12 offset:16384
v_mul_f32 v67, v67, v15
v_mul_f32 v1, s32, v68
v_mfma_f32_16x16x32_bf16 v[120:123], v[24:27], a[20:23], v[120:123]
ds_read_b64_tr_b16 v[58:59], v12 offset:18432
v_mul_f32 v2, s32, v69
v_mul_f32 v14, s32, v70
v_mfma_f32_16x16x32_bf16 v[108:111], v[28:31], a[16:19], v[108:111]
ds_read_b64_tr_b16 v[60:61], v13 offset:16384
v_mul_f32 v15, s32, v71
v_exp_f32 v1, -v1
v_mfma_f32_16x16x32_bf16 v[124:127], v[28:31], a[20:23], v[124:127]
s_waitcnt lgkmcnt(7)
ds_read_b64_tr_b16 v[62:63], v13 offset:18432
v_exp_f32 v2, -v2
v_exp_f32 v14, -v14
v_mfma_f32_16x16x32_bf16 v[96:99], v[32:35], a[24:27], v[96:99]
ds_read_b64_tr_b16 v[16:17], v8 offset:20480
v_exp_f32 v15, -v15
v_mul_f32 v68, v68, v76
v_mfma_f32_16x16x32_bf16 v[112:115], v[32:35], a[28:31], v[112:115]
ds_read_b64_tr_b16 v[18:19], v8 offset:22528
v_mul_f32 v69, v69, v77
v_mul_f32 v70, v70, v78
v_mfma_f32_16x16x32_bf16 v[100:103], v[36:39], a[24:27], v[100:103]
ds_read_b64_tr_b16 v[20:21], v9 offset:20480
v_mul_f32 v71, v71, v79
v_add_f32 v1, 1.0, v1
v_mfma_f32_16x16x32_bf16 v[116:119], v[36:39], a[28:31], v[116:119]
ds_read_b64_tr_b16 v[22:23], v9 offset:22528
v_add_f32 v2, 1.0, v2
v_add_f32 v14, 1.0, v14
v_mfma_f32_16x16x32_bf16 v[104:107], v[40:43], a[24:27], v[104:107]
ds_read_b64_tr_b16 v[24:25], v12 offset:20480
v_add_f32 v15, 1.0, v15
v_rcp_f32 v1, v1
v_mfma_f32_16x16x32_bf16 v[120:123], v[40:43], a[28:31], v[120:123]
ds_read_b64_tr_b16 v[26:27], v12 offset:22528
v_rcp_f32 v2, v2
v_rcp_f32 v14, v14
v_mfma_f32_16x16x32_bf16 v[108:111], v[44:47], a[24:27], v[108:111]
ds_read_b64_tr_b16 v[28:29], v13 offset:20480
v_rcp_f32 v15, v15
s_nop 0
v_mfma_f32_16x16x32_bf16 v[124:127], v[44:47], a[28:31], v[124:127]
s_waitcnt lgkmcnt(7)
ds_read_b64_tr_b16 v[30:31], v13 offset:22528
v_mul_f32 v68, v68, v1
v_mul_f32 v69, v69, v2
v_mfma_f32_16x16x32_bf16 v[96:99], v[48:51], a[32:35], v[96:99]
ds_read_b64_tr_b16 v[32:33], v8 offset:24576
v_mul_f32 v70, v70, v14
v_mul_f32 v71, v71, v15
v_mfma_f32_16x16x32_bf16 v[112:115], v[48:51], a[36:39], v[112:115]
ds_read_b64_tr_b16 v[34:35], v8 offset:26624
v_cvt_pk_bf16_f32 v64, v64, v65
v_cvt_pk_bf16_f32 v65, v66, v67
v_mfma_f32_16x16x32_bf16 v[100:103], v[52:55], a[32:35], v[100:103]
ds_read_b64_tr_b16 v[36:37], v9 offset:24576
v_cvt_pk_bf16_f32 v66, v68, v69
v_cvt_pk_bf16_f32 v67, v70, v71
v_mfma_f32_16x16x32_bf16 v[116:119], v[52:55], a[36:39], v[116:119]
ds_read_b64_tr_b16 v[38:39], v9 offset:26624
s_add_u32 s30, s41, 0
buffer_store_dwordx4 v[64:67], v5, s[4:7], s30 offen sc1
v_mul_f32 v1, s32, v80
v_mfma_f32_16x16x32_bf16 v[104:107], v[56:59], a[32:35], v[104:107]
ds_read_b64_tr_b16 v[40:41], v12 offset:24576
v_mul_f32 v2, s32, v81
v_mul_f32 v14, s32, v82
v_mfma_f32_16x16x32_bf16 v[120:123], v[56:59], a[36:39], v[120:123]
ds_read_b64_tr_b16 v[42:43], v12 offset:26624
v_mul_f32 v15, s32, v83
v_exp_f32 v1, -v1
v_mfma_f32_16x16x32_bf16 v[108:111], v[60:63], a[32:35], v[108:111]
ds_read_b64_tr_b16 v[44:45], v13 offset:24576
v_exp_f32 v2, -v2
v_exp_f32 v14, -v14
v_mfma_f32_16x16x32_bf16 v[124:127], v[60:63], a[36:39], v[124:127]
s_waitcnt lgkmcnt(7)
ds_read_b64_tr_b16 v[46:47], v13 offset:26624
v_exp_f32 v15, -v15
v_mul_f32 v80, v80, v88
v_mfma_f32_16x16x32_bf16 v[96:99], v[16:19], a[40:43], v[96:99]
ds_read_b64_tr_b16 v[48:49], v8 offset:28672
v_mul_f32 v81, v81, v89
v_mul_f32 v82, v82, v90
v_mfma_f32_16x16x32_bf16 v[112:115], v[16:19], a[44:47], v[112:115]
ds_read_b64_tr_b16 v[50:51], v8 offset:30720
v_mul_f32 v83, v83, v91
v_add_f32 v1, 1.0, v1
v_mfma_f32_16x16x32_bf16 v[100:103], v[20:23], a[40:43], v[100:103]
ds_read_b64_tr_b16 v[52:53], v9 offset:28672
v_add_f32 v2, 1.0, v2
v_add_f32 v14, 1.0, v14
v_mfma_f32_16x16x32_bf16 v[116:119], v[20:23], a[44:47], v[116:119]
ds_read_b64_tr_b16 v[54:55], v9 offset:30720
v_add_f32 v15, 1.0, v15
v_rcp_f32 v1, v1
v_mfma_f32_16x16x32_bf16 v[104:107], v[24:27], a[40:43], v[104:107]
ds_read_b64_tr_b16 v[56:57], v12 offset:28672
v_rcp_f32 v2, v2
v_rcp_f32 v14, v14
v_mfma_f32_16x16x32_bf16 v[120:123], v[24:27], a[44:47], v[120:123]
ds_read_b64_tr_b16 v[58:59], v12 offset:30720
v_rcp_f32 v15, v15
s_nop 0
v_mfma_f32_16x16x32_bf16 v[108:111], v[28:31], a[40:43], v[108:111]
ds_read_b64_tr_b16 v[60:61], v13 offset:28672
v_mul_f32 v80, v80, v1
v_mul_f32 v81, v81, v2
v_mfma_f32_16x16x32_bf16 v[124:127], v[28:31], a[44:47], v[124:127]
s_waitcnt lgkmcnt(7)
ds_read_b64_tr_b16 v[62:63], v13 offset:30720
v_mul_f32 v82, v82, v14
v_mul_f32 v83, v83, v15
v_mfma_f32_16x16x32_bf16 v[96:99], v[32:35], a[48:51], v[96:99]
ds_read_b64_tr_b16 v[16:17], v8 offset:32768
v_mul_f32 v1, s32, v84
v_mul_f32 v2, s32, v85
v_mfma_f32_16x16x32_bf16 v[112:115], v[32:35], a[52:55], v[112:115]
ds_read_b64_tr_b16 v[18:19], v8 offset:34816
v_mul_f32 v14, s32, v86
v_mul_f32 v15, s32, v87
v_mfma_f32_16x16x32_bf16 v[100:103], v[36:39], a[48:51], v[100:103]
ds_read_b64_tr_b16 v[20:21], v9 offset:32768
v_exp_f32 v1, -v1
v_exp_f32 v2, -v2
v_mfma_f32_16x16x32_bf16 v[116:119], v[36:39], a[52:55], v[116:119]
ds_read_b64_tr_b16 v[22:23], v9 offset:34816
v_exp_f32 v14, -v14
v_exp_f32 v15, -v15
v_mfma_f32_16x16x32_bf16 v[104:107], v[40:43], a[48:51], v[104:107]
ds_read_b64_tr_b16 v[24:25], v12 offset:32768
v_mul_f32 v84, v84, v92
v_mul_f32 v85, v85, v93
v_mfma_f32_16x16x32_bf16 v[120:123], v[40:43], a[52:55], v[120:123]
ds_read_b64_tr_b16 v[26:27], v12 offset:34816
v_mul_f32 v86, v86, v94
v_mul_f32 v87, v87, v95
v_mfma_f32_16x16x32_bf16 v[108:111], v[44:47], a[48:51], v[108:111]
ds_read_b64_tr_b16 v[28:29], v13 offset:32768
v_add_f32 v1, 1.0, v1
v_add_f32 v2, 1.0, v2
v_mfma_f32_16x16x32_bf16 v[124:127], v[44:47], a[52:55], v[124:127]
s_waitcnt lgkmcnt(7)
ds_read_b64_tr_b16 v[30:31], v13 offset:34816
v_add_f32 v14, 1.0, v14
v_add_f32 v15, 1.0, v15
v_mfma_f32_16x16x32_bf16 v[96:99], v[48:51], a[56:59], v[96:99]
ds_read_b64_tr_b16 v[32:33], v8 offset:36864
v_rcp_f32 v1, v1
v_rcp_f32 v2, v2
v_mfma_f32_16x16x32_bf16 v[112:115], v[48:51], a[60:63], v[112:115]
ds_read_b64_tr_b16 v[34:35], v8 offset:38912
v_rcp_f32 v14, v14
v_rcp_f32 v15, v15
v_mfma_f32_16x16x32_bf16 v[100:103], v[52:55], a[56:59], v[100:103]
ds_read_b64_tr_b16 v[36:37], v9 offset:36864
s_nop 0
v_mul_f32 v84, v84, v1
v_mfma_f32_16x16x32_bf16 v[116:119], v[52:55], a[60:63], v[116:119]
ds_read_b64_tr_b16 v[38:39], v9 offset:38912
v_mul_f32 v85, v85, v2
v_mul_f32 v86, v86, v14
v_mfma_f32_16x16x32_bf16 v[104:107], v[56:59], a[56:59], v[104:107]
ds_read_b64_tr_b16 v[40:41], v12 offset:36864
v_mul_f32 v87, v87, v15
v_cvt_pk_bf16_f32 v80, v80, v81
v_mfma_f32_16x16x32_bf16 v[120:123], v[56:59], a[60:63], v[120:123]
ds_read_b64_tr_b16 v[42:43], v12 offset:38912
v_cvt_pk_bf16_f32 v81, v82, v83
v_cvt_pk_bf16_f32 v82, v84, v85
v_mfma_f32_16x16x32_bf16 v[108:111], v[60:63], a[56:59], v[108:111]
ds_read_b64_tr_b16 v[44:45], v13 offset:36864
v_cvt_pk_bf16_f32 v83, v86, v87
s_add_u32 s30, s41, 57344
buffer_store_dwordx4 v[80:83], v5, s[4:7], s30 offen sc1
v_mfma_f32_16x16x32_bf16 v[124:127], v[60:63], a[60:63], v[124:127]
s_waitcnt lgkmcnt(7)
ds_read_b64_tr_b16 v[46:47], v13 offset:38912
v_mfma_f32_16x16x32_bf16 v[96:99], v[16:19], a[64:67], v[96:99]
ds_read_b64_tr_b16 v[48:49], v8 offset:40960
v_mfma_f32_16x16x32_bf16 v[112:115], v[16:19], a[68:71], v[112:115]
ds_read_b64_tr_b16 v[50:51], v8 offset:43008
v_mfma_f32_16x16x32_bf16 v[100:103], v[20:23], a[64:67], v[100:103]
ds_read_b64_tr_b16 v[52:53], v9 offset:40960
v_mfma_f32_16x16x32_bf16 v[116:119], v[20:23], a[68:71], v[116:119]
ds_read_b64_tr_b16 v[54:55], v9 offset:43008
v_mfma_f32_16x16x32_bf16 v[104:107], v[24:27], a[64:67], v[104:107]
ds_read_b64_tr_b16 v[56:57], v12 offset:40960
v_mfma_f32_16x16x32_bf16 v[120:123], v[24:27], a[68:71], v[120:123]
ds_read_b64_tr_b16 v[58:59], v12 offset:43008
v_mfma_f32_16x16x32_bf16 v[108:111], v[28:31], a[64:67], v[108:111]
ds_read_b64_tr_b16 v[60:61], v13 offset:40960
v_mfma_f32_16x16x32_bf16 v[124:127], v[28:31], a[68:71], v[124:127]
s_waitcnt lgkmcnt(7)
ds_read_b64_tr_b16 v[62:63], v13 offset:43008
v_mfma_f32_16x16x32_bf16 v[96:99], v[32:35], a[72:75], v[96:99]
ds_read_b64_tr_b16 v[16:17], v8 offset:45056
v_mfma_f32_16x16x32_bf16 v[112:115], v[32:35], a[76:79], v[112:115]
ds_read_b64_tr_b16 v[18:19], v8 offset:47104
v_mfma_f32_16x16x32_bf16 v[100:103], v[36:39], a[72:75], v[100:103]
ds_read_b64_tr_b16 v[20:21], v9 offset:45056
v_mfma_f32_16x16x32_bf16 v[116:119], v[36:39], a[76:79], v[116:119]
ds_read_b64_tr_b16 v[22:23], v9 offset:47104
v_mfma_f32_16x16x32_bf16 v[104:107], v[40:43], a[72:75], v[104:107]
ds_read_b64_tr_b16 v[24:25], v12 offset:45056
v_mfma_f32_16x16x32_bf16 v[120:123], v[40:43], a[76:79], v[120:123]
ds_read_b64_tr_b16 v[26:27], v12 offset:47104
v_mfma_f32_16x16x32_bf16 v[108:111], v[44:47], a[72:75], v[108:111]
ds_read_b64_tr_b16 v[28:29], v13 offset:45056
v_mfma_f32_16x16x32_bf16 v[124:127], v[44:47], a[76:79], v[124:127]
s_waitcnt lgkmcnt(7)
ds_read_b64_tr_b16 v[30:31], v13 offset:47104
v_mfma_f32_16x16x32_bf16 v[96:99], v[48:51], a[80:83], v[96:99]
ds_read_b64_tr_b16 v[32:33], v8 offset:49152
v_mfma_f32_16x16x32_bf16 v[112:115], v[48:51], a[84:87], v[112:115]
ds_read_b64_tr_b16 v[34:35], v8 offset:51200
v_mfma_f32_16x16x32_bf16 v[100:103], v[52:55], a[80:83], v[100:103]
ds_read_b64_tr_b16 v[36:37], v9 offset:49152
v_mfma_f32_16x16x32_bf16 v[116:119], v[52:55], a[84:87], v[116:119]
ds_read_b64_tr_b16 v[38:39], v9 offset:51200
v_mfma_f32_16x16x32_bf16 v[104:107], v[56:59], a[80:83], v[104:107]
ds_read_b64_tr_b16 v[40:41], v12 offset:49152
v_mfma_f32_16x16x32_bf16 v[120:123], v[56:59], a[84:87], v[120:123]
ds_read_b64_tr_b16 v[42:43], v12 offset:51200
v_mfma_f32_16x16x32_bf16 v[108:111], v[60:63], a[80:83], v[108:111]
ds_read_b64_tr_b16 v[44:45], v13 offset:49152
v_mfma_f32_16x16x32_bf16 v[124:127], v[60:63], a[84:87], v[124:127]
s_waitcnt lgkmcnt(7)
ds_read_b64_tr_b16 v[46:47], v13 offset:51200
v_mfma_f32_16x16x32_bf16 v[96:99], v[16:19], a[88:91], v[96:99]
ds_read_b64_tr_b16 v[48:49], v8 offset:53248
v_mfma_f32_16x16x32_bf16 v[112:115], v[16:19], a[92:95], v[112:115]
ds_read_b64_tr_b16 v[50:51], v8 offset:55296
v_mfma_f32_16x16x32_bf16 v[100:103], v[20:23], a[88:91], v[100:103]
ds_read_b64_tr_b16 v[52:53], v9 offset:53248
v_mfma_f32_16x16x32_bf16 v[116:119], v[20:23], a[92:95], v[116:119]
ds_read_b64_tr_b16 v[54:55], v9 offset:55296
v_mfma_f32_16x16x32_bf16 v[104:107], v[24:27], a[88:91], v[104:107]
ds_read_b64_tr_b16 v[56:57], v12 offset:53248
v_mfma_f32_16x16x32_bf16 v[120:123], v[24:27], a[92:95], v[120:123]
ds_read_b64_tr_b16 v[58:59], v12 offset:55296
v_mfma_f32_16x16x32_bf16 v[108:111], v[28:31], a[88:91], v[108:111]
ds_read_b64_tr_b16 v[60:61], v13 offset:53248
v_mfma_f32_16x16x32_bf16 v[124:127], v[28:31], a[92:95], v[124:127]
s_waitcnt lgkmcnt(7)
ds_read_b64_tr_b16 v[62:63], v13 offset:55296
v_mfma_f32_16x16x32_bf16 v[96:99], v[32:35], a[96:99], v[96:99]
ds_read_b64_tr_b16 v[16:17], v8 offset:57344
v_mfma_f32_16x16x32_bf16 v[112:115], v[32:35], a[100:103], v[112:115]
ds_read_b64_tr_b16 v[18:19], v8 offset:59392
v_mfma_f32_16x16x32_bf16 v[100:103], v[36:39], a[96:99], v[100:103]
ds_read_b64_tr_b16 v[20:21], v9 offset:57344
v_mfma_f32_16x16x32_bf16 v[116:119], v[36:39], a[100:103], v[116:119]
ds_read_b64_tr_b16 v[22:23], v9 offset:59392
v_mfma_f32_16x16x32_bf16 v[104:107], v[40:43], a[96:99], v[104:107]
ds_read_b64_tr_b16 v[24:25], v12 offset:57344
v_mfma_f32_16x16x32_bf16 v[120:123], v[40:43], a[100:103], v[120:123]
ds_read_b64_tr_b16 v[26:27], v12 offset:59392
v_mfma_f32_16x16x32_bf16 v[108:111], v[44:47], a[96:99], v[108:111]
ds_read_b64_tr_b16 v[28:29], v13 offset:57344
v_mfma_f32_16x16x32_bf16 v[124:127], v[44:47], a[100:103], v[124:127]
s_waitcnt lgkmcnt(7)
ds_read_b64_tr_b16 v[30:31], v13 offset:59392
v_mfma_f32_16x16x32_bf16 v[96:99], v[48:51], a[104:107], v[96:99]
ds_read_b64_tr_b16 v[32:33], v8 offset:61440
v_mfma_f32_16x16x32_bf16 v[112:115], v[48:51], a[108:111], v[112:115]
ds_read_b64_tr_b16 v[34:35], v8 offset:63488
v_mfma_f32_16x16x32_bf16 v[100:103], v[52:55], a[104:107], v[100:103]
ds_read_b64_tr_b16 v[36:37], v9 offset:61440
v_mfma_f32_16x16x32_bf16 v[116:119], v[52:55], a[108:111], v[116:119]
ds_read_b64_tr_b16 v[38:39], v9 offset:63488
v_mfma_f32_16x16x32_bf16 v[104:107], v[56:59], a[104:107], v[104:107]
ds_read_b64_tr_b16 v[40:41], v12 offset:61440
v_mfma_f32_16x16x32_bf16 v[120:123], v[56:59], a[108:111], v[120:123]
ds_read_b64_tr_b16 v[42:43], v12 offset:63488
v_mfma_f32_16x16x32_bf16 v[108:111], v[60:63], a[104:107], v[108:111]
ds_read_b64_tr_b16 v[44:45], v13 offset:61440
v_mfma_f32_16x16x32_bf16 v[124:127], v[60:63], a[108:111], v[124:127]
s_waitcnt lgkmcnt(7)
ds_read_b64_tr_b16 v[46:47], v13 offset:63488
v_mfma_f32_16x16x32_bf16 v[96:99], v[16:19], a[112:115], v[96:99]
v_mfma_f32_16x16x32_bf16 v[112:115], v[16:19], a[116:119], v[112:115]
v_mfma_f32_16x16x32_bf16 v[100:103], v[20:23], a[112:115], v[100:103]
v_mfma_f32_16x16x32_bf16 v[116:119], v[20:23], a[116:119], v[116:119]
v_mfma_f32_16x16x32_bf16 v[104:107], v[24:27], a[112:115], v[104:107]
v_mfma_f32_16x16x32_bf16 v[120:123], v[24:27], a[116:119], v[120:123]
v_mfma_f32_16x16x32_bf16 v[108:111], v[28:31], a[112:115], v[108:111]
v_mfma_f32_16x16x32_bf16 v[124:127], v[28:31], a[116:119], v[124:127]
s_waitcnt lgkmcnt(0)
v_mfma_f32_16x16x32_bf16 v[96:99], v[32:35], a[120:123], v[96:99]
v_mfma_f32_16x16x32_bf16 v[112:115], v[32:35], a[124:127], v[112:115]
v_mfma_f32_16x16x32_bf16 v[100:103], v[36:39], a[120:123], v[100:103]
v_mfma_f32_16x16x32_bf16 v[116:119], v[36:39], a[124:127], v[116:119]
v_mfma_f32_16x16x32_bf16 v[104:107], v[40:43], a[120:123], v[104:107]
v_mfma_f32_16x16x32_bf16 v[120:123], v[40:43], a[124:127], v[120:123]
v_mfma_f32_16x16x32_bf16 v[108:111], v[44:47], a[120:123], v[108:111]
v_mfma_f32_16x16x32_bf16 v[124:127], v[44:47], a[124:127], v[124:127]
s_nop 7
v_mul_f32 v1, s32, v96
v_mul_f32 v2, s32, v97
v_mul_f32 v14, s32, v98
v_mul_f32 v15, s32, v99
v_exp_f32 v1, -v1
v_exp_f32 v2, -v2
v_exp_f32 v14, -v14
v_exp_f32 v15, -v15
v_mul_f32 v96, v96, v104
v_mul_f32 v97, v97, v105
v_mul_f32 v98, v98, v106
v_mul_f32 v99, v99, v107
v_add_f32 v1, 1.0, v1
v_add_f32 v2, 1.0, v2
v_add_f32 v14, 1.0, v14
v_add_f32 v15, 1.0, v15
v_rcp_f32 v1, v1
v_rcp_f32 v2, v2
v_rcp_f32 v14, v14
v_rcp_f32 v15, v15
s_nop 0
v_mul_f32 v96, v96, v1
v_mul_f32 v97, v97, v2
v_mul_f32 v98, v98, v14
v_mul_f32 v99, v99, v15
v_mul_f32 v1, s32, v100
v_mul_f32 v2, s32, v101
v_mul_f32 v14, s32, v102
v_mul_f32 v15, s32, v103
v_exp_f32 v1, -v1
v_exp_f32 v2, -v2
v_exp_f32 v14, -v14
v_exp_f32 v15, -v15
v_mul_f32 v100, v100, v108
v_mul_f32 v101, v101, v109
v_mul_f32 v102, v102, v110
v_mul_f32 v103, v103, v111
v_add_f32 v1, 1.0, v1
v_add_f32 v2, 1.0, v2
v_add_f32 v14, 1.0, v14
v_add_f32 v15, 1.0, v15
v_rcp_f32 v1, v1
v_rcp_f32 v2, v2
v_rcp_f32 v14, v14
v_rcp_f32 v15, v15
s_nop 0
v_mul_f32 v100, v100, v1
v_mul_f32 v101, v101, v2
v_mul_f32 v102, v102, v14
v_mul_f32 v103, v103, v15
v_cvt_pk_bf16_f32 v96, v96, v97
v_cvt_pk_bf16_f32 v97, v98, v99
v_cvt_pk_bf16_f32 v98, v100, v101
v_cvt_pk_bf16_f32 v99, v102, v103
s_add_u32 s30, s41, 1024
buffer_store_dwordx4 v[96:99], v5, s[4:7], s30 offen sc1
v_mul_f32 v1, s32, v112
v_mul_f32 v2, s32, v113
v_mul_f32 v14, s32, v114
v_mul_f32 v15, s32, v115
v_exp_f32 v1, -v1
v_exp_f32 v2, -v2
v_exp_f32 v14, -v14
v_exp_f32 v15, -v15
v_mul_f32 v112, v112, v120
v_mul_f32 v113, v113, v121
v_mul_f32 v114, v114, v122
v_mul_f32 v115, v115, v123
v_add_f32 v1, 1.0, v1
v_add_f32 v2, 1.0, v2
v_add_f32 v14, 1.0, v14
v_add_f32 v15, 1.0, v15
v_rcp_f32 v1, v1
v_rcp_f32 v2, v2
v_rcp_f32 v14, v14
v_rcp_f32 v15, v15
s_nop 0
v_mul_f32 v112, v112, v1
v_mul_f32 v113, v113, v2
v_mul_f32 v114, v114, v14
v_mul_f32 v115, v115, v15
v_mul_f32 v1, s32, v116
v_mul_f32 v2, s32, v117
v_mul_f32 v14, s32, v118
v_mul_f32 v15, s32, v119
v_exp_f32 v1, -v1
v_exp_f32 v2, -v2
v_exp_f32 v14, -v14
v_exp_f32 v15, -v15
v_mul_f32 v116, v116, v124
v_mul_f32 v117, v117, v125
v_mul_f32 v118, v118, v126
v_mul_f32 v119, v119, v127
v_add_f32 v1, 1.0, v1
v_add_f32 v2, 1.0, v2
v_add_f32 v14, 1.0, v14
v_add_f32 v15, 1.0, v15
v_rcp_f32 v1, v1
v_rcp_f32 v2, v2
v_rcp_f32 v14, v14
v_rcp_f32 v15, v15
s_nop 0
v_mul_f32 v116, v116, v1
v_mul_f32 v117, v117, v2
v_mul_f32 v118, v118, v14
v_mul_f32 v119, v119, v15
v_cvt_pk_bf16_f32 v112, v112, v113
v_cvt_pk_bf16_f32 v113, v114, v115
v_cvt_pk_bf16_f32 v114, v116, v117
v_cvt_pk_bf16_f32 v115, v118, v119
s_add_u32 s30, s41, 58368
buffer_store_dwordx4 v[112:115], v5, s[4:7], s30 offen sc1
s_waitcnt vmcnt(0)
s_barrier
s_lshl_b32 s30, s33, 7
s_add_u32 s30, s30, 0x21c00
s_cmp_eq_u32 s20, 0
s_cselect_b32 s31, s30, s86
v_mov_b32 v1, 1
s_mov_b64 exec, 1
buffer_atomic_add v1, off, s[4:7], s31 sc1
s_mov_b64 exec, -1
L_k5_1050:
s_load_dwordx2 s[12:13], s[0:1], 72
v_lshrrev_b32 v14, 3, v0
s_mov_b32 s55, 1024
v_mul_lo_u32 v48, v14, s55
v_bfe_u32 v14, v14, 1, 2
v_bfe_u32 v15, v0, 1, 2
v_xor_b32 v14, v14, v15
v_and_b32 v15, 1, v0
v_lshlrev_b32 v15, 4, v15
v_add_u32 v48, v48, v15
v_lshl_add_u32 v49, v14, 5, v48
v_lshl_add_u32 v48, v14, 5, v48
v_add_u32 v49, 7168, v49
v_lshrrev_b32 v14, 4, v0
v_bfe_u32 v15, v0, 2, 2
v_lshl_add_u32 v15, v14, 2, v15
v_lshlrev_b32 v6, 7, v15
v_bfe_u32 v14, v15, 1, 2
v_lshl_add_u32 v6, v14, 5, v6
v_and_b32 v15, 3, v0
v_lshl_add_u32 v6, v15, 3, v6
v_xor_b32 v7, 32, v6
v_xor_b32 v8, 64, v6
v_xor_b32 v9, 96, v6
v_add_u32 v49, 7168, v48
v_add_u32 v50, 14336, v48
v_add_u32 v51, 21504, v48
s_mul_i32 s27, s20, 20480
v_add_u32 v6, s27, v6
v_add_u32 v7, s27, v7
v_add_u32 v8, s27, v8
v_add_u32 v9, s27, v9
s_mul_i32 s25, s23, 229376
s_mul_i32 s30, s20, 7168
s_add_u32 s25, s25, s30
s_add_u32 s25, s25, 0xa00000
s_mul_i32 s26, s20, 229376
s_lshl_b32 s30, s24, 7
s_add_u32 s26, s26, s30
s_waitcnt lgkmcnt(0)
s_mov_b32 s14, 0x1c0000
s_mov_b32 s15, 0x20000
s_lshr_b32 s30, s23, 2
s_lshl_b32 s32, s30, 7
s_add_u32 s32, s32, 0x21c00
s_add_u32 m0, s27, 0
s_add_u32 s30, s26, 0
buffer_load_dwordx4 v48, s[12:15], s30 offen offset:0 lds
buffer_load_dwordx4 v49, s[12:15], s30 offen offset:1024 lds
buffer_load_dwordx4 v50, s[12:15], s30 offen offset:2048 lds
buffer_load_dwordx4 v51, s[12:15], s30 offen offset:3072 lds
s_add_u32 m0, s27, 4096
s_add_u32 s30, s26, 32768
buffer_load_dwordx4 v48, s[12:15], s30 offen offset:0 lds
buffer_load_dwordx4 v49, s[12:15], s30 offen offset:1024 lds
buffer_load_dwordx4 v50, s[12:15], s30 offen offset:2048 lds
buffer_load_dwordx4 v51, s[12:15], s30 offen offset:3072 lds
s_add_u32 m0, s27, 8192
s_add_u32 s30, s26, 65536
buffer_load_dwordx4 v48, s[12:15], s30 offen offset:0 lds
buffer_load_dwordx4 v49, s[12:15], s30 offen offset:1024 lds
buffer_load_dwordx4 v50, s[12:15], s30 offen offset:2048 lds
buffer_load_dwordx4 v51, s[12:15], s30 offen offset:3072 lds
s_add_u32 m0, s27, 12288
s_add_u32 s30, s26, 98304
buffer_load_dwordx4 v48, s[12:15], s30 offen offset:0 lds
buffer_load_dwordx4 v49, s[12:15], s30 offen offset:1024 lds
buffer_load_dwordx4 v50, s[12:15], s30 offen offset:2048 lds
buffer_load_dwordx4 v51, s[12:15], s30 offen offset:3072 lds
s_lshl_b32 s30, s24, 6
s_lshl_b32 s31, s29, 5
s_add_u32 s30, s30, s31
v_lshrrev_b32 v15, 4, v0
v_lshlrev_b32 v15, 2, v15
v_add_u32 v15, s30, v15
v_lshlrev_b32 v13, 2, v15
s_mov_b32 s30, 0x2800
buffer_load_dwordx4 v[60:63], v13, s[4:7], s30 offen sc1
buffer_load_dwordx4 v[12:15], v13, s[4:7], s30 offen offset:64 sc1
s_load_dwordx2 s[16:17], s[0:1], 96
s_cmp_lg_u32 s20, 0
s_cbranch_scc1 L_sok_1053
s_mov_b32 s31, 0x40000
L_sloop_1054:
buffer_load_dword v1, off, s[4:7], s32 sc1
s_waitcnt vmcnt(0)
v_readfirstlane_b32 s30, v1
s_nop 3
s_cmp_ge_u32 s30, 28
s_cbranch_scc1 L_sok_1053
s_sleep 16
s_sub_u32 s31, s31, 1
s_cmp_lg_u32 s31, 0
s_cbranch_scc1 L_sloop_1054
L_sok_1053:
s_waitcnt lgkmcnt(0)
s_mov_b32 s18, 0x200000
s_mov_b32 s19, 0x20000
s_barrier
s_lshl_b32 s30, s23, 2
s_add_u32 s30, s30, s28
s_lshl_b32 s30, s30, 4
s_lshl_b32 s31, s24, 1
s_add_u32 s30, s30, s31
s_add_u32 s30, s30, s29
s_lshl_b32 s30, s30, 11
s_add_u32 s30, s30, 0x400000
buffer_load_dwordx4 v[52:55], v5, s[4:7], s30 offen sc1
buffer_load_dwordx4 v[56:59], v5, s[4:7], s30 offen offset:1024 sc1
s_add_u32 s31, s25, 0
buffer_load_dwordx4 a[64:67], v5, s[4:7], s31 offen sc1
s_add_u32 s31, s25, 57344
buffer_load_dwordx4 a[68:71], v5, s[4:7], s31 offen sc1
s_add_u32 s31, s25, 114688
buffer_load_dwordx4 a[72:75], v5, s[4:7], s31 offen sc1
s_add_u32 s31, s25, 172032
buffer_load_dwordx4 a[76:79], v5, s[4:7], s31 offen sc1
s_add_u32 s31, s25, 1024
buffer_load_dwordx4 a[80:83], v5, s[4:7], s31 offen sc1
s_add_u32 s31, s25, 58368
buffer_load_dwordx4 a[84:87], v5, s[4:7], s31 offen sc1
s_add_u32 s31, s25, 115712
buffer_load_dwordx4 a[88:91], v5, s[4:7], s31 offen sc1
s_add_u32 s31, s25, 173056
buffer_load_dwordx4 a[92:95], v5, s[4:7], s31 offen sc1
s_add_u32 s31, s25, 2048
buffer_load_dwordx4 a[96:99], v5, s[4:7], s31 offen sc1
s_add_u32 s31, s25, 59392
buffer_load_dwordx4 a[100:103], v5, s[4:7], s31 offen sc1
s_add_u32 s31, s25, 116736
buffer_load_dwordx4 a[104:107], v5, s[4:7], s31 offen sc1
s_add_u32 s31, s25, 174080
buffer_load_dwordx4 a[108:111], v5, s[4:7], s31 offen sc1
s_add_u32 s31, s25, 3072
buffer_load_dwordx4 a[112:115], v5, s[4:7], s31 offen sc1
s_add_u32 s31, s25, 60416
buffer_load_dwordx4 a[116:119], v5, s[4:7], s31 offen sc1
s_add_u32 s31, s25, 117760
buffer_load_dwordx4 a[120:123], v5, s[4:7], s31 offen sc1
s_add_u32 s31, s25, 175104
buffer_load_dwordx4 a[124:127], v5, s[4:7], s31 offen sc1
s_waitcnt vmcnt(32)
ds_read_b64_tr_b16 v[16:17], v6 offset:0
ds_read_b64_tr_b16 v[18:19], v6 offset:2048
ds_read_b64_tr_b16 v[20:21], v7 offset:0
ds_read_b64_tr_b16 v[22:23], v7 offset:2048
ds_read_b64_tr_b16 v[24:25], v8 offset:0
ds_read_b64_tr_b16 v[26:27], v8 offset:2048
ds_read_b64_tr_b16 v[28:29], v9 offset:0
ds_read_b64_tr_b16 v[30:31], v9 offset:2048
s_waitcnt vmcnt(28)
s_waitcnt lgkmcnt(0)
s_waitcnt vmcnt(12)
v_mfma_f32_16x16x32_bf16 a[0:3], v[16:19], a[64:67], 0
ds_read_b64_tr_b16 v[32:33], v6 offset:4096
v_mfma_f32_16x16x32_bf16 a[4:7], v[16:19], a[68:71], 0
ds_read_b64_tr_b16 v[34:35], v6 offset:6144
v_mfma_f32_16x16x32_bf16 a[8:11], v[16:19], a[72:75], 0
ds_read_b64_tr_b16 v[36:37], v7 offset:4096
v_mfma_f32_16x16x32_bf16 a[12:15], v[16:19], a[76:79], 0
ds_read_b64_tr_b16 v[38:39], v7 offset:6144
v_mfma_f32_16x16x32_bf16 a[16:19], v[20:23], a[64:67], 0
ds_read_b64_tr_b16 v[40:41], v8 offset:4096
v_mfma_f32_16x16x32_bf16 a[20:23], v[20:23], a[68:71], 0
ds_read_b64_tr_b16 v[42:43], v8 offset:6144
v_mfma_f32_16x16x32_bf16 a[24:27], v[20:23], a[72:75], 0
ds_read_b64_tr_b16 v[44:45], v9 offset:4096
v_mfma_f32_16x16x32_bf16 a[28:31], v[20:23], a[76:79], 0
ds_read_b64_tr_b16 v[46:47], v9 offset:6144
v_mfma_f32_16x16x32_bf16 a[32:35], v[24:27], a[64:67], 0
s_add_u32 m0, s27, 16384
s_add_u32 s30, s26, 131072
buffer_load_dwordx4 v48, s[12:15], s30 offen offset:0 lds
buffer_load_dwordx4 v49, s[12:15], s30 offen offset:1024 lds
buffer_load_dwordx4 v50, s[12:15], s30 offen offset:2048 lds
buffer_load_dwordx4 v51, s[12:15], s30 offen offset:3072 lds
v_mfma_f32_16x16x32_bf16 a[36:39], v[24:27], a[68:71], 0
v_mfma_f32_16x16x32_bf16 a[40:43], v[24:27], a[72:75], 0
v_mfma_f32_16x16x32_bf16 a[44:47], v[24:27], a[76:79], 0
v_mfma_f32_16x16x32_bf16 a[48:51], v[28:31], a[64:67], 0
v_mfma_f32_16x16x32_bf16 a[52:55], v[28:31], a[68:71], 0
v_mfma_f32_16x16x32_bf16 a[56:59], v[28:31], a[72:75], 0
v_mfma_f32_16x16x32_bf16 a[60:63], v[28:31], a[76:79], 0
s_add_u32 s31, s25, 4096
buffer_load_dwordx4 a[64:67], v5, s[4:7], s31 offen sc1
s_add_u32 s31, s25, 61440
buffer_load_dwordx4 a[68:71], v5, s[4:7], s31 offen sc1
s_add_u32 s31, s25, 118784
buffer_load_dwordx4 a[72:75], v5, s[4:7], s31 offen sc1
s_add_u32 s31, s25, 176128
buffer_load_dwordx4 a[76:79], v5, s[4:7], s31 offen sc1
s_waitcnt lgkmcnt(0)
s_waitcnt vmcnt(16)
v_mfma_f32_16x16x32_bf16 a[0:3], v[32:35], a[80:83], a[0:3]
ds_read_b64_tr_b16 v[16:17], v6 offset:8192
v_mfma_f32_16x16x32_bf16 a[4:7], v[32:35], a[84:87], a[4:7]
ds_read_b64_tr_b16 v[18:19], v6 offset:10240
v_mfma_f32_16x16x32_bf16 a[8:11], v[32:35], a[88:91], a[8:11]
ds_read_b64_tr_b16 v[20:21], v7 offset:8192
v_mfma_f32_16x16x32_bf16 a[12:15], v[32:35], a[92:95], a[12:15]
ds_read_b64_tr_b16 v[22:23], v7 offset:10240
v_mfma_f32_16x16x32_bf16 a[16:19], v[36:39], a[80:83], a[16:19]
ds_read_b64_tr_b16 v[24:25], v8 offset:8192
v_mfma_f32_16x16x32_bf16 a[20:23], v[36:39], a[84:87], a[20:23]
ds_read_b64_tr_b16 v[26:27], v8 offset:10240
v_mfma_f32_16x16x32_bf16 a[24:27], v[36:39], a[88:91], a[24:27]
ds_read_b64_tr_b16 v[28:29], v9 offset:8192
v_mfma_f32_16x16x32_bf16 a[28:31], v[36:39], a[92:95], a[28:31]
ds_read_b64_tr_b16 v[30:31], v9 offset:10240
v_mfma_f32_16x16x32_bf16 a[32:35], v[40:43], a[80:83], a[32:35]
s_add_u32 m0, s27, 0
s_add_u32 s30, s26, 163840
buffer_load_dwordx4 v48, s[12:15], s30 offen offset:0 lds
buffer_load_dwordx4 v49, s[12:15], s30 offen offset:1024 lds
buffer_load_dwordx4 v50, s[12:15], s30 offen offset:2048 lds
buffer_load_dwordx4 v51, s[12:15], s30 offen offset:3072 lds
v_mfma_f32_16x16x32_bf16 a[36:39], v[40:43], a[84:87], a[36:39]
v_mfma_f32_16x16x32_bf16 a[40:43], v[40:43], a[88:91], a[40:43]
v_mfma_f32_16x16x32_bf16 a[44:47], v[40:43], a[92:95], a[44:47]
v_mfma_f32_16x16x32_bf16 a[48:51], v[44:47], a[80:83], a[48:51]
v_mfma_f32_16x16x32_bf16 a[52:55], v[44:47], a[84:87], a[52:55]
v_mfma_f32_16x16x32_bf16 a[56:59], v[44:47], a[88:91], a[56:59]
v_mfma_f32_16x16x32_bf16 a[60:63], v[44:47], a[92:95], a[60:63]
s_add_u32 s31, s25, 5120
buffer_load_dwordx4 a[80:83], v5, s[4:7], s31 offen sc1
s_add_u32 s31, s25, 62464
buffer_load_dwordx4 a[84:87], v5, s[4:7], s31 offen sc1
s_add_u32 s31, s25, 119808
buffer_load_dwordx4 a[88:91], v5, s[4:7], s31 offen sc1
s_add_u32 s31, s25, 177152
buffer_load_dwordx4 a[92:95], v5, s[4:7], s31 offen sc1
s_waitcnt lgkmcnt(0)
s_waitcnt vmcnt(20)
v_mfma_f32_16x16x32_bf16 a[0:3], v[16:19], a[96:99], a[0:3]
ds_read_b64_tr_b16 v[32:33], v6 offset:12288
v_mfma_f32_16x16x32_bf16 a[4:7], v[16:19], a[100:103], a[4:7]
ds_read_b64_tr_b16 v[34:35], v6 offset:14336
v_mfma_f32_16x16x32_bf16 a[8:11], v[16:19], a[104:107], a[8:11]
ds_read_b64_tr_b16 v[36:37], v7 offset:12288
v_mfma_f32_16x16x32_bf16 a[12:15], v[16:19], a[108:111], a[12:15]
ds_read_b64_tr_b16 v[38:39], v7 offset:14336
v_mfma_f32_16x16x32_bf16 a[16:19], v[20:23], a[96:99], a[16:19]
ds_read_b64_tr_b16 v[40:41], v8 offset:12288
v_mfma_f32_16x16x32_bf16 a[20:23], v[20:23], a[100:103], a[20:23]
ds_read_b64_tr_b16 v[42:43], v8 offset:14336
v_mfma_f32_16x16x32_bf16 a[24:27], v[20:23], a[104:107], a[24:27]
ds_read_b64_tr_b16 v[44:45], v9 offset:12288
v_mfma_f32_16x16x32_bf16 a[28:31], v[20:23], a[108:111], a[28:31]
ds_read_b64_tr_b16 v[46:47], v9 offset:14336
v_mfma_f32_16x16x32_bf16 a[32:35], v[24:27], a[96:99], a[32:35]
s_add_u32 m0, s27, 4096
s_add_u32 s30, s26, 196608
buffer_load_dwordx4 v48, s[12:15], s30 offen offset:0 lds
buffer_load_dwordx4 v49, s[12:15], s30 offen offset:1024 lds
buffer_load_dwordx4 v50, s[12:15], s30 offen offset:2048 lds
buffer_load_dwordx4 v51, s[12:15], s30 offen offset:3072 lds
v_mfma_f32_16x16x32_bf16 a[36:39], v[24:27], a[100:103], a[36:39]
v_mfma_f32_16x16x32_bf16 a[40:43], v[24:27], a[104:107], a[40:43]
v_mfma_f32_16x16x32_bf16 a[44:47], v[24:27], a[108:111], a[44:47]
v_mfma_f32_16x16x32_bf16 a[48:51], v[28:31], a[96:99], a[48:51]
v_mfma_f32_16x16x32_bf16 a[52:55], v[28:31], a[100:103], a[52:55]
v_mfma_f32_16x16x32_bf16 a[56:59], v[28:31], a[104:107], a[56:59]
v_mfma_f32_16x16x32_bf16 a[60:63], v[28:31], a[108:111], a[60:63]
s_add_u32 s31, s25, 6144
buffer_load_dwordx4 a[96:99], v5, s[4:7], s31 offen sc1
s_add_u32 s31, s25, 63488
buffer_load_dwordx4 a[100:103], v5, s[4:7], s31 offen sc1
s_add_u32 s31, s25, 120832
buffer_load_dwordx4 a[104:107], v5, s[4:7], s31 offen sc1
s_add_u32 s31, s25, 178176
buffer_load_dwordx4 a[108:111], v5, s[4:7], s31 offen sc1
s_waitcnt vmcnt(20)
s_waitcnt lgkmcnt(0)
v_mfma_f32_16x16x32_bf16 a[0:3], v[32:35], a[112:115], a[0:3]
ds_read_b64_tr_b16 v[16:17], v6 offset:16384
v_mfma_f32_16x16x32_bf16 a[4:7], v[32:35], a[116:119], a[4:7]
ds_read_b64_tr_b16 v[18:19], v6 offset:18432
v_mfma_f32_16x16x32_bf16 a[8:11], v[32:35], a[120:123], a[8:11]
ds_read_b64_tr_b16 v[20:21], v7 offset:16384
v_mfma_f32_16x16x32_bf16 a[12:15], v[32:35], a[124:127], a[12:15]
ds_read_b64_tr_b16 v[22:23], v7 offset:18432
v_mfma_f32_16x16x32_bf16 a[16:19], v[36:39], a[112:115], a[16:19]
ds_read_b64_tr_b16 v[24:25], v8 offset:16384
v_mfma_f32_16x16x32_bf16 a[20:23], v[36:39], a[116:119], a[20:23]
ds_read_b64_tr_b16 v[26:27], v8 offset:18432
v_mfma_f32_16x16x32_bf16 a[24:27], v[36:39], a[120:123], a[24:27]
ds_read_b64_tr_b16 v[28:29], v9 offset:16384
v_mfma_f32_16x16x32_bf16 a[28:31], v[36:39], a[124:127], a[28:31]
ds_read_b64_tr_b16 v[30:31], v9 offset:18432
v_mfma_f32_16x16x32_bf16 a[32:35], v[40:43], a[112:115], a[32:35]
v_mfma_f32_16x16x32_bf16 a[36:39], v[40:43], a[116:119], a[36:39]
v_mfma_f32_16x16x32_bf16 a[40:43], v[40:43], a[120:123], a[40:43]
v_mfma_f32_16x16x32_bf16 a[44:47], v[40:43], a[124:127], a[44:47]
v_mfma_f32_16x16x32_bf16 a[48:51], v[44:47], a[112:115], a[48:51]
v_mfma_f32_16x16x32_bf16 a[52:55], v[44:47], a[116:119], a[52:55]
v_mfma_f32_16x16x32_bf16 a[56:59], v[44:47], a[120:123], a[56:59]
v_mfma_f32_16x16x32_bf16 a[60:63], v[44:47], a[124:127], a[60:63]
s_waitcnt vmcnt(12)
s_waitcnt lgkmcnt(0)
v_mfma_f32_16x16x32_bf16 a[0:3], v[16:19], a[64:67], a[0:3]
ds_read_b64_tr_b16 v[32:33], v6 offset:0
v_mfma_f32_16x16x32_bf16 a[4:7], v[16:19], a[68:71], a[4:7]
ds_read_b64_tr_b16 v[34:35], v6 offset:2048
v_mfma_f32_16x16x32_bf16 a[8:11], v[16:19], a[72:75], a[8:11]
ds_read_b64_tr_b16 v[36:37], v7 offset:0
v_mfma_f32_16x16x32_bf16 a[12:15], v[16:19], a[76:79], a[12:15]
ds_read_b64_tr_b16 v[38:39], v7 offset:2048
v_mfma_f32_16x16x32_bf16 a[16:19], v[20:23], a[64:67], a[16:19]
ds_read_b64_tr_b16 v[40:41], v8 offset:0
v_mfma_f32_16x16x32_bf16 a[20:23], v[20:23], a[68:71], a[20:23]
ds_read_b64_tr_b16 v[42:43], v8 offset:2048
v_mfma_f32_16x16x32_bf16 a[24:27], v[20:23], a[72:75], a[24:27]
ds_read_b64_tr_b16 v[44:45], v9 offset:0
v_mfma_f32_16x16x32_bf16 a[28:31], v[20:23], a[76:79], a[28:31]
ds_read_b64_tr_b16 v[46:47], v9 offset:2048
v_mfma_f32_16x16x32_bf16 a[32:35], v[24:27], a[64:67], a[32:35]
v_mfma_f32_16x16x32_bf16 a[36:39], v[24:27], a[68:71], a[36:39]
v_mfma_f32_16x16x32_bf16 a[40:43], v[24:27], a[72:75], a[40:43]
v_mfma_f32_16x16x32_bf16 a[44:47], v[24:27], a[76:79], a[44:47]
v_mfma_f32_16x16x32_bf16 a[48:51], v[28:31], a[64:67], a[48:51]
v_mfma_f32_16x16x32_bf16 a[52:55], v[28:31], a[68:71], a[52:55]
v_mfma_f32_16x16x32_bf16 a[56:59], v[28:31], a[72:75], a[56:59]
v_mfma_f32_16x16x32_bf16 a[60:63], v[28:31], a[76:79], a[60:63]
s_waitcnt vmcnt(4)
s_waitcnt lgkmcnt(0)
v_mfma_f32_16x16x32_bf16 a[0:3], v[32:35], a[80:83], a[0:3]
ds_read_b64_tr_b16 v[16:17], v6 offset:4096
v_mfma_f32_16x16x32_bf16 a[4:7], v[32:35], a[84:87], a[4:7]
ds_read_b64_tr_b16 v[18:19], v6 offset:6144
v_mfma_f32_16x16x32_bf16 a[8:11], v[32:35], a[88:91], a[8:11]
ds_read_b64_tr_b16 v[20:21], v7 offset:4096
v_mfma_f32_16x16x32_bf16 a[12:15], v[32:35], a[92:95], a[12:15]
ds_read_b64_tr_b16 v[22:23], v7 offset:6144
v_mfma_f32_16x16x32_bf16 a[16:19], v[36:39], a[80:83], a[16:19]
ds_read_b64_tr_b16 v[24:25], v8 offset:4096
v_mfma_f32_16x16x32_bf16 a[20:23], v[36:39], a[84:87], a[20:23]
ds_read_b64_tr_b16 v[26:27], v8 offset:6144
v_mfma_f32_16x16x32_bf16 a[24:27], v[36:39], a[88:91], a[24:27]
ds_read_b64_tr_b16 v[28:29], v9 offset:4096
v_mfma_f32_16x16x32_bf16 a[28:31], v[36:39], a[92:95], a[28:31]
ds_read_b64_tr_b16 v[30:31], v9 offset:6144
v_mfma_f32_16x16x32_bf16 a[32:35], v[40:43], a[80:83], a[32:35]
v_mfma_f32_16x16x32_bf16 a[36:39], v[40:43], a[84:87], a[36:39]
v_mfma_f32_16x16x32_bf16 a[40:43], v[40:43], a[88:91], a[40:43]
v_mfma_f32_16x16x32_bf16 a[44:47], v[40:43], a[92:95], a[44:47]
v_mfma_f32_16x16x32_bf16 a[48:51], v[44:47], a[80:83], a[48:51]
v_mfma_f32_16x16x32_bf16 a[52:55], v[44:47], a[84:87], a[52:55]
v_mfma_f32_16x16x32_bf16 a[56:59], v[44:47], a[88:91], a[56:59]
v_mfma_f32_16x16x32_bf16 a[60:63], v[44:47], a[92:95], a[60:63]
s_waitcnt lgkmcnt(0)
s_waitcnt vmcnt(0)
v_mfma_f32_16x16x32_bf16 a[0:3], v[16:19], a[96:99], a[0:3]
v_mfma_f32_16x16x32_bf16 a[4:7], v[16:19], a[100:103], a[4:7]
v_mfma_f32_16x16x32_bf16 a[8:11], v[16:19], a[104:107], a[8:11]
v_mfma_f32_16x16x32_bf16 a[12:15], v[16:19], a[108:111], a[12:15]
v_mfma_f32_16x16x32_bf16 a[16:19], v[20:23], a[96:99], a[16:19]
v_mfma_f32_16x16x32_bf16 a[20:23], v[20:23], a[100:103], a[20:23]
v_mfma_f32_16x16x32_bf16 a[24:27], v[20:23], a[104:107], a[24:27]
v_mfma_f32_16x16x32_bf16 a[28:31], v[20:23], a[108:111], a[28:31]
v_mfma_f32_16x16x32_bf16 a[32:35], v[24:27], a[96:99], a[32:35]
v_mfma_f32_16x16x32_bf16 a[36:39], v[24:27], a[100:103], a[36:39]
v_mfma_f32_16x16x32_bf16 a[40:43], v[24:27], a[104:107], a[40:43]
v_mfma_f32_16x16x32_bf16 a[44:47], v[24:27], a[108:111], a[44:47]
v_mfma_f32_16x16x32_bf16 a[48:51], v[28:31], a[96:99], a[48:51]
v_mfma_f32_16x16x32_bf16 a[52:55], v[28:31], a[100:103], a[52:55]
v_mfma_f32_16x16x32_bf16 a[56:59], v[28:31], a[104:107], a[56:59]
v_mfma_f32_16x16x32_bf16 a[60:63], v[28:31], a[108:111], a[60:63]
s_nop 7
s_barrier
s_lshl_b32 s30, s20, 14
v_add_u32 v10, s30, v5
ds_write_b128 v10, a[0:3] offset:0
ds_write_b128 v10, a[4:7] offset:1024
ds_write_b128 v10, a[8:11] offset:2048
ds_write_b128 v10, a[12:15] offset:3072
ds_write_b128 v10, a[16:19] offset:4096
ds_write_b128 v10, a[20:23] offset:5120
ds_write_b128 v10, a[24:27] offset:6144
ds_write_b128 v10, a[28:31] offset:7168
ds_write_b128 v10, a[32:35] offset:8192
ds_write_b128 v10, a[36:39] offset:9216
ds_write_b128 v10, a[40:43] offset:10240
ds_write_b128 v10, a[44:47] offset:11264
ds_write_b128 v10, a[48:51] offset:12288
ds_write_b128 v10, a[52:55] offset:13312
ds_write_b128 v10, a[56:59] offset:14336
ds_write_b128 v10, a[60:63] offset:15360
s_lshl_b32 s30, s29, 3
s_add_u32 s30, s30, s28
s_lshl_b32 s30, s30, 10
v_add_u32 v10, s30, v5
v_add_u32 v11, 0x10000, v10
s_waitcnt lgkmcnt(0)
s_barrier
ds_read_b128 v[64:67], v10 offset:0
ds_read_b128 v[68:71], v10 offset:4096
ds_read_b128 v[72:75], v10 offset:16384
ds_read_b128 v[76:79], v10 offset:20480
ds_read_b128 v[80:83], v10 offset:32768
ds_read_b128 v[84:87], v10 offset:36864
ds_read_b128 v[88:91], v10 offset:49152
ds_read_b128 v[92:95], v10 offset:53248
ds_read_b128 v[96:99], v11 offset:0
ds_read_b128 v[100:103], v11 offset:4096
ds_read_b128 v[104:107], v11 offset:16384
ds_read_b128 v[108:111], v11 offset:20480
ds_read_b128 v[112:115], v11 offset:32768
ds_read_b128 v[116:119], v11 offset:36864
ds_read_b128 v[120:123], v11 offset:49152
s_waitcnt lgkmcnt(8)
ds_read_b128 v[124:127], v11 offset:53248
s_waitcnt lgkmcnt(0)
v_add_f32 v64, v64, v96
v_add_f32 v65, v65, v97
v_add_f32 v66, v66, v98
v_add_f32 v67, v67, v99
v_add_f32 v68, v68, v100
v_add_f32 v69, v69, v101
v_add_f32 v70, v70, v102
v_add_f32 v71, v71, v103
v_add_f32 v72, v72, v104
v_add_f32 v73, v73, v105
v_add_f32 v74, v74, v106
v_add_f32 v75, v75, v107
v_add_f32 v76, v76, v108
v_add_f32 v77, v77, v109
v_add_f32 v78, v78, v110
v_add_f32 v79, v79, v111
v_add_f32 v80, v80, v112
v_add_f32 v81, v81, v113
v_add_f32 v82, v82, v114
v_add_f32 v83, v83, v115
v_add_f32 v84, v84, v116
v_add_f32 v85, v85, v117
v_add_f32 v86, v86, v118
v_add_f32 v87, v87, v119
v_add_f32 v88, v88, v120
v_add_f32 v89, v89, v121
v_add_f32 v90, v90, v122
v_add_f32 v91, v91, v123
v_add_f32 v92, v92, v124
v_add_f32 v93, v93, v125
v_add_f32 v94, v94, v126
v_add_f32 v95, v95, v127
v_add_f32 v64, v64, v80
v_add_f32 v65, v65, v81
v_add_f32 v66, v66, v82
v_add_f32 v67, v67, v83
v_add_f32 v68, v68, v84
v_add_f32 v69, v69, v85
v_add_f32 v70, v70, v86
v_add_f32 v71, v71, v87
v_add_f32 v72, v72, v88
v_add_f32 v73, v73, v89
v_add_f32 v74, v74, v90
v_add_f32 v75, v75, v91
v_add_f32 v76, v76, v92
v_add_f32 v77, v77, v93
v_add_f32 v78, v78, v94
v_add_f32 v79, v79, v95
v_add_f32 v64, v64, v72
v_add_f32 v65, v65, v73
v_add_f32 v66, v66, v74
v_add_f32 v67, v67, v75
v_add_f32 v68, v68, v76
v_add_f32 v69, v69, v77
v_add_f32 v70, v70, v78
v_add_f32 v71, v71, v79
v_fma_f32 v64, v64, v60, v52
v_fma_f32 v65, v65, v61, v53
v_fma_f32 v66, v66, v62, v54
v_fma_f32 v67, v67, v63, v55
v_fma_f32 v68, v68, v12, v56
v_fma_f32 v69, v69, v13, v57
v_fma_f32 v70, v70, v14, v58
v_fma_f32 v71, v71, v15, v59
v_cvt_pk_bf16_f32 v16, v64, v65
v_cvt_pk_bf16_f32 v17, v66, v67
v_cvt_pk_bf16_f32 v18, v68, v69
v_cvt_pk_bf16_f32 v19, v70, v71
s_barrier
v_and_b32 v20, 15, v0
s_lshl_b32 s30, s28, 4
v_add_u32 v20, s30, v20
v_mul_u32_u24 v20, 144, v20
v_lshrrev_b32 v21, 4, v0
v_lshl_add_u32 v20, v21, 3, v20
s_lshl_b32 s30, s29, 6
v_add_u32 v20, s30, v20
ds_write_b64 v20, v[16:17]
ds_write_b64 v20, v[18:19] offset:32
s_waitcnt lgkmcnt(0)
s_barrier
v_lshrrev_b32 v20, 3, v0
s_lshl_b32 s30, s20, 3
v_add_u32 v20, s30, v20
v_and_b32 v21, 7, v0
v_mul_u32_u24 v22, 144, v20
v_lshl_add_u32 v22, v21, 4, v22
ds_read_b128 v[24:27], v22
s_lshl_b32 s30, s23, 6
v_add_u32 v20, s30, v20
v_lshlrev_b32 v20, 10, v20
v_lshl_add_u32 v20, v21, 4, v20
s_lshl_b32 s30, s24, 7
s_waitcnt lgkmcnt(0)
buffer_store_dwordx4 v[24:27], v20, s[16:19], s30 offen
L_end_adaLN_cond__compressed_kv_cla__swiglu_ffn__prompt_kernel:
s_endpgm
.section .rodata,"a"
.p2align 6
.amdhsa_kernel adaLN_cond__compressed_kv_cla__swiglu_ffn__prompt_kernel
  .amdhsa_next_free_vgpr 256
  .amdhsa_next_free_sgpr 102
  .amdhsa_accum_offset 128
  .amdhsa_group_segment_fixed_size 0
  .amdhsa_kernarg_size 120
  .amdhsa_user_sgpr_count 2
  .amdhsa_user_sgpr_kernarg_segment_ptr 1
  .amdhsa_system_sgpr_workgroup_id_x 1
.end_amdhsa_kernel
```
